```python
import torch

def _softmax(x, axis=-1):
    return torch.softmax(x, dim=axis)

def _gelu(x):
    return torch.nn.functional.gelu(x, approximate='tanh')

def _silu(x):
    return torch.nn.functional.silu(x)

def _sigmoid(x):
    return torch.sigmoid(x)

def _layernorm(x, axis=-1, eps=1e-05):
    m = x.mean(dim=axis, keepdim=True)
    v = x.var(dim=axis, keepdim=True, unbiased=False)
    return (x - m) / torch.sqrt(v + eps)

def _scatter_add(tgt, idx, src, axis=0):
    return tgt.clone().index_add_(axis, idx, src)

def _segment_sum(src, seg, n):
    out = torch.zeros((n,) + src.shape[1:], dtype=src.dtype)
    return out.index_add_(0, seg, src)

def _pad(x, pw):
    flat = tuple((v for pair in reversed(pw) for v in pair))
    return torch.nn.functional.pad(x, flat)
kernel_name = 'recurrent_scan__memory_aug_recurrent_mem_tr__glu_gated_swiglu__prompt'

def setup_inputs():

    _w = lambda a: (lambda t: t.to(torch.bfloat16) if t.is_floating_point() else t)(torch.as_tensor(a))

    def _A_setup():
        B, S, Dm = (1, 2048, 640)
        H, Dh = (32, 128)
        M, seg = (8, 32)
        seg = min(seg, S)
        S = S // seg * seg
        return {'x': _w((lambda *s: torch.randn(*s, dtype=torch.bfloat16) * 0.1)(B, S, Dm)), 'mem0': _w((lambda *s: torch.randn(*s, dtype=torch.bfloat16) * 1.6)(B, M, Dm)), 'Wq': _w((lambda *s: torch.randn(*s, dtype=torch.bfloat16) * 0.8)(Dm, H, Dh) * Dm ** (-0.5)), 'Wk': _w((lambda *s: torch.randn(*s, dtype=torch.bfloat16) * 0.8)(Dm, H, Dh) * Dm ** (-0.5)), 'Wv': _w((lambda *s: torch.randn(*s, dtype=torch.bfloat16) * 1.6)(Dm, H, Dh) * Dm ** (-0.5)), 'Wo': _w((lambda *s: torch.randn(*s, dtype=torch.bfloat16) * 1.6)(H, Dh, Dm) * (H * Dh) ** (-0.5)), 'seg_len': seg}
    _A_in = _A_setup()

    def _B_setup():
        B, S, D, F = (1, 2048, 640, 1728)
        return {'x': _w((lambda *s: torch.randn(*s, dtype=torch.bfloat16) * 0.1)(B, S, D)), 'w1': _w((lambda *s: torch.randn(*s, dtype=torch.bfloat16) * 0.4)(D, F) * (2.0 / D) ** 0.5), 'w3': _w((lambda *s: torch.randn(*s, dtype=torch.bfloat16) * 0.4)(D, F) * (2.0 / D) ** 0.5), 'w2': _w((lambda *s: torch.randn(*s, dtype=torch.bfloat16) * 0.4)(F, D) * (2.0 / F) ** 0.5)}
    _B_in = _B_setup()
    return {'A_x': _A_in['x'], 'A_mem0': _A_in['mem0'], 'A_Wq': _A_in['Wq'], 'A_Wk': _A_in['Wk'], 'A_Wv': _A_in['Wv'], 'A_Wo': _A_in['Wo'], 'A_seg_len': _A_in['seg_len'], 'B_x': _B_in['x'], 'B_w1': _B_in['w1'], 'B_w3': _B_in['w3'], 'B_w2': _B_in['w2']}

def reference(A_x, A_mem0, A_Wq, A_Wk, A_Wv, A_Wo, A_seg_len, B_x, B_w1, B_w3, B_w2):

    def _A_ref(x, mem0, Wq, Wk, Wv, Wo, seg_len):
        B, S, Dm = x.shape
        H, Dh = (Wq.shape[1], Wq.shape[2])
        M = mem0.shape[1]
        scale = Dh ** (-0.5)
        n_seg = S // seg_len
        L = M + seg_len
        idx = torch.arange(L)
        mask = (idx[:, None] < M) | (idx[:, None] >= idx[None, :])
        mem = mem0
        outs = []
        for s in range(n_seg):
            xs = x[:, s * seg_len:(s + 1) * seg_len, :].clone()
            h = torch.concatenate([mem, xs], axis=1)
            q = torch.einsum('btd,dhe->bhte', h, Wq)
            k = torch.einsum('btd,dhe->bhte', h, Wk)
            v = torch.einsum('btd,dhe->bhte', h, Wv)
            scores = torch.einsum('bhqe,bhke->bhqk', q, k) * scale
            scores = torch.where(mask[None, None], scores, -1000000000.0)
            p = _softmax(scores, axis=-1)
            o = torch.einsum('bhqk,bhke->bhqe', p, v)
            o = torch.einsum('bhte,hed->btd', o, Wo)
            mem = o[:, :M, :].clone()
            outs.append(o[:, M:, :])
        return torch.concatenate(outs, axis=1)

    def _B_ref(x, w1, w3, w2):
        gate = torch.einsum('bsd,df->bsf', x, w1)
        up = torch.einsum('bsd,df->bsf', x, w3)
        h = _silu(gate) * up
        out = torch.einsum('bsf,fd->bsd', h, w2)
        return out
    x = A_x
    xn = _layernorm(x, axis=-1)
    s = _A_ref(xn, A_mem0, A_Wq, A_Wk, A_Wv, A_Wo, A_seg_len)
    g = _silu(_B_ref(xn, B_w1, B_w3, B_w2))
    return x + s * g
```

```asm
; @launch grid=(256,1,1) block=(256,1,1) lds=163840
.amdgcn_target "amdgcn-amd-amdhsa--gfx950"
.text
.globl recurrent_scan__memory_aug_recurrent_mem_tr__glu_gated_swiglu__prompt_kernel
.p2align 8
.type recurrent_scan__memory_aug_recurrent_mem_tr__glu_gated_swiglu__prompt_kernel,@function
recurrent_scan__memory_aug_recurrent_mem_tr__glu_gated_swiglu__prompt_kernel:
    s_cmp_ge_u32 s2, 256
    s_cbranch_scc0 k_go
    s_endpgm
k_go:
    s_getreg_b32 s3, hwreg(HW_REG_XCC_ID, 0, 3)
    s_mov_b32 s93, s2
    s_sub_u32 s99, s3, s2
    s_and_b32 s99, s99, 7
    s_or_b32 s99, s99, 0x100
    s_cmp_lg_u32 s2, 0
    s_cbranch_scc1 k_role
    s_load_dwordx2 s[4:5], s[0:1], 96
    s_mov_b32 s6, s99
    s_waitcnt lgkmcnt(0)
    s_atomic_or s6, s[4:5], 200
k_role:
    s_add_u32 s3, s93, s99
    s_and_b32 s3, s3, 7
    s_andn2_b32 s2, s93, 7
    s_or_b32 s2, s2, s3
    s_and_b32 s3, s2, 4
    s_cbranch_scc0 chain_go
    s_branch bulk_entry
chain_go:
    s_getpc_b64 s[64:65]
    s_lshr_b32 s3, s2, 3
    s_mul_i32 s3, s3, 1024
    v_lshlrev_b32 v250, 7, v0
    v_add_u32 v250, s3, v250
    v_cmp_gt_u32 vcc, 8, v0
    s_and_saveexec_b64 s[66:67], vcc
    s_cbranch_execz cpf_1
    global_load_dword v251, v250, s[64:65]
cpf_1:
    s_mov_b64 exec, s[66:67]
    s_load_dwordx4 s[16:19], s[0:1], 16
    s_load_dwordx4 s[20:23], s[0:1], 32
    s_load_dwordx4 s[24:27], s[0:1], 96
    s_load_dwordx2 s[72:73], s[0:1], 8
    v_lshrrev_b32 v235, 6, v0
    v_and_b32 v232, 63, v0
    v_readfirstlane_b32 s30, v235
    v_bfe_u32 v233, v0, 4, 2
    v_and_b32 v234, 15, v0
    s_and_b32 s31, s2, 3
    s_lshr_b32 s32, s2, 3
    s_lshr_b32 s33, s32, 2
    s_lshl_b32 s3, s31, 3
    s_add_u32 s33, s33, s3
    s_and_b32 s34, s32, 3
    s_and_b32 s28, s34, 1
    s_mov_b32 s36, 0x400000
    v_mov_b32 v236, s34
    v_mov_b32 v237, s33
    v_mov_b32 v238, s32
    v_mov_b32 v239, s31
    v_mov_b32 v240, v0
    v_lshlrev_b32 v192, 0x4, v232
    v_mov_b32 v15, v192
    v_lshrrev_b32 v192, 0x2, v232
    v_lshlrev_b32 v193, 0xd, v192
    v_lshrrev_b32 v194, 0x1, v232
    v_and_b32 v195, 0x1, v194
    v_lshrrev_b32 v196, 0x5, v232
    v_and_b32 v197, 0x1, v196
    v_xor_b32 v198, v197, v195
    v_lshlrev_b32 v199, 0x5, v198
    v_add_u32 v200, v199, v193
    v_and_b32 v201, 0x1, v232
    v_lshlrev_b32 v202, 0x4, v201
    v_add_u32 v203, v202, v200
    v_lshlrev_b32 v204, 0x8, v237
    v_add_u32 v205, v204, v203
    v_lshlrev_b32 v206, 0x6, v236
    v_add_u32 v207, v206, v205
    v_mov_b32 v172, v207
    s_waitcnt lgkmcnt(0)
    s_mov_b32 s4, s26
    s_and_b32 s5, s27, 0xffff
    s_mov_b32 s6, 0x10000000
    s_mov_b32 s7, 0x00020000
    s_lshl_b32 s3, s31, 5
    s_add_u32 s3, s3, s32
    s_lshl_b32 s60, s30, 7
    s_add_u32 s3, s3, s60
    s_cmp_ge_u32 s3, 22
    s_cbranch_scc1 cal_done
    s_sub_u32 s60, 0, s26
    s_and_b32 s60, s60, 0x1fffff
    s_lshl_b32 s61, s32, 21
    s_add_u32 s60, s60, s61
    s_add_u32 s60, s60, 10452992
    s_add_u32 s70, s26, s60
    s_addc_u32 s71, s27, 0
    s_mov_b32 s62, -1
    s_mov_b32 s63, -1
    s_mov_b32 s61, 0
    s_memtime s[64:65]
    s_waitcnt lgkmcnt(0)
    s_atomic_or s61, s[70:71], 0 glc
    s_waitcnt lgkmcnt(0)
    s_memtime s[66:67]
    s_waitcnt lgkmcnt(0)
    s_sub_u32 s64, s66, s64
    s_min_u32 s62, s62, s64
    s_mov_b32 s61, 0
    s_memtime s[64:65]
    s_waitcnt lgkmcnt(0)
    s_atomic_or s61, s[70:71], 8192 glc
    s_waitcnt lgkmcnt(0)
    s_memtime s[66:67]
    s_waitcnt lgkmcnt(0)
    s_sub_u32 s64, s66, s64
    s_min_u32 s63, s63, s64
    s_mov_b32 s61, 0
    s_memtime s[64:65]
    s_waitcnt lgkmcnt(0)
    s_atomic_or s61, s[70:71], 4096 glc
    s_waitcnt lgkmcnt(0)
    s_memtime s[66:67]
    s_waitcnt lgkmcnt(0)
    s_sub_u32 s64, s66, s64
    s_min_u32 s62, s62, s64
    s_mov_b32 s61, 0
    s_memtime s[64:65]
    s_waitcnt lgkmcnt(0)
    s_atomic_or s61, s[70:71], 12288 glc
    s_waitcnt lgkmcnt(0)
    s_memtime s[66:67]
    s_waitcnt lgkmcnt(0)
    s_sub_u32 s64, s66, s64
    s_min_u32 s63, s63, s64
    s_mov_b32 s61, 0
    s_memtime s[64:65]
    s_waitcnt lgkmcnt(0)
    s_atomic_or s61, s[70:71], 0 glc
    s_waitcnt lgkmcnt(0)
    s_memtime s[66:67]
    s_waitcnt lgkmcnt(0)
    s_sub_u32 s64, s66, s64
    s_min_u32 s62, s62, s64
    s_mov_b32 s61, 0
    s_memtime s[64:65]
    s_waitcnt lgkmcnt(0)
    s_atomic_or s61, s[70:71], 8192 glc
    s_waitcnt lgkmcnt(0)
    s_memtime s[66:67]
    s_waitcnt lgkmcnt(0)
    s_sub_u32 s64, s66, s64
    s_min_u32 s63, s63, s64
    s_mov_b32 s61, 0
    s_memtime s[64:65]
    s_waitcnt lgkmcnt(0)
    s_atomic_or s61, s[70:71], 4096 glc
    s_waitcnt lgkmcnt(0)
    s_memtime s[66:67]
    s_waitcnt lgkmcnt(0)
    s_sub_u32 s64, s66, s64
    s_min_u32 s62, s62, s64
    s_mov_b32 s61, 0
    s_memtime s[64:65]
    s_waitcnt lgkmcnt(0)
    s_atomic_or s61, s[70:71], 12288 glc
    s_waitcnt lgkmcnt(0)
    s_memtime s[66:67]
    s_waitcnt lgkmcnt(0)
    s_sub_u32 s64, s66, s64
    s_min_u32 s63, s63, s64
    s_mov_b32 s61, 0
    s_memtime s[64:65]
    s_waitcnt lgkmcnt(0)
    s_atomic_or s61, s[70:71], 0 glc
    s_waitcnt lgkmcnt(0)
    s_memtime s[66:67]
    s_waitcnt lgkmcnt(0)
    s_sub_u32 s64, s66, s64
    s_min_u32 s62, s62, s64
    s_mov_b32 s61, 0
    s_memtime s[64:65]
    s_waitcnt lgkmcnt(0)
    s_atomic_or s61, s[70:71], 8192 glc
    s_waitcnt lgkmcnt(0)
    s_memtime s[66:67]
    s_waitcnt lgkmcnt(0)
    s_sub_u32 s64, s66, s64
    s_min_u32 s63, s63, s64
    s_mov_b32 s61, 0
    s_memtime s[64:65]
    s_waitcnt lgkmcnt(0)
    s_atomic_or s61, s[70:71], 4096 glc
    s_waitcnt lgkmcnt(0)
    s_memtime s[66:67]
    s_waitcnt lgkmcnt(0)
    s_sub_u32 s64, s66, s64
    s_min_u32 s62, s62, s64
    s_mov_b32 s61, 0
    s_memtime s[64:65]
    s_waitcnt lgkmcnt(0)
    s_atomic_or s61, s[70:71], 12288 glc
    s_waitcnt lgkmcnt(0)
    s_memtime s[66:67]
    s_waitcnt lgkmcnt(0)
    s_sub_u32 s64, s66, s64
    s_min_u32 s63, s63, s64
    s_mov_b32 s61, 0
    s_memtime s[64:65]
    s_waitcnt lgkmcnt(0)
    s_atomic_or s61, s[70:71], 0 glc
    s_waitcnt lgkmcnt(0)
    s_memtime s[66:67]
    s_waitcnt lgkmcnt(0)
    s_sub_u32 s64, s66, s64
    s_min_u32 s62, s62, s64
    s_mov_b32 s61, 0
    s_memtime s[64:65]
    s_waitcnt lgkmcnt(0)
    s_atomic_or s61, s[70:71], 8192 glc
    s_waitcnt lgkmcnt(0)
    s_memtime s[66:67]
    s_waitcnt lgkmcnt(0)
    s_sub_u32 s64, s66, s64
    s_min_u32 s63, s63, s64
    s_cmp_lt_u32 s63, s62
    s_cselect_b32 s61, 1, 0
    s_lshl_b32 s61, s61, s32
    s_load_dword s60, s[24:25], 200
    s_waitcnt lgkmcnt(0)
    s_cmp_lg_u32 s60, 0
    s_cbranch_scc1 ro_3
rp_2:
    s_load_dword s60, s[24:25], 200 glc
    s_waitcnt lgkmcnt(0)
    s_cmp_lg_u32 s60, 0
    s_cbranch_scc1 ro_3
    s_sleep 16
    s_sub_u32 s36, s36, 1
    s_cbranch_scc0 rp_2
    s_branch chain_abort10
ro_3:
    s_cmp_lg_u32 s60, s99
    s_cbranch_scc1 cal_done
    s_atomic_or s61, s[24:25], 72 glc
    s_waitcnt lgkmcnt(0)
    s_mov_b32 s61, 1
    s_atomic_add s61, s[24:25], 64 glc
    s_waitcnt lgkmcnt(0)
    s_cmp_lg_u32 s61, 85
    s_cbranch_scc1 cal_done
    s_mov_b32 s61, 0
    s_atomic_or s61, s[24:25], 72 glc
    s_waitcnt lgkmcnt(0)
    s_or_b32 s61, s61, 0x80000000
    s_atomic_or s61, s[24:25], 192
    s_waitcnt lgkmcnt(0)
cal_done:
    v_xor_b32 v192, 0x0, v172
    v_mov_b32 v177, v192
    s_mov_b32 s8, s16
    s_and_b32 s9, s17, 0xffff
    s_mov_b32 s10, 0x500000
    s_mov_b32 s11, 0x00020000
    s_mov_b32 s56, s18
    s_and_b32 s57, s19, 0xffff
    s_mov_b32 s58, 0x500000
    s_mov_b32 s59, 0x00020000
    s_mov_b32 s60, s20
    s_and_b32 s61, s21, 0xffff
    s_mov_b32 s62, 0x500000
    s_mov_b32 s63, 0x00020000
    s_mov_b32 s64, s22
    s_and_b32 s65, s23, 0xffff
    s_mov_b32 s66, 0x500000
    s_mov_b32 s67, 0x00020000
    s_lshl_b32 s70, s30, 10
    s_mul_i32 s71, s30, 131072
    s_mul_i32 s74, s33, 163840
    s_mul_i32 s3, s34, 320
    s_add_u32 s74, s74, s3
    s_add_u32 m0, s70, 40960
    s_add_u32 s3, s71, 0
    buffer_load_dwordx4 v172, s[8:11], s3 offen lds
    s_add_u32 m0, s70, 45056
    s_add_u32 s3, s71, 524288
    buffer_load_dwordx4 v172, s[8:11], s3 offen lds
    s_add_u32 m0, s70, 49152
    s_add_u32 s3, s71, 1048576
    buffer_load_dwordx4 v172, s[8:11], s3 offen lds
    s_add_u32 m0, s70, 53248
    s_add_u32 s3, s71, 1572864
    buffer_load_dwordx4 v172, s[8:11], s3 offen lds
    s_add_u32 m0, s70, 57344
    s_add_u32 s3, s71, 2097152
    buffer_load_dwordx4 v172, s[8:11], s3 offen lds
    s_add_u32 m0, s70, 61440
    s_add_u32 s3, s71, 2621440
    buffer_load_dwordx4 v172, s[8:11], s3 offen lds
    s_add_u32 m0, s70, 65536
    s_add_u32 s3, s71, 3145728
    buffer_load_dwordx4 v172, s[8:11], s3 offen lds
    s_add_u32 m0, s70, 69632
    s_add_u32 s3, s71, 3670016
    buffer_load_dwordx4 v172, s[8:11], s3 offen lds
    s_add_u32 m0, s70, 73728
    s_add_u32 s3, s71, 4194304
    buffer_load_dwordx4 v172, s[8:11], s3 offen lds
    s_add_u32 m0, s70, 77824
    s_add_u32 s3, s71, 4718592
    buffer_load_dwordx4 v172, s[8:11], s3 offen lds
    s_add_u32 m0, s70, 81920
    s_add_u32 s3, s71, 0
    buffer_load_dwordx4 v177, s[56:59], s3 offen lds
    s_add_u32 m0, s70, 86016
    s_add_u32 s3, s71, 524288
    buffer_load_dwordx4 v177, s[56:59], s3 offen lds
    s_add_u32 m0, s70, 90112
    s_add_u32 s3, s71, 1048576
    buffer_load_dwordx4 v177, s[56:59], s3 offen lds
    s_add_u32 m0, s70, 94208
    s_add_u32 s3, s71, 1572864
    buffer_load_dwordx4 v177, s[56:59], s3 offen lds
    s_add_u32 m0, s70, 98304
    s_add_u32 s3, s71, 2097152
    buffer_load_dwordx4 v177, s[56:59], s3 offen lds
    s_add_u32 m0, s70, 102400
    s_add_u32 s3, s71, 2621440
    buffer_load_dwordx4 v177, s[56:59], s3 offen lds
    s_add_u32 m0, s70, 106496
    s_add_u32 s3, s71, 3145728
    buffer_load_dwordx4 v177, s[56:59], s3 offen lds
    s_add_u32 m0, s70, 110592
    s_add_u32 s3, s71, 3670016
    buffer_load_dwordx4 v177, s[56:59], s3 offen lds
    s_add_u32 m0, s70, 114688
    s_add_u32 s3, s71, 4194304
    buffer_load_dwordx4 v177, s[56:59], s3 offen lds
    s_add_u32 m0, s70, 118784
    s_add_u32 s3, s71, 4718592
    buffer_load_dwordx4 v177, s[56:59], s3 offen lds
    s_add_u32 m0, s70, 122880
    s_add_u32 s3, s71, 0
    buffer_load_dwordx4 v172, s[60:63], s3 offen lds
    s_add_u32 m0, s70, 126976
    s_add_u32 s3, s71, 524288
    buffer_load_dwordx4 v172, s[60:63], s3 offen lds
    s_add_u32 m0, s70, 131072
    s_add_u32 s3, s71, 1048576
    buffer_load_dwordx4 v172, s[60:63], s3 offen lds
    s_add_u32 m0, s70, 135168
    s_add_u32 s3, s71, 1572864
    buffer_load_dwordx4 v172, s[60:63], s3 offen lds
    s_add_u32 m0, s70, 139264
    s_add_u32 s3, s71, 2097152
    buffer_load_dwordx4 v172, s[60:63], s3 offen lds
    s_add_u32 m0, s70, 143360
    s_add_u32 s3, s71, 2621440
    buffer_load_dwordx4 v172, s[60:63], s3 offen lds
    s_add_u32 m0, s70, 147456
    s_add_u32 s3, s71, 3145728
    buffer_load_dwordx4 v172, s[60:63], s3 offen lds
    s_add_u32 m0, s70, 151552
    s_add_u32 s3, s71, 3670016
    buffer_load_dwordx4 v172, s[60:63], s3 offen lds
    s_add_u32 m0, s70, 155648
    s_add_u32 s3, s71, 4194304
    buffer_load_dwordx4 v172, s[60:63], s3 offen lds
    s_add_u32 m0, s70, 159744
    s_add_u32 s3, s71, 4718592
    buffer_load_dwordx4 v172, s[60:63], s3 offen lds
    v_mul_u32_u24 v192, 0xccd, v240
    v_lshrrev_b32 v193, 0x10, v192
    v_mul_u32_u24 v194, 0x500, v193
    v_mul_u32_u24 v195, 0x14, v193
    v_subrev_u32 v196, v195, v240
    v_lshlrev_b32 v197, 0x4, v196
    v_add_u32 v198, v197, v194
    v_mov_b32 v30, v198
    s_add_u32 m0, s70, 0
    s_nop 0
    buffer_load_dwordx4 v30, s[64:67], s74 offen lds
    v_add_u32 v192, 0x100, v240
    v_mul_u32_u24 v193, 0xccd, v192
    v_lshrrev_b32 v194, 0x10, v193
    v_mul_u32_u24 v195, 0x500, v194
    v_mul_u32_u24 v196, 0x14, v194
    v_subrev_u32 v197, v196, v192
    v_lshlrev_b32 v198, 0x4, v197
    v_add_u32 v199, v198, v195
    v_mov_b32 v30, v199
    s_add_u32 m0, s70, 4096
    s_nop 0
    buffer_load_dwordx4 v30, s[64:67], s74 offen lds
    v_add_u32 v192, 0x200, v240
    v_mul_u32_u24 v193, 0xccd, v192
    v_lshrrev_b32 v194, 0x10, v193
    v_mul_u32_u24 v195, 0x500, v194
    v_mul_u32_u24 v196, 0x14, v194
    v_subrev_u32 v197, v196, v192
    v_lshlrev_b32 v198, 0x4, v197
    v_add_u32 v199, v198, v195
    v_mov_b32 v30, v199
    s_add_u32 m0, s70, 8192
    s_nop 0
    buffer_load_dwordx4 v30, s[64:67], s74 offen lds
    v_add_u32 v192, 0x300, v240
    v_mul_u32_u24 v193, 0xccd, v192
    v_lshrrev_b32 v194, 0x10, v193
    v_mul_u32_u24 v195, 0x500, v194
    v_mul_u32_u24 v196, 0x14, v194
    v_subrev_u32 v197, v196, v192
    v_lshlrev_b32 v198, 0x4, v197
    v_add_u32 v199, v198, v195
    v_mov_b32 v30, v199
    s_add_u32 m0, s70, 12288
    s_nop 0
    buffer_load_dwordx4 v30, s[64:67], s74 offen lds
    v_add_u32 v192, 0x400, v240
    v_mul_u32_u24 v193, 0xccd, v192
    v_lshrrev_b32 v194, 0x10, v193
    v_mul_u32_u24 v195, 0x500, v194
    v_mul_u32_u24 v196, 0x14, v194
    v_subrev_u32 v197, v196, v192
    v_lshlrev_b32 v198, 0x4, v197
    v_add_u32 v199, v198, v195
    v_mov_b32 v30, v199
    s_add_u32 m0, s70, 16384
    s_nop 0
    buffer_load_dwordx4 v30, s[64:67], s74 offen lds
    v_add_u32 v192, 0x500, v240
    v_mul_u32_u24 v193, 0xccd, v192
    v_lshrrev_b32 v194, 0x10, v193
    v_mul_u32_u24 v195, 0x500, v194
    v_mul_u32_u24 v196, 0x14, v194
    v_subrev_u32 v197, v196, v192
    v_lshlrev_b32 v198, 0x4, v197
    v_add_u32 v199, v198, v195
    v_mov_b32 v30, v199
    s_add_u32 m0, s70, 20480
    s_nop 0
    buffer_load_dwordx4 v30, s[64:67], s74 offen lds
    v_add_u32 v192, 0x600, v240
    v_mul_u32_u24 v193, 0xccd, v192
    v_lshrrev_b32 v194, 0x10, v193
    v_mul_u32_u24 v195, 0x500, v194
    v_mul_u32_u24 v196, 0x14, v194
    v_subrev_u32 v197, v196, v192
    v_lshlrev_b32 v198, 0x4, v197
    v_add_u32 v199, v198, v195
    v_mov_b32 v30, v199
    s_add_u32 m0, s70, 24576
    s_nop 0
    buffer_load_dwordx4 v30, s[64:67], s74 offen lds
    v_add_u32 v192, 0x700, v240
    v_mul_u32_u24 v193, 0xccd, v192
    v_lshrrev_b32 v194, 0x10, v193
    v_mul_u32_u24 v195, 0x500, v194
    v_mul_u32_u24 v196, 0x14, v194
    v_subrev_u32 v197, v196, v192
    v_lshlrev_b32 v198, 0x4, v197
    v_add_u32 v199, v198, v195
    v_mov_b32 v30, v199
    s_add_u32 m0, s70, 28672
    s_nop 0
    buffer_load_dwordx4 v30, s[64:67], s74 offen lds
    v_add_u32 v192, 0x800, v240
    v_mul_u32_u24 v193, 0xccd, v192
    v_lshrrev_b32 v194, 0x10, v193
    v_mul_u32_u24 v195, 0x500, v194
    v_mul_u32_u24 v196, 0x14, v194
    v_subrev_u32 v197, v196, v192
    v_lshlrev_b32 v198, 0x4, v197
    v_add_u32 v199, v198, v195
    v_mov_b32 v30, v199
    s_add_u32 m0, s70, 32768
    s_nop 0
    buffer_load_dwordx4 v30, s[64:67], s74 offen lds
    v_add_u32 v192, 0x900, v240
    v_mul_u32_u24 v193, 0xccd, v192
    v_lshrrev_b32 v194, 0x10, v193
    v_mul_u32_u24 v195, 0x500, v194
    v_mul_u32_u24 v196, 0x14, v194
    v_subrev_u32 v197, v196, v192
    v_lshlrev_b32 v198, 0x4, v197
    v_add_u32 v199, v198, v195
    v_mov_b32 v30, v199
    s_add_u32 m0, s70, 36864
    s_nop 0
    buffer_load_dwordx4 v30, s[64:67], s74 offen lds
    s_load_dword s60, s[24:25], 200
    s_waitcnt lgkmcnt(0)
    s_cmp_lg_u32 s60, 0
    s_cbranch_scc1 ro_5
rp_4:
    s_load_dword s60, s[24:25], 200 glc
    s_waitcnt lgkmcnt(0)
    s_cmp_lg_u32 s60, 0
    s_cbranch_scc1 ro_5
    s_sleep 16
    s_sub_u32 s36, s36, 1
    s_cbranch_scc0 rp_4
    s_branch chain_abort10
ro_5:
    s_cmp_eq_u32 s60, s99
    s_cbranch_scc1 rv_6
    s_mov_b32 s99, s60
    s_waitcnt vmcnt(0)
    s_barrier
    s_branch k_role
rv_6:
    v_mov_b32 v188, 0xffffffff
    v_mov_b32 v189, 0xffffffff
    v_mov_b32 v190, 0xffffffff
    v_mov_b32 v191, 0xffffffff
    s_mov_b32 s8, s72
    s_and_b32 s9, s73, 0xffff
    s_mov_b32 s10, 0x2800
    s_mov_b32 s11, 0x00020000
    v_mul_u32_u24 v192, 0x14, v238
    v_add_u32 v193, v240, v192
    v_and_b32 v194, 0x7, v193
    v_mul_u32_u24 v195, 0x500, v194
    v_mul_u32_u24 v196, 0x14, v238
    v_add_u32 v197, v240, v196
    v_lshrrev_b32 v198, 0x3, v197
    v_lshlrev_b32 v199, 0x4, v198
    v_add_u32 v200, v199, v195
    v_cmp_gt_u32 vcc, 20, v240
    v_mov_b32 v201, 0x40000000
    s_nop 1
    v_cndmask_b32 v202, v201, v200, vcc
    v_mov_b32 v32, v202
    buffer_load_dwordx4 v[144:147], v32, s[8:11], 0 offen
    v_lshlrev_b32 v192, 0x5, v239
    v_add_u32 v193, v238, v192
    v_mul_u32_u24 v194, 0x5000, v193
    v_lshlrev_b32 v195, 0x4, v240
    v_add_u32 v196, v195, v194
    v_add_u32 v197, 0x30a000, v196
    v_mov_b32 v31, v197
    s_mov_b32 s6, 0x568000
    buffer_store_dwordx4 v[188:191], v31, s[4:7], 0 offen sc1
    v_add_u32 v31, 4096, v31
    buffer_store_dwordx4 v[188:191], v31, s[4:7], 0 offen sc1
    v_add_u32 v31, 4096, v31
    buffer_store_dwordx4 v[188:191], v31, s[4:7], 0 offen sc1
    v_add_u32 v31, 4096, v31
    buffer_store_dwordx4 v[188:191], v31, s[4:7], 0 offen sc1
    v_add_u32 v31, 4096, v31
    buffer_store_dwordx4 v[188:191], v31, s[4:7], 0 offen sc1
    v_add_u32 v31, 4096, v31
    s_mov_b32 s6, 0x10000000
    s_sub_u32 s60, 0, s26
    s_and_b32 s60, s60, 0x1fffff
    s_add_u32 s60, s60, 8388608
    v_lshlrev_b32 v192, 0x5, v239
    v_add_u32 v193, v238, v192
    v_lshlrev_b32 v194, 0x5, v239
    v_add_u32 v195, v238, v194
    v_lshlrev_b32 v196, 0xe, v195
    v_lshlrev_b32 v197, 0x4, v240
    v_add_u32 v198, v197, v196
    v_cmp_gt_u32 vcc, 120, v193
    v_mov_b32 v199, 0x40000000
    s_nop 1
    v_cndmask_b32 v200, v199, v198, vcc
    v_mov_b32 v31, v200
    buffer_store_dwordx4 v[188:191], v31, s[4:7], s60 offen sc1
    s_add_u32 s60, s60, 4096
    buffer_store_dwordx4 v[188:191], v31, s[4:7], s60 offen sc1
    s_add_u32 s60, s60, 4096
    buffer_store_dwordx4 v[188:191], v31, s[4:7], s60 offen sc1
    s_add_u32 s60, s60, 4096
    buffer_store_dwordx4 v[188:191], v31, s[4:7], s60 offen sc1
    s_add_u32 s60, s60, 4096
    v_mul_u32_u24 v192, 0x14, v238
    v_add_u32 v193, v240, v192
    v_lshlrev_b32 v194, 0x4, v193
    v_mul_u32_u24 v195, 0x2800, v239
    v_add_u32 v196, v195, v194
    v_add_u32 v197, 0x300000, v196
    v_cmp_gt_u32 vcc, 20, v240
    v_mov_b32 v198, 0x40000000
    s_nop 1
    v_cndmask_b32 v199, v198, v197, vcc
    v_mov_b32 v148, v199
    v_mov_b32 v19, 0xfffffffe
    v_mov_b32 v30, 0x3f803f80
    v_accvgpr_write_b32 a244, v30
    v_accvgpr_write_b32 a245, v30
    v_accvgpr_write_b32 a246, v30
    v_accvgpr_write_b32 a247, v30
    v_cmp_gt_u32 vcc, 2, v233
    v_mov_b32 v192, 0x3f803f80
    v_mov_b32 v193, 0x0
    s_nop 1
    v_cndmask_b32 v194, v193, v192, vcc
    v_mov_b32 v30, v194
    v_accvgpr_write_b32 a252, v30
    v_accvgpr_write_b32 a253, v30
    v_lshlrev_b32 v192, 0x3, v233
    v_and_b32 v193, 0x7, v234
    v_add_u32 v194, v193, v192
    v_lshlrev_b32 v195, 0x4, v194
    v_lshrrev_b32 v196, 0x3, v234
    v_lshlrev_b32 v197, 0x9, v196
    v_add_u32 v198, v197, v195
    v_mov_b32 v3, v198
    v_mul_u32_u24 v192, 0xc00, v235
    v_lshlrev_b32 v193, 0xb, v235
    v_add_u32 v194, 0x800, v193
    v_cmp_gt_u32 vcc, 2, v235
    s_nop 1
    v_cndmask_b32 v195, v194, v192, vcc
    v_add_u32 v196, v3, v195
    v_mov_b32 v2, v196
    v_lshlrev_b32 v192, 0x3, v233
    v_and_b32 v193, 0x7, v234
    v_add_u32 v194, v193, v192
    v_lshlrev_b32 v195, 0x4, v194
    v_add_u32 v196, 0x3000, v195
    v_mov_b32 v9, v196
    v_cmp_gt_u32 vcc, 8, v234
    v_mov_b32 v192, 0x2800
    v_mov_b32 v193, 0x5800
    s_nop 1
    v_cndmask_b32 v194, v193, v192, vcc
    v_lshlrev_b32 v195, 0x3, v233
    v_and_b32 v196, 0x7, v234
    v_add_u32 v197, v196, v195
    v_lshlrev_b32 v198, 0x4, v197
    v_add_u32 v199, v198, v194
    v_mov_b32 v8, v199
    v_and_b32 v192, 0x2, v236
    v_and_b32 v193, 0x1, v235
    v_add_u32 v194, v193, v192
    v_lshlrev_b32 v195, 0xa, v194
    v_lshrrev_b32 v196, 0x1, v235
    v_lshlrev_b32 v197, 0x9, v196
    v_add_u32 v198, v197, v195
    v_lshlrev_b32 v199, 0x3, v233
    v_and_b32 v200, 0x7, v234
    v_add_u32 v201, v200, v199
    v_lshlrev_b32 v202, 0x4, v201
    v_add_u32 v203, v202, v198
    v_and_b32 v204, 0x1, v236
    v_lshlrev_b32 v205, 0x3, v204
    v_add_u32 v206, v205, v203
    v_cmp_gt_u32 vcc, 8, v234
    v_mov_b32 v207, 0x40000000
    s_nop 1
    v_cndmask_b32 v208, v207, v206, vcc
    v_mov_b32 v4, v208
    v_lshrrev_b32 v192, 0x1, v233
    v_lshrrev_b32 v193, 0x1, v235
    v_lshlrev_b32 v194, 0xa, v236
    v_add_u32 v195, v15, v194
    v_and_b32 v196, 0x1, v235
    v_lshlrev_b32 v197, 0x3, v196
    v_add_u32 v198, v197, v195
    v_add_u32 v199, 0x1000, v198
    v_cmp_eq_u32 vcc, v192, v193
    v_mov_b32 v200, 0x40000000
    s_nop 1
    v_cndmask_b32 v201, v200, v199, vcc
    v_mov_b32 v5, v201
    v_lshlrev_b32 v192, 0xa, v235
    v_add_u32 v193, v15, v192
    v_add_u32 v194, 0x1000, v193
    v_mov_b32 v10, v194
    v_lshlrev_b32 v192, 0xa, v235
    v_add_u32 v193, v15, v192
    v_mov_b32 v6, v193
    v_lshlrev_b32 v192, 0xa, v235
    v_add_u32 v193, v15, v192
    v_add_u32 v194, 0x3800, v193
    v_mov_b32 v11, v194
    v_cmp_gt_u32 vcc, 2, v233
    v_mov_b32 v192, 0x2800
    v_mov_b32 v193, 0x2e00
    s_nop 1
    v_cndmask_b32 v194, v193, v192, vcc
    v_lshlrev_b32 v195, 0x9, v235
    v_add_u32 v196, v195, v194
    v_add_u32 v197, v15, v196
    v_mov_b32 v7, v197
    v_mul_u32_u24 v192, 0x14, v236
    v_lshlrev_b32 v193, 0x2, v235
    v_add_u32 v194, v193, v192
    v_lshrrev_b32 v195, 0x1, v234
    v_add_u32 v196, v195, v194
    v_lshlrev_b32 v197, 0xc, v196
    v_and_b32 v198, 0x1, v234
    v_lshlrev_b32 v199, 0x2, v198
    v_add_u32 v200, v233, v199
    v_lshlrev_b32 v201, 0x4, v200
    v_add_u32 v202, v201, v197
    v_mov_b32 v30, v202
    v_mul_u32_u24 v192, 0x14, v236
    v_add_u32 v193, 0x10, v192
    v_lshlrev_b32 v194, 0x1, v235
    v_add_u32 v195, v194, v193
    v_lshrrev_b32 v196, 0x2, v234
    v_and_b32 v197, 0x1, v196
    v_add_u32 v198, v197, v195
    v_lshlrev_b32 v199, 0xc, v198
    v_lshrrev_b32 v200, 0x1, v234
    v_and_b32 v201, 0x1, v200
    v_lshlrev_b32 v202, 0x2, v201
    v_add_u32 v203, v233, v202
    v_lshlrev_b32 v204, 0x4, v203
    v_add_u32 v205, v204, v199
    v_mov_b32 v31, v205
    v_and_b32 v192, 0x1, v234
    v_and_b32 v193, 0x2, v235
    v_add_u32 v194, v193, v192
    v_cmp_eq_u32 vcc, 0, v194
    v_mov_b32 v195, 0x40000000
    s_nop 1
    v_cndmask_b32 v196, v195, v31, vcc
    v_mov_b32 v31, v196
    v_cmp_gt_u32 vcc, 8, v234
    s_nop 1
    v_cndmask_b32 v192, v31, v30, vcc
    v_lshlrev_b32 v193, 0x7, v237
    v_add_u32 v194, v193, v192
    v_mov_b32 v12, v194
    v_lshrrev_b32 v192, 0xd, v12
    v_lshlrev_b32 v193, 0xe, v192
    v_and_b32 v194, 0x1fff, v12
    v_add_u32 v195, v194, v193
    v_cmp_gt_u32 vcc, 1073741824, v12
    v_mov_b32 v196, 0x40000000
    s_nop 1
    v_cndmask_b32 v197, v196, v195, vcc
    v_mov_b32 v13, v197
    v_lshrrev_b32 v192, 0x1, v236
    v_lshlrev_b32 v193, 0x7, v192
    v_lshlrev_b32 v194, 0x2, v237
    v_add_u32 v195, v194, v193
    v_add_u32 v196, v235, v195
    v_lshlrev_b32 v197, 0xa, v196
    v_and_b32 v198, 0x1, v236
    v_lshlrev_b32 v199, 0x7, v198
    v_add_u32 v200, v199, v197
    v_add_u32 v201, v15, v200
    v_subrev_u32 v202, 0x80, v201
    v_cmp_gt_u32 vcc, 8, v234
    v_mov_b32 v203, 0x40000000
    s_nop 1
    v_cndmask_b32 v204, v202, v203, vcc
    v_mov_b32 v14, v204
    v_mul_u32_u24 v192, 0x3, v238
    v_and_b32 v193, 0x1, v235
    v_cmp_gt_u32 vcc, 2, v235
    v_mov_b32 v194, 0x2
    s_nop 1
    v_cndmask_b32 v195, v193, v194, vcc
    v_add_u32 v196, v195, v192
    v_lshlrev_b32 v197, 0x1, v238
    v_add_u32 v198, 0x10, v197
    v_and_b32 v199, 0x1, v235
    v_add_u32 v200, v199, v198
    v_cmp_gt_u32 vcc, 16, v238
    s_nop 1
    v_cndmask_b32 v201, v200, v196, vcc
    v_mov_b32 v30, v201
    v_mul_u32_u24 v192, 0x14, v236
    v_lshrrev_b32 v193, 0x3, v232
    v_add_u32 v194, v193, v192
    v_lshlrev_b32 v195, 0xc, v194
    v_lshlrev_b32 v196, 0x7, v237
    v_add_u32 v197, v196, v195
    v_and_b32 v198, 0x7, v232
    v_lshlrev_b32 v199, 0x4, v198
    v_add_u32 v200, v199, v197
    v_lshrrev_b32 v201, 0x1, v30
    v_lshlrev_b32 v202, 0xe, v201
    v_and_b32 v203, 0x1, v30
    v_lshlrev_b32 v204, 0xc, v203
    v_add_u32 v205, v204, v202
    v_add_u32 v206, v15, v205
    v_add_u32 v207, 0x1, v239
    v_and_b32 v208, 0x3, v207
    v_lshlrev_b32 v209, 0xa, v208
    v_add_u32 v210, v209, v206
    v_cmp_eq_u32 vcc, 0, v235
    s_nop 1
    v_cndmask_b32 v211, v210, v200, vcc
    v_mov_b32 v21, v211
    v_cmp_gt_u32 vcc, 32, v232
    v_mov_b32 v192, 0x40000000
    s_nop 1
    v_cndmask_b32 v193, v192, v21, vcc
    v_lshrrev_b32 v194, 0x1, v30
    v_lshlrev_b32 v195, 0xe, v194
    v_and_b32 v196, 0x1, v30
    v_lshlrev_b32 v197, 0xc, v196
    v_add_u32 v198, v197, v195
    v_add_u32 v199, v15, v198
    v_add_u32 v200, 0x2, v239
    v_and_b32 v201, 0x3, v200
    v_lshlrev_b32 v202, 0xa, v201
    v_add_u32 v203, v202, v199
    v_cmp_eq_u32 vcc, 0, v235
    s_nop 1
    v_cndmask_b32 v204, v203, v193, vcc
    v_mov_b32 v22, v204
    v_lshlrev_b32 v192, 0xb, v236
    v_add_u32 v193, v15, v192
    v_lshrrev_b32 v194, 0x1, v30
    v_lshlrev_b32 v195, 0xe, v194
    v_and_b32 v196, 0x1, v30
    v_lshlrev_b32 v197, 0xc, v196
    v_add_u32 v198, v197, v195
    v_add_u32 v199, v15, v198
    v_add_u32 v200, 0x3, v239
    v_and_b32 v201, 0x3, v200
    v_lshlrev_b32 v202, 0xa, v201
    v_add_u32 v203, v202, v199
    v_cmp_eq_u32 vcc, 0, v235
    s_nop 1
    v_cndmask_b32 v204, v203, v193, vcc
    v_mov_b32 v23, v204
    v_mul_u32_u24 v192, 0x140, v238
    v_add_u32 v193, v15, v192
    v_cmp_gt_u32 vcc, 20, v232
    v_mov_b32 v194, 0x40000000
    s_nop 1
    v_cndmask_b32 v195, v194, v193, vcc
    v_lshlrev_b32 v196, 0xc, v30
    v_add_u32 v197, v15, v196
    v_add_u32 v198, 0x4, v239
    v_and_b32 v199, 0x3, v198
    v_lshlrev_b32 v200, 0xa, v199
    v_add_u32 v201, v200, v197
    v_cmp_eq_u32 vcc, 0, v235
    s_nop 1
    v_cndmask_b32 v202, v201, v195, vcc
    v_mov_b32 v24, v202
    v_lshlrev_b32 v192, 0xc, v236
    v_lshlrev_b32 v193, 0x7, v232
    v_add_u32 v194, v193, v192
    v_lshlrev_b32 v195, 0xb, v236
    v_lshlrev_b32 v196, 0x7, v232
    v_add_u32 v197, v196, v195
    v_add_u32 v198, 0x3000, v197
    v_cmp_gt_u32 vcc, 48, v232
    v_mov_b32 v199, 0x40000000
    s_nop 1
    v_cndmask_b32 v200, v199, v198, vcc
    v_cmp_gt_u32 vcc, 32, v232
    s_nop 1
    v_cndmask_b32 v201, v200, v194, vcc
    v_mov_b32 v25, v201
    v_add_u32 v192, v238, v232
    v_add_u32 v193, v239, v192
    v_cmp_eq_u32 vcc, 0, v193
    v_mov_b32 v194, 0x0
    v_mov_b32 v195, 0x40000000
    s_nop 1
    v_cndmask_b32 v196, v195, v194, vcc
    v_lshlrev_b32 v197, 0x4, v237
    v_and_b32 v198, 0x3, v232
    v_lshlrev_b32 v199, 0x2, v198
    v_add_u32 v200, v199, v197
    v_add_u32 v201, 0x569400, v200
    v_cmp_eq_u32 vcc, 0, v235
    s_nop 1
    v_cndmask_b32 v202, v201, v196, vcc
    v_mov_b32 v26, v202
    v_cmp_eq_u32 vcc, 0, v232
    v_mov_b32 v192, 0x0
    v_mov_b32 v193, 0x40000000
    s_nop 1
    v_cndmask_b32 v194, v193, v192, vcc
    v_mov_b32 v27, v194
    v_lshrrev_b32 v192, 0x1, v233
    v_add_u32 v193, v192, v30
    v_lshlrev_b32 v194, 0x3, v193
    v_and_b32 v195, 0x1, v233
    v_lshlrev_b32 v196, 0x2, v195
    v_add_u32 v197, v196, v194
    v_and_b32 v198, 0x7, v234
    v_lshrrev_b32 v199, 0x1, v198
    v_add_u32 v200, v199, v197
    v_mov_b32 v35, v200
    v_lshrrev_b32 v192, 0x3, v35
    v_mul_u32_u24 v193, 0xccd, v192
    v_lshrrev_b32 v194, 0x10, v193
    v_mov_b32 v31, v194
    v_lshrrev_b32 v192, 0x3, v35
    v_mul_u32_u24 v193, 0x14, v31
    v_subrev_u32 v194, v193, v192
    v_mov_b32 v32, v194
    v_mul_u32_u24 v192, 0x5, v31
    v_lshrrev_b32 v193, 0x2, v32
    v_add_u32 v194, v193, v192
    v_lshlrev_b32 v195, 0x9, v194
    v_lshrrev_b32 v196, 0x2, v35
    v_and_b32 v197, 0x1, v196
    v_lshlrev_b32 v198, 0x1, v197
    v_and_b32 v199, 0x1, v35
    v_add_u32 v200, v199, v198
    v_lshlrev_b32 v201, 0x3, v200
    v_and_b32 v202, 0x3, v32
    v_lshlrev_b32 v203, 0x1, v202
    v_add_u32 v204, v203, v201
    v_lshrrev_b32 v205, 0x1, v35
    v_and_b32 v206, 0x1, v205
    v_add_u32 v207, v206, v204
    v_lshlrev_b32 v208, 0x4, v207
    v_add_u32 v209, v208, v195
    v_mov_b32 v33, v209
    v_mul_u32_u24 v192, 0x5, v31
    v_add_u32 v193, 0x4, v192
    v_lshlrev_b32 v194, 0x9, v193
    v_and_b32 v195, 0x2, v32
    v_and_b32 v196, 0x1, v35
    v_add_u32 v197, v196, v195
    v_lshlrev_b32 v198, 0x3, v197
    v_and_b32 v199, 0x1, v32
    v_lshlrev_b32 v200, 0x2, v199
    v_add_u32 v201, v200, v198
    v_lshrrev_b32 v202, 0x1, v35
    v_and_b32 v203, 0x1, v202
    v_lshlrev_b32 v204, 0x1, v203
    v_add_u32 v205, v204, v201
    v_lshrrev_b32 v206, 0x2, v35
    v_and_b32 v207, 0x1, v206
    v_add_u32 v208, v207, v205
    v_lshlrev_b32 v209, 0x4, v208
    v_add_u32 v210, v209, v194
    v_mov_b32 v34, v210
    v_cmp_gt_u32 vcc, 16, v32
    s_nop 1
    v_cndmask_b32 v192, v34, v33, vcc
    v_mov_b32 v34, v192
    v_lshrrev_b32 v192, 0x3, v234
    v_lshrrev_b32 v193, 0x1, v233
    v_add_u32 v194, v193, v192
    v_and_b32 v195, 0x1, v234
    v_lshlrev_b32 v196, 0x3, v195
    v_add_u32 v197, v196, v34
    v_cmp_eq_u32 vcc, 0, v194
    v_mov_b32 v198, 0x40000000
    s_nop 1
    v_cndmask_b32 v199, v198, v197, vcc
    v_mov_b32 v29, v199
    v_lshrrev_b32 v192, 0x1, v234
    v_and_b32 v193, 0x1, v234
    v_cmp_eq_u32 vcc, 0, v193
    v_mov_b32 v194, 0x3f80
    v_mov_b32 v195, 0x3f800000
    s_nop 1
    v_cndmask_b32 v196, v195, v194, vcc
    v_cmp_eq_u32 vcc, 0, v192
    v_mov_b32 v197, 0x0
    s_nop 1
    v_cndmask_b32 v198, v197, v196, vcc
    v_mov_b32 v31, v198
    v_accvgpr_write_b32 a240, v31
    v_lshrrev_b32 v192, 0x1, v234
    v_and_b32 v193, 0x1, v234
    v_cmp_eq_u32 vcc, 0, v193
    v_mov_b32 v194, 0x3f80
    v_mov_b32 v195, 0x3f800000
    s_nop 1
    v_cndmask_b32 v196, v195, v194, vcc
    v_cmp_eq_u32 vcc, 1, v192
    v_mov_b32 v197, 0x0
    s_nop 1
    v_cndmask_b32 v198, v197, v196, vcc
    v_mov_b32 v31, v198
    v_accvgpr_write_b32 a241, v31
    v_lshrrev_b32 v192, 0x1, v234
    v_and_b32 v193, 0x1, v234
    v_cmp_eq_u32 vcc, 0, v193
    v_mov_b32 v194, 0x3f80
    v_mov_b32 v195, 0x3f800000
    s_nop 1
    v_cndmask_b32 v196, v195, v194, vcc
    v_cmp_eq_u32 vcc, 2, v192
    v_mov_b32 v197, 0x0
    s_nop 1
    v_cndmask_b32 v198, v197, v196, vcc
    v_mov_b32 v31, v198
    v_accvgpr_write_b32 a242, v31
    v_lshrrev_b32 v192, 0x1, v234
    v_and_b32 v193, 0x1, v234
    v_cmp_eq_u32 vcc, 0, v193
    v_mov_b32 v194, 0x3f80
    v_mov_b32 v195, 0x3f800000
    s_nop 1
    v_cndmask_b32 v196, v195, v194, vcc
    v_cmp_eq_u32 vcc, 3, v192
    v_mov_b32 v197, 0x0
    s_nop 1
    v_cndmask_b32 v198, v197, v196, vcc
    v_mov_b32 v31, v198
    v_accvgpr_write_b32 a243, v31
    v_lshlrev_b32 v192, 0x3, v236
    v_add_u32 v193, v234, v192
    v_subrev_u32 v194, 0x8, v193
    v_cmp_gt_u32 vcc, 8, v234
    v_mov_b32 v195, 0x3f
    s_nop 1
    v_cndmask_b32 v196, v194, v195, vcc
    v_mov_b32 v31, v196
    v_lshlrev_b32 v192, 0x2, v233
    v_cmp_gt_u32 vcc, v192, v31
    v_mov_b32 v193, 0xf149f2ca
    v_mov_b32 v194, 0x0
    s_nop 1
    v_cndmask_b32 v195, v194, v193, vcc
    v_mov_b32 v40, v195
    v_lshlrev_b32 v192, 0x2, v233
    v_add_u32 v193, 0x1, v192
    v_cmp_gt_u32 vcc, v193, v31
    v_mov_b32 v194, 0xf149f2ca
    v_mov_b32 v195, 0x0
    s_nop 1
    v_cndmask_b32 v196, v195, v194, vcc
    v_mov_b32 v41, v196
    v_lshlrev_b32 v192, 0x2, v233
    v_add_u32 v193, 0x2, v192
    v_cmp_gt_u32 vcc, v193, v31
    v_mov_b32 v194, 0xf149f2ca
    v_mov_b32 v195, 0x0
    s_nop 1
    v_cndmask_b32 v196, v195, v194, vcc
    v_mov_b32 v42, v196
    v_lshlrev_b32 v192, 0x2, v233
    v_add_u32 v193, 0x3, v192
    v_cmp_gt_u32 vcc, v193, v31
    v_mov_b32 v194, 0xf149f2ca
    v_mov_b32 v195, 0x0
    s_nop 1
    v_cndmask_b32 v196, v195, v194, vcc
    v_mov_b32 v43, v196
    v_lshlrev_b32 v192, 0x2, v233
    v_add_u32 v193, 0x10, v192
    v_cmp_gt_u32 vcc, v193, v31
    v_mov_b32 v194, 0xf149f2ca
    v_mov_b32 v195, 0x0
    s_nop 1
    v_cndmask_b32 v196, v195, v194, vcc
    v_mov_b32 v44, v196
    v_lshlrev_b32 v192, 0x2, v233
    v_add_u32 v193, 0x11, v192
    v_cmp_gt_u32 vcc, v193, v31
    v_mov_b32 v194, 0xf149f2ca
    v_mov_b32 v195, 0x0
    s_nop 1
    v_cndmask_b32 v196, v195, v194, vcc
    v_mov_b32 v45, v196
    v_lshlrev_b32 v192, 0x2, v233
    v_add_u32 v193, 0x12, v192
    v_cmp_gt_u32 vcc, v193, v31
    v_mov_b32 v194, 0xf149f2ca
    v_mov_b32 v195, 0x0
    s_nop 1
    v_cndmask_b32 v196, v195, v194, vcc
    v_mov_b32 v46, v196
    v_lshlrev_b32 v192, 0x2, v233
    v_add_u32 v193, 0x13, v192
    v_cmp_gt_u32 vcc, v193, v31
    v_mov_b32 v194, 0xf149f2ca
    v_mov_b32 v195, 0x0
    s_nop 1
    v_cndmask_b32 v196, v195, v194, vcc
    v_mov_b32 v47, v196
    v_lshlrev_b32 v192, 0x9, v233
    v_lshrrev_b32 v193, 0x2, v232
    v_and_b32 v194, 0x3, v193
    v_lshlrev_b32 v195, 0x6, v194
    v_add_u32 v196, v195, v192
    v_and_b32 v197, 0x1, v235
    v_and_b32 v198, 0x1, v233
    v_xor_b32 v199, v198, v197
    v_lshlrev_b32 v200, 0x5, v199
    v_add_u32 v201, v200, v196
    v_and_b32 v202, 0x3, v232
    v_lshlrev_b32 v203, 0x3, v202
    v_add_u32 v204, v203, v201
    v_lshrrev_b32 v205, 0x1, v235
    v_mul_u32_u24 v206, 0xa000, v205
    v_add_u32 v207, v206, v204
    v_add_u32 v208, 0xa000, v207
    v_mov_b32 v173, v208
    v_lshlrev_b32 v192, 0x9, v233
    v_lshrrev_b32 v193, 0x2, v232
    v_and_b32 v194, 0x3, v193
    v_lshlrev_b32 v195, 0x6, v194
    v_add_u32 v196, v195, v192
    v_and_b32 v197, 0x1, v235
    v_and_b32 v198, 0x1, v233
    v_xor_b32 v199, v198, v197
    v_lshlrev_b32 v200, 0x5, v199
    v_add_u32 v201, v200, v196
    v_and_b32 v202, 0x3, v232
    v_lshlrev_b32 v203, 0x3, v202
    v_add_u32 v204, v203, v201
    v_add_u32 v205, 0x1e000, v204
    v_mov_b32 v174, v205
    v_lshlrev_b32 v192, 0x2, v233
    v_lshrrev_b32 v193, 0x2, v232
    v_and_b32 v194, 0x3, v193
    v_add_u32 v195, v194, v192
    v_mul_u32_u24 v196, 0x140, v195
    v_and_b32 v197, 0x3, v232
    v_lshlrev_b32 v198, 0x3, v197
    v_add_u32 v199, v198, v196
    v_lshlrev_b32 v200, 0x6, v235
    v_add_u32 v201, v200, v199
    v_mov_b32 v175, v201
    v_lshlrev_b32 v192, 0x2, v233
    v_lshrrev_b32 v193, 0x2, v232
    v_and_b32 v194, 0x3, v193
    v_add_u32 v195, v194, v192
    v_mul_u32_u24 v196, 0x140, v195
    v_and_b32 v197, 0x3, v232
    v_lshlrev_b32 v198, 0x3, v197
    v_add_u32 v199, v198, v196
    v_and_b32 v200, 0x1, v235
    v_lshlrev_b32 v201, 0x5, v200
    v_add_u32 v202, v201, v199
    v_add_u32 v203, 0x100, v202
    v_mov_b32 v176, v203
    v_cmp_eq_u32 vcc, 0, v240
    v_mov_b32 v192, 0x0
    v_mov_b32 v193, 0x40000000
    s_nop 1
    v_cndmask_b32 v194, v193, v192, vcc
    v_mov_b32 v165, v194
    v_and_b32 v192, 0x1f, v232
    v_lshlrev_b32 v193, 0x2, v192
    v_mov_b32 v166, v193
    v_lshlrev_b32 v192, 0x2, v232
    v_cmp_gt_u32 vcc, 16, v232
    v_mov_b32 v193, 0x40000000
    s_nop 1
    v_cndmask_b32 v194, v193, v192, vcc
    v_mov_b32 v0, v194
    s_mov_b32 s48, 110624768
    s_cmp_lt_u32 s32, 16
    s_cselect_b32 s49, 3, 2
    s_mov_b32 s12, 0x3e0293ee
    s_mov_b32 s13, 0x3e0293ee
    s_mul_i32 s50, s31, 10240
    s_add_u32 s50, s50, 3145728
    s_lshl_b32 s51, s33, 13
    s_add_u32 s51, s51, 3309568
    s_mul_i32 s54, s33, 24576
    s_add_u32 s54, s54, 58720256
    s_lshl_b32 s75, s31, 5
    s_add_u32 s75, s75, s32
    s_lshl_b32 s52, s75, 2
    s_add_u32 s52, s52, s30
    s_lshl_b32 s52, s52, 12
    s_add_u32 s52, s52, 0xf000000
    s_lshl_b32 s14, s30, 11
    s_lshl_b32 s15, s34, 11
    s_add_u32 s15, s15, s54
    s_add_u32 s15, s15, 16384
    s_add_u32 s45, s54, s14
    s_mov_b32 s89, 0x3e000000
    s_add_u32 s88, s54, 786432
    s_waitcnt vmcnt(0)
    v_min_u32 v144, -2, v144
    v_min_u32 v145, -2, v145
    v_min_u32 v146, -2, v146
    v_min_u32 v147, -2, v147
    buffer_store_dwordx4 v[144:147], v148, s[4:7], 0 offen sc1
    s_barrier
    ds_read_b64_tr_b16 a[0:1], v173 offset:0
    ds_read_b64_tr_b16 a[2:3], v173 offset:256
    ds_read_b64_tr_b16 a[4:5], v173 offset:2048
    ds_read_b64_tr_b16 a[6:7], v173 offset:2304
    ds_read_b64_tr_b16 a[8:9], v173 offset:4096
    ds_read_b64_tr_b16 a[10:11], v173 offset:4352
    ds_read_b64_tr_b16 a[12:13], v173 offset:6144
    ds_read_b64_tr_b16 a[14:15], v173 offset:6400
    s_waitcnt lgkmcnt(4)
    ds_read_b64_tr_b16 a[16:17], v173 offset:8192
    ds_read_b64_tr_b16 a[18:19], v173 offset:8448
    ds_read_b64_tr_b16 a[20:21], v173 offset:10240
    ds_read_b64_tr_b16 a[22:23], v173 offset:10496
    ds_read_b64_tr_b16 a[24:25], v173 offset:12288
    ds_read_b64_tr_b16 a[26:27], v173 offset:12544
    ds_read_b64_tr_b16 a[28:29], v173 offset:14336
    ds_read_b64_tr_b16 a[30:31], v173 offset:14592
    s_waitcnt lgkmcnt(4)
    ds_read_b64_tr_b16 a[32:33], v173 offset:16384
    ds_read_b64_tr_b16 a[34:35], v173 offset:16640
    ds_read_b64_tr_b16 a[36:37], v173 offset:18432
    ds_read_b64_tr_b16 a[38:39], v173 offset:18688
    ds_read_b64_tr_b16 a[40:41], v173 offset:20480
    ds_read_b64_tr_b16 a[42:43], v173 offset:20736
    ds_read_b64_tr_b16 a[44:45], v173 offset:22528
    ds_read_b64_tr_b16 a[46:47], v173 offset:22784
    s_waitcnt lgkmcnt(4)
    ds_read_b64_tr_b16 a[48:49], v173 offset:24576
    ds_read_b64_tr_b16 a[50:51], v173 offset:24832
    ds_read_b64_tr_b16 a[52:53], v173 offset:26624
    ds_read_b64_tr_b16 a[54:55], v173 offset:26880
    ds_read_b64_tr_b16 a[56:57], v173 offset:28672
    ds_read_b64_tr_b16 a[58:59], v173 offset:28928
    ds_read_b64_tr_b16 a[60:61], v173 offset:30720
    ds_read_b64_tr_b16 a[62:63], v173 offset:30976
    s_waitcnt lgkmcnt(4)
    ds_read_b64_tr_b16 a[64:65], v173 offset:32768
    ds_read_b64_tr_b16 a[66:67], v173 offset:33024
    ds_read_b64_tr_b16 a[68:69], v173 offset:34816
    ds_read_b64_tr_b16 a[70:71], v173 offset:35072
    ds_read_b64_tr_b16 a[72:73], v173 offset:36864
    ds_read_b64_tr_b16 a[74:75], v173 offset:37120
    ds_read_b64_tr_b16 a[76:77], v173 offset:38912
    ds_read_b64_tr_b16 a[78:79], v173 offset:39168
    s_waitcnt lgkmcnt(4)
    s_cmp_ge_u32 s30, 2
    s_cbranch_scc1 v_odd
    ds_read_b64_tr_b16 a[80:81], v174 offset:0
    ds_read_b64_tr_b16 a[82:83], v174 offset:256
    ds_read_b64_tr_b16 a[84:85], v174 offset:4096
    ds_read_b64_tr_b16 a[86:87], v174 offset:4352
    ds_read_b64_tr_b16 a[88:89], v174 offset:8192
    ds_read_b64_tr_b16 a[90:91], v174 offset:8448
    ds_read_b64_tr_b16 a[92:93], v174 offset:12288
    ds_read_b64_tr_b16 a[94:95], v174 offset:12544
    s_waitcnt lgkmcnt(4)
    ds_read_b64_tr_b16 a[96:97], v174 offset:16384
    ds_read_b64_tr_b16 a[98:99], v174 offset:16640
    ds_read_b64_tr_b16 a[100:101], v174 offset:20480
    ds_read_b64_tr_b16 a[102:103], v174 offset:20736
    ds_read_b64_tr_b16 a[104:105], v174 offset:24576
    ds_read_b64_tr_b16 a[106:107], v174 offset:24832
    ds_read_b64_tr_b16 a[108:109], v174 offset:28672
    ds_read_b64_tr_b16 a[110:111], v174 offset:28928
    s_waitcnt lgkmcnt(4)
    ds_read_b64_tr_b16 a[112:113], v174 offset:32768
    ds_read_b64_tr_b16 a[114:115], v174 offset:33024
    ds_read_b64_tr_b16 a[116:117], v174 offset:36864
    ds_read_b64_tr_b16 a[118:119], v174 offset:37120
    s_branch v_done
v_odd:
    ds_read_b64_tr_b16 a[80:81], v174 offset:2048
    ds_read_b64_tr_b16 a[82:83], v174 offset:2304
    ds_read_b64_tr_b16 a[84:85], v174 offset:6144
    ds_read_b64_tr_b16 a[86:87], v174 offset:6400
    ds_read_b64_tr_b16 a[88:89], v174 offset:10240
    ds_read_b64_tr_b16 a[90:91], v174 offset:10496
    ds_read_b64_tr_b16 a[92:93], v174 offset:14336
    ds_read_b64_tr_b16 a[94:95], v174 offset:14592
    s_waitcnt lgkmcnt(4)
    ds_read_b64_tr_b16 a[96:97], v174 offset:18432
    ds_read_b64_tr_b16 a[98:99], v174 offset:18688
    ds_read_b64_tr_b16 a[100:101], v174 offset:22528
    ds_read_b64_tr_b16 a[102:103], v174 offset:22784
    ds_read_b64_tr_b16 a[104:105], v174 offset:26624
    ds_read_b64_tr_b16 a[106:107], v174 offset:26880
    ds_read_b64_tr_b16 a[108:109], v174 offset:30720
    ds_read_b64_tr_b16 a[110:111], v174 offset:30976
    s_waitcnt lgkmcnt(4)
    ds_read_b64_tr_b16 a[112:113], v174 offset:34816
    ds_read_b64_tr_b16 a[114:115], v174 offset:35072
    ds_read_b64_tr_b16 a[116:117], v174 offset:38912
    ds_read_b64_tr_b16 a[118:119], v174 offset:39168
v_done:
    ds_read_b64_tr_b16 v[56:57], v175 offset:0
    ds_read_b64_tr_b16 v[58:59], v175 offset:5120
    ds_read_b64_tr_b16 v[60:61], v175 offset:10240
    ds_read_b64_tr_b16 v[62:63], v175 offset:15360
    ds_read_b64_tr_b16 v[64:65], v175 offset:20480
    ds_read_b64_tr_b16 v[66:67], v175 offset:25600
    ds_read_b64_tr_b16 v[68:69], v175 offset:30720
    ds_read_b64_tr_b16 v[70:71], v175 offset:35840
    s_waitcnt lgkmcnt(0)
    ds_read_b64_tr_b16 v[72:73], v175 offset:32
    ds_read_b64_tr_b16 v[74:75], v175 offset:5152
    ds_read_b64_tr_b16 v[76:77], v175 offset:10272
    ds_read_b64_tr_b16 v[78:79], v175 offset:15392
    ds_read_b64_tr_b16 v[80:81], v175 offset:20512
    ds_read_b64_tr_b16 v[82:83], v175 offset:25632
    ds_read_b64_tr_b16 v[84:85], v175 offset:30752
    ds_read_b64_tr_b16 v[86:87], v175 offset:35872
    s_waitcnt lgkmcnt(0)
    ds_read_b64_tr_b16 v[88:89], v176 offset:0
    ds_read_b64_tr_b16 v[90:91], v176 offset:5120
    ds_read_b64_tr_b16 v[92:93], v176 offset:10240
    ds_read_b64_tr_b16 v[94:95], v176 offset:15360
    ds_read_b64_tr_b16 v[96:97], v176 offset:20480
    ds_read_b64_tr_b16 v[98:99], v176 offset:25600
    ds_read_b64_tr_b16 v[100:101], v176 offset:30720
    ds_read_b64_tr_b16 v[102:103], v176 offset:35840
    s_waitcnt lgkmcnt(0)
    s_mov_b32 s8, s24
    s_and_b32 s9, s25, 0xffff
    s_mov_b32 s10, 0x100
    s_mov_b32 s11, 0x00020000
ws_7:
    v_mov_b32 v30, 0
    buffer_load_dword v30, v30, s[8:11], 0 offen offset:192 sc1
    s_waitcnt vmcnt(0)
    v_readfirstlane_b32 s74, v30
    s_cmp_lt_i32 s74, 0
    s_cbranch_scc1 start_ok
    s_sleep 4
    s_sub_u32 s36, s36, 1
    s_cbranch_scc0 ws_7
    s_branch chain_abort10
start_ok:
    v_mul_u32_u24 v192, 0x5556, v232
    v_lshrrev_b32 v193, 0x10, v192
    v_mov_b32 v31, v193
    v_mov_b32 v1, s74
    v_lshrrev_b32 v1, v31, v1
    v_lshlrev_b32 v192, 0x15, v31
    v_mul_u32_u24 v193, 0x3, v31
    v_subrev_u32 v194, v193, v232
    v_mul_u32_u24 v195, 0xa0000, v194
    v_add_u32 v196, v195, v192
    v_and_b32 v197, 0x1, v1
    v_lshlrev_b32 v198, 0xd, v197
    v_add_u32 v199, v198, v196
    v_mov_b32 v1, v199
    s_sub_u32 s3, 0, s26
    s_and_b32 s3, s3, 0x1fffff
    s_add_u32 s3, s3, 8388608
    v_add_u32 v1, s3, v1
    s_getreg_b32 s74, hwreg(HW_REG_XCC_ID, 0, 4)
    s_lshl_b32 s3, s75, 2
    s_add_u32 s3, s3, 5668864
    v_mov_b32 v31, s74
    buffer_store_dword v31, v165, s[4:7], s3 offen sc1
    s_cmp_lg_u32 s30, 1
    s_cbranch_scc1 qp0_ok
    s_mov_b32 s47, 1
qp0:
    buffer_load_dword v30, v26, s[4:7], 0 offen sc1
    s_waitcnt vmcnt(0)
    v_min_i32_dpp v30, v30, v30 row_ror:2 row_mask:0xf bank_mask:0xf
    s_nop 1
    v_readfirstlane_b32 s29, v30
    s_cmp_ge_i32 s29, s47
    s_cbranch_scc1 qp0_ok
    s_sub_u32 s36, s36, 1
    s_cbranch_scc0 qp0
    s_mov_b32 s46, 9
    s_branch chain_abort
qp0_ok:
    s_barrier
    s_mov_b32 s29, 0
    s_mov_b32 s90, 2
    s_mov_b32 s91, 5671936
    s_lshl_b32 s3, s31, 7
    s_add_u32 s3, s3, 5668864
    s_mov_b32 s60, 5668864
    v_lshrrev_b32 v32, 1, v15
tab_poll:
    buffer_load_dwordx2 v[34:35], v32, s[4:7], s60 offen sc1
    buffer_load_dword v30, v166, s[4:7], s3 offen sc1
    s_waitcnt vmcnt(0)
    v_max3_u32 v33, v34, v35, v30
    v_cmp_eq_u32 vcc, -1, v33
    s_cbranch_vccz tab_ok
    s_sub_u32 s36, s36, 1
    s_cbranch_scc0 tab_poll
    s_mov_b32 s46, 5
    s_branch chain_abort
tab_ok:
    v_cmp_ne_u32 s[68:69], v31, v30
    s_mov_b32 s35, 0
    s_add_u32 m0, s14, 24576
    s_add_u32 s42, s45, 8192
    buffer_load_dwordx4 v15, s[4:7], s45 offen sc1 lds
    buffer_load_dwordx4 v15, s[4:7], s45 offen offset:1024 sc1 lds
    buffer_load_dwordx4 v[136:139], v15, s[4:7], s42 offen sc1
    buffer_load_dwordx4 v[140:143], v15, s[4:7], s42 offen offset:1024 sc1
    s_add_u32 s45, s45, 786432
    s_cmp_lg_u32 s30, 1
    s_cbranch_scc1 no_q0
    s_mov_b32 m0, 22528
    s_nop 0
    buffer_load_dwordx4 v15, s[4:7], s15 offen sc1 lds
    buffer_load_dwordx4 v15, s[4:7], s15 offen offset:1024 sc1 lds
    s_add_u32 s15, s15, 786432
    buffer_load_dword v20, v25, s[4:7], s88 offen sc1
    s_add_u32 s88, s88, 786432
no_q0:
    s_add_u32 s46, s35, 0
    s_and_b32 s47, s46, 63
    s_and_b32 s46, s46, 3
    s_mul_i32 s38, s46, 40960
    s_add_u32 s38, s38, s50
    v_readlane_b32 s40, v1, s47
    s_mul_i32 s44, s46, 327680
    s_add_u32 s44, s44, 4358144
    s_mul_i32 s39, s46, 262144
    s_add_u32 s39, s39, s51
    s_add_u32 s46, s46, 1
    s_and_b32 s46, s46, 3
    s_mul_i32 s41, s46, 40960
    s_add_u32 s41, s41, s50
    v_readlane_b32 s37, v1, 4
    s_xor_b32 s37, s37, 8192
    s_mov_b32 s16, 0
    s_mov_b32 s17, 0
    s_mov_b32 s18, 0
    s_mov_b32 s19, 0
    s_mov_b32 s20, 0
    s_cmp_lg_u64 s[68:69], 0
    s_cbranch_scc1 disp_s
    s_cmp_eq_u32 s30, 0
    s_cbranch_scc1 j_fD
    s_cmp_eq_u32 s30, 2
    s_cbranch_scc1 j_fB
    s_cmp_eq_u32 s30, 3
    s_cbranch_scc1 j_fC
    s_cmp_eq_u32 s49, 3
    s_cbranch_scc1 j_fE
    s_branch entry_fA
j_fB:
    s_branch entry_fB
j_fD:
    s_branch entry_fD
j_fE:
    s_branch entry_fE
j_fC:
    s_branch entry_fC
disp_s:
    s_cmp_eq_u32 s30, 0
    s_cbranch_scc1 j_sD
    s_cmp_eq_u32 s30, 2
    s_cbranch_scc1 j_sB
    s_cmp_eq_u32 s30, 3
    s_cbranch_scc1 j_sC
    s_cmp_eq_u32 s49, 3
    s_cbranch_scc1 j_sE
    s_branch entry_sA
j_sB:
    s_branch entry_sB
j_sD:
    s_branch entry_sD
j_sE:
    s_branch entry_sE
j_sC:
    s_branch entry_sC
entry_fD:
    buffer_load_dwordx4 v[224:227], v2, s[4:7], s38 offen offset:0 sc1
    buffer_load_dwordx4 v[228:231], v2, s[4:7], s38 offen offset:1024 sc1
    buffer_load_dwordx4 v[232:235], v2, s[4:7], s38 offen offset:2048 sc1
    s_waitcnt vmcnt(0)
    buffer_load_dwordx4 v[236:239], v2, s[4:7], s38 offen offset:0 sc1
    buffer_load_dwordx4 v[240:243], v2, s[4:7], s38 offen offset:1024 sc1
    buffer_load_dwordx4 v[244:247], v2, s[4:7], s38 offen offset:2048 sc1
    s_branch loop_fD
.p2align 6
loop_fD:
    s_waitcnt vmcnt(5)
    ds_write_b128 v2, v[224:227] offset:0
    v_max3_u32 v30, v224, v225, v226
    v_max_u32 v30, v30, v227
    s_waitcnt vmcnt(4)
    ds_write_b128 v2, v[228:231] offset:1024
    v_max3_u32 v30, v30, v228, v229
    v_max3_u32 v30, v30, v230, v231
    s_waitcnt vmcnt(3)
    ds_write_b128 v2, v[232:235] offset:2048
    v_max3_u32 v30, v30, v232, v233
    v_max3_u32 v30, v30, v234, v235
    v_cmp_eq_u32 vcc, -1, v30
    s_waitcnt lgkmcnt(0)
    s_cbranch_vccnz x3s_fD
x3ok_fD:
    s_barrier
    ds_read_b128 v[192:195], v3 offset:0
    ds_read_b128 v[196:199], v3 offset:1024
    ds_read_b128 v[200:203], v3 offset:2048
    ds_read_b128 v[204:207], v3 offset:3072
    ds_read_b128 v[208:211], v3 offset:4096
    ds_read_b128 v[212:215], v3 offset:5120
    ds_read_b128 v[216:219], v3 offset:6144
    ds_read_b128 v[220:223], v3 offset:7168
    ds_read_b128 v[144:147], v3 offset:8192
    ds_read_b128 v[148:151], v3 offset:9216
p2c_fD:
    s_waitcnt lgkmcnt(9)
    v_mfma_f32_16x16x32_bf16 v[156:159], a[0:3], v[192:195], 0
    v_mfma_f32_16x16x32_bf16 v[160:163], a[4:7], v[192:195], 0
    s_waitcnt lgkmcnt(8)
    v_mfma_f32_16x16x32_bf16 v[156:159], a[8:11], v[196:199], v[156:159]
    v_mfma_f32_16x16x32_bf16 v[160:163], a[12:15], v[196:199], v[160:163]
    s_waitcnt lgkmcnt(7)
    v_mfma_f32_16x16x32_bf16 v[156:159], a[16:19], v[200:203], v[156:159]
    v_mfma_f32_16x16x32_bf16 v[160:163], a[20:23], v[200:203], v[160:163]
    s_waitcnt lgkmcnt(6)
    v_mfma_f32_16x16x32_bf16 v[156:159], a[24:27], v[204:207], v[156:159]
    v_mfma_f32_16x16x32_bf16 v[160:163], a[28:31], v[204:207], v[160:163]
    s_waitcnt lgkmcnt(5)
    v_mfma_f32_16x16x32_bf16 v[156:159], a[32:35], v[208:211], v[156:159]
    v_mfma_f32_16x16x32_bf16 v[160:163], a[36:39], v[208:211], v[160:163]
    s_waitcnt lgkmcnt(4)
    v_mfma_f32_16x16x32_bf16 v[156:159], a[40:43], v[212:215], v[156:159]
    v_mfma_f32_16x16x32_bf16 v[160:163], a[44:47], v[212:215], v[160:163]
    s_waitcnt lgkmcnt(3)
    v_mfma_f32_16x16x32_bf16 v[156:159], a[48:51], v[216:219], v[156:159]
    v_mfma_f32_16x16x32_bf16 v[160:163], a[52:55], v[216:219], v[160:163]
    s_waitcnt lgkmcnt(2)
    v_mfma_f32_16x16x32_bf16 v[156:159], a[56:59], v[220:223], v[156:159]
    v_mfma_f32_16x16x32_bf16 v[160:163], a[60:63], v[220:223], v[160:163]
    s_waitcnt lgkmcnt(1)
    v_mfma_f32_16x16x32_bf16 v[156:159], a[64:67], v[144:147], v[156:159]
    v_mfma_f32_16x16x32_bf16 v[160:163], a[68:71], v[144:147], v[160:163]
    s_waitcnt lgkmcnt(0)
    v_mfma_f32_16x16x32_bf16 v[156:159], a[72:75], v[148:151], v[156:159]
    v_mfma_f32_16x16x32_bf16 v[160:163], a[76:79], v[148:151], v[160:163]
    v_mfma_f32_16x16x32_bf16 v[52:55], v[192:195], a[80:83], 0
    v_mfma_f32_16x16x32_bf16 v[52:55], v[196:199], a[84:87], v[52:55]
    v_mfma_f32_16x16x32_bf16 v[52:55], v[200:203], a[88:91], v[52:55]
    v_add_f32_dpp v156, v160, v156 row_ror:8 row_mask:0xf bank_mask:0xf
    v_add_f32_dpp v157, v161, v157 row_ror:8 row_mask:0xf bank_mask:0xf
    v_add_f32_dpp v158, v162, v158 row_ror:8 row_mask:0xf bank_mask:0xf
    v_add_f32_dpp v159, v163, v159 row_ror:8 row_mask:0xf bank_mask:0xf
    v_pk_mul_f32 v[156:157], v[156:157], s[12:13]
    v_pk_mul_f32 v[158:159], v[158:159], s[12:13]
    v_cvt_pk_bf16_f32 v30, v156, v157
    v_cvt_pk_bf16_f32 v31, v158, v159
    v_min_u32 v30, -2, v30
    v_min_u32 v31, -2, v31
    buffer_store_dwordx2 v[30:31], v4, s[4:7], s39 offen
    v_mfma_f32_16x16x32_bf16 v[52:55], v[204:207], a[92:95], v[52:55]
    v_mfma_f32_16x16x32_bf16 v[52:55], v[208:211], a[96:99], v[52:55]
    v_mfma_f32_16x16x32_bf16 v[52:55], v[212:215], a[100:103], v[52:55]
    v_mfma_f32_16x16x32_bf16 v[52:55], v[216:219], a[104:107], v[52:55]
    v_mfma_f32_16x16x32_bf16 v[52:55], v[220:223], a[108:111], v[52:55]
    buffer_load_dwordx4 v[248:251], v6, s[4:7], s39 offen sc1
    v_mfma_f32_16x16x32_bf16 v[52:55], v[144:147], a[112:115], v[52:55]
    v_mfma_f32_16x16x32_bf16 v[52:55], v[148:151], a[116:119], v[52:55]
    ds_read_b128 v[104:107], v15 offset:24576
    ds_read_b128 v[108:111], v15 offset:25600
    ds_read_b128 v[112:115], v15 offset:26624
    ds_read_b128 v[116:119], v15 offset:27648
    ds_read_b128 v[120:123], v15 offset:28672
    ds_read_b128 v[124:127], v15 offset:29696
    ds_read_b128 v[128:131], v15 offset:30720
    ds_read_b128 v[132:135], v15 offset:31744
    v_cvt_pk_bf16_f32 v32, v52, v53
    v_cvt_pk_bf16_f32 v33, v54, v55
    v_min_u32 v32, -2, v32
    v_min_u32 v33, -2, v33
    buffer_store_dwordx2 v[32:33], v5, s[4:7], s39 offen
    buffer_load_dwordx4 v[252:255], v6, s[4:7], s39 offen sc1
    s_waitcnt vmcnt(2)
    ds_write_b128 v7, v[248:251]
    v_max3_u32 v30, v248, v249, v250
    v_max_u32 v30, v30, v251
    v_cmp_eq_u32 vcc, -1, v30
    s_waitcnt lgkmcnt(0)
    s_cbranch_vccnz qks_fD
qkok_fD:
    buffer_load_dwordx4 v[168:171], v10, s[4:7], s39 offen sc1
    s_barrier
    ds_read_b128 v[192:195], v8 offset:0
    ds_read_b128 v[196:199], v8 offset:512
    ds_read_b128 v[200:203], v8 offset:1024
    ds_read_b128 v[204:207], v8 offset:1536
    ds_read_b128 v[208:211], v9 offset:0
    ds_read_b128 v[212:215], v9 offset:512
    ds_read_b128 v[216:219], v9 offset:1024
    ds_read_b128 v[220:223], v9 offset:1536
    s_waitcnt lgkmcnt(7)
    v_mfma_f32_16x16x32_bf16 v[144:147], v[104:107], v[192:195], v[40:43]
    s_waitcnt lgkmcnt(6)
    v_mfma_f32_16x16x32_bf16 v[144:147], v[108:111], v[196:199], v[144:147]
    s_waitcnt lgkmcnt(5)
    v_mfma_f32_16x16x32_bf16 v[144:147], v[112:115], v[200:203], v[144:147]
    s_waitcnt lgkmcnt(4)
    v_mfma_f32_16x16x32_bf16 v[144:147], v[116:119], v[204:207], v[144:147]
    s_waitcnt lgkmcnt(3)
    v_mfma_f32_16x16x32_bf16 v[152:155], v[208:211], v[192:195], 0
    s_waitcnt lgkmcnt(2)
    v_mfma_f32_16x16x32_bf16 v[152:155], v[212:215], v[196:199], v[152:155]
    s_waitcnt lgkmcnt(1)
    v_mfma_f32_16x16x32_bf16 v[152:155], v[216:219], v[200:203], v[152:155]
    v_exp_f32 v144, v144
    s_waitcnt lgkmcnt(0)
    v_mfma_f32_16x16x32_bf16 v[152:155], v[220:223], v[204:207], v[152:155]
    v_exp_f32 v145, v145
    v_mfma_f32_16x16x32_bf16 v[148:151], v[120:123], v[192:195], v[44:47]
    v_exp_f32 v146, v146
    v_mfma_f32_16x16x32_bf16 v[148:151], v[124:127], v[196:199], v[148:151]
    v_exp_f32 v147, v147
    v_mfma_f32_16x16x32_bf16 v[148:151], v[128:131], v[200:203], v[148:151]
    v_exp_f32 v152, v152
    v_mfma_f32_16x16x32_bf16 v[148:151], v[132:135], v[204:207], v[148:151]
    v_exp_f32 v153, v153
    v_exp_f32 v154, v154
    v_exp_f32 v155, v155
    s_waitcnt vmcnt(0)
    v_max3_u32 v32, v168, v169, v170
    v_max_u32 v32, v32, v171
    v_cmp_eq_u32 vcc, -1, v32
    v_cvt_pk_bf16_f32 v36, v152, v153
    v_cvt_pk_bf16_f32 v37, v154, v155
    v_exp_f32 v148, v148
    s_cbranch_vccnz pvs_fD
pvok_fD:
    v_mfma_f32_16x16x16_bf16 v[156:159], v[168:169], v[36:37], 0
    v_exp_f32 v149, v149
    buffer_load_dword v18, v27, s[4:7], s37 offen sc1
    v_mfma_f32_16x16x16_bf16 v[160:163], v[170:171], v[36:37], 0
    v_exp_f32 v150, v150
    v_mfma_f32_16x16x16_bf16 v[48:51], a[252:253], v[36:37], 0
    v_exp_f32 v151, v151
    v_cvt_pk_bf16_f32 v164, v144, v145
    v_cvt_pk_bf16_f32 v165, v146, v147
    v_cvt_pk_bf16_f32 v166, v148, v149
    v_cvt_pk_bf16_f32 v167, v150, v151
    s_nop 1
    v_mfma_f32_16x16x32_bf16 v[156:159], v[136:139], v[164:167], v[156:159]
    v_mfma_f32_16x16x32_bf16 v[160:163], v[140:143], v[164:167], v[160:163]
    v_mfma_f32_16x16x32_bf16 v[48:51], a[244:247], v[164:167], v[48:51]
    s_nop 5
    v_cvt_pk_bf16_f32 v184, v156, v157
    v_cvt_pk_bf16_f32 v185, v158, v159
    v_cvt_pk_bf16_f32 v186, v160, v161
    v_cvt_pk_bf16_f32 v187, v162, v163
    ds_write_b128 v11, v[184:187]
    v_rcp_f32 v34, v48
    v_mfma_f32_16x16x32_bf16 v[224:227], v[56:59], v[184:187], 0
    v_mfma_f32_16x16x32_bf16 v[228:231], v[72:75], v[184:187], 0
    v_mfma_f32_16x16x32_bf16 v[232:235], v[88:91], v[184:187], 0
    v_subrev_u32 v30, 0x21800000, v48
    v_cmp_le_u32 vcc, s89, v30
    v_mov_b32 v35, v34
    s_cmp_eq_u32 s35, 63
    s_waitcnt lgkmcnt(0)
    s_cbranch_vccnz smx_fD
smok_fD:
    s_cbranch_scc1 last_fD
    s_barrier
    ds_read_b128 v[196:199], v15 offset:15360
    ds_read_b128 v[200:203], v15 offset:16384
    ds_read_b128 v[204:207], v15 offset:17408
    v_pk_mul_f32 v[156:157], v[156:157], v[34:35]
    v_pk_mul_f32 v[160:161], v[160:161], v[34:35]
    v_pk_mul_f32 v[158:159], v[158:159], v[34:35]
    v_pk_mul_f32 v[162:163], v[162:163], v[34:35]
    v_cvt_pk_bf16_f32 v184, v156, v157
    v_cvt_pk_bf16_f32 v185, v158, v159
    s_waitcnt lgkmcnt(2)
    v_mfma_f32_16x16x32_bf16 v[232:235], v[92:95], v[196:199], v[232:235]
    v_cvt_pk_bf16_f32 v186, v160, v161
    v_cvt_pk_bf16_f32 v187, v162, v163
    s_waitcnt lgkmcnt(1)
    v_mfma_f32_16x16x32_bf16 v[232:235], v[96:99], v[200:203], v[232:235]
    s_waitcnt lgkmcnt(0)
    v_mfma_f32_16x16x32_bf16 v[232:235], v[100:103], v[204:207], v[232:235]
    v_mfma_f32_16x16x32_bf16 v[224:227], v[60:63], v[196:199], v[224:227]
    v_mfma_f32_16x16x32_bf16 v[224:227], v[64:67], v[200:203], v[224:227]
    v_mfma_f32_16x16x32_bf16 v[224:227], v[68:71], v[204:207], v[224:227]
    v_pk_mul_f32 v[232:233], v[232:233], v[34:35]
    v_pk_mul_f32 v[234:235], v[234:235], v[34:35]
    v_cvt_pk_bf16_f32 v232, v232, v233
    v_mfma_f32_16x16x32_bf16 v[228:231], v[76:79], v[196:199], v[228:231]
    v_cvt_pk_bf16_f32 v233, v234, v235
    s_nop 0
    v_min_u32_dpp v144, v232, v19 row_shr:8 row_mask:0xf bank_mask:0xc
    v_min_u32_dpp v145, v233, v19 row_shr:8 row_mask:0xf bank_mask:0xc
    v_mfma_f32_16x16x32_bf16 v[228:231], v[80:83], v[200:203], v[228:231]
    v_min_u32_dpp v146, v232, v19 row_shr:7 row_mask:0xf bank_mask:0xc
    v_min_u32_dpp v147, v233, v19 row_shr:7 row_mask:0xf bank_mask:0xc
    v_mfma_f32_16x16x32_bf16 v[228:231], v[84:87], v[204:207], v[228:231]
    v_pk_mul_f32 v[224:225], v[224:225], v[34:35]
    v_pk_mul_f32 v[226:227], v[226:227], v[34:35]
    v_cvt_pk_bf16_f32 v224, v224, v225
    v_cvt_pk_bf16_f32 v225, v226, v227
    s_nop 1
    v_min_u32_dpp v144, v224, v19 quad_perm:[0,1,2,3] row_mask:0xf bank_mask:0x3
    v_min_u32_dpp v145, v225, v19 quad_perm:[0,1,2,3] row_mask:0xf bank_mask:0x3
    v_pk_mul_f32 v[228:229], v[228:229], v[34:35]
    v_pk_mul_f32 v[230:231], v[230:231], v[34:35]
    v_cvt_pk_bf16_f32 v228, v228, v229
    v_cvt_pk_bf16_f32 v229, v230, v231
    s_nop 0
    v_min_u32_dpp v146, v228, v19 quad_perm:[0,1,2,3] row_mask:0xf bank_mask:0x3
    v_min_u32_dpp v147, v229, v19 quad_perm:[0,1,2,3] row_mask:0xf bank_mask:0x3
    buffer_store_dwordx4 v[144:147], v13, s[4:7], s40 offen sc1
    buffer_store_dwordx4 v[144:147], v12, s[4:7], s44 offen
    s_cmp_eq_u32 s35, s90
    s_cbranch_scc1 z1_fD
z1ok_fD:
    s_add_u32 m0, s14, 24576
    s_add_u32 s42, s45, 8192
    buffer_load_dwordx4 v15, s[4:7], s45 offen sc1 lds
    buffer_load_dwordx4 v15, s[4:7], s45 offen offset:1024 sc1 lds
    buffer_load_dwordx4 v[136:139], v15, s[4:7], s42 offen sc1
    buffer_load_dwordx4 v[140:143], v15, s[4:7], s42 offen offset:1024 sc1
    s_add_u32 s45, s45, 786432
    buffer_store_dwordx4 v[184:187], v14, s[4:7], s48 offen sc1
    s_add_u32 s48, s48, 262144
    s_add_u32 s55, s35, 2
    s_and_b32 s55, s55, 3
    s_mul_i32 s46, s55, 327680
    s_add_u32 s46, s46, 4358144
    buffer_store_dwordx4 v[188:191], v21, s[4:7], s46 offen
    s_add_u32 s46, s46, 32768
    buffer_store_dwordx4 v[188:191], v21, s[4:7], s46 offen
    s_add_u32 s46, s46, 32768
    buffer_store_dwordx4 v[188:191], v22, s[4:7], s46 offen
    s_mul_i32 s47, s55, 262144
    s_add_u32 s47, s47, s51
    buffer_store_dwordx4 v[188:191], v23, s[4:7], s47 offen
    buffer_store_dwordx4 v[188:191], v23, s[4:7], s47 offen offset:1024
    s_add_u32 s55, s55, 1
    s_and_b32 s55, s55, 3
    s_mul_i32 s47, s55, 40960
    s_add_u32 s47, s47, s50
    buffer_store_dwordx4 v[188:191], v24, s[4:7], s47 offen
    s_add_u32 s46, s35, 5
    s_min_u32 s46, s46, 63
    v_readlane_b32 s37, v1, s46
    s_xor_b32 s37, s37, 8192
    s_lshl_b32 s46, s35, 7
    s_add_u32 s46, s46, 5676800
    buffer_store_dword v19, v26, s[4:7], s46 offen sc1
    s_add_u32 s46, s35, 1
    s_and_b32 s47, s46, 63
    s_and_b32 s46, s46, 3
    s_mul_i32 s38, s46, 40960
    s_add_u32 s38, s38, s50
    v_readlane_b32 s40, v1, s47
    s_mul_i32 s44, s46, 327680
    s_add_u32 s44, s44, 4358144
    s_mul_i32 s39, s46, 262144
    s_add_u32 s39, s39, s51
    s_add_u32 s46, s46, 1
    s_and_b32 s46, s46, 3
    s_mul_i32 s41, s46, 40960
    s_add_u32 s41, s41, s50
    s_barrier
    buffer_load_dwordx4 v[224:227], v2, s[4:7], s38 offen offset:0 sc1
    buffer_load_dwordx4 v[228:231], v2, s[4:7], s38 offen offset:1024 sc1
    buffer_load_dwordx4 v[232:235], v2, s[4:7], s38 offen offset:2048 sc1
    s_add_u32 s35, s35, 1
    s_sleep 1
    buffer_load_dwordx4 v[236:239], v2, s[4:7], s38 offen offset:0 sc1
    buffer_load_dwordx4 v[240:243], v2, s[4:7], s38 offen offset:1024 sc1
    buffer_load_dwordx4 v[244:247], v2, s[4:7], s38 offen offset:2048 sc1
    s_branch loop_fD
last_fD:
    v_pk_mul_f32 v[156:157], v[156:157], v[34:35]
    v_pk_mul_f32 v[160:161], v[160:161], v[34:35]
    v_pk_mul_f32 v[158:159], v[158:159], v[34:35]
    v_pk_mul_f32 v[162:163], v[162:163], v[34:35]
    v_cvt_pk_bf16_f32 v184, v156, v157
    v_cvt_pk_bf16_f32 v185, v158, v159
    v_cvt_pk_bf16_f32 v186, v160, v161
    v_cvt_pk_bf16_f32 v187, v162, v163
    buffer_store_dwordx4 v[184:187], v14, s[4:7], s48 offen sc1
    s_add_u32 s48, s48, 262144
    s_mov_b32 s46, 5684864
    buffer_store_dword v19, v26, s[4:7], s46 offen sc1
    s_waitcnt vmcnt(0)
    s_barrier
    s_lshl_b32 s46, s31, 5
    s_add_u32 s46, s46, s32
    s_lshl_b32 s46, s46, 2
    s_add_u32 s46, s46, 5669888
    v_cmp_eq_u32 vcc, 0, v15
    v_mov_b32 v30, 0x40000000
    s_nop 1
    v_cndmask_b32 v30, v30, 0, vcc
    buffer_store_dword v19, v30, s[4:7], s46 offen sc1
    s_endpgm
x3s_fD:
    buffer_load_dwordx4 v[224:227], v2, s[4:7], s38 offen offset:0 sc1
    buffer_load_dwordx4 v[228:231], v2, s[4:7], s38 offen offset:1024 sc1
    buffer_load_dwordx4 v[232:235], v2, s[4:7], s38 offen offset:2048 sc1
    s_waitcnt vmcnt(5)
    ds_write_b128 v2, v[236:239] offset:0
    v_max3_u32 v30, v236, v237, v238
    v_max_u32 v30, v30, v239
    s_waitcnt vmcnt(4)
    ds_write_b128 v2, v[240:243] offset:1024
    v_max3_u32 v30, v30, v240, v241
    v_max3_u32 v30, v30, v242, v243
    s_waitcnt vmcnt(3)
    ds_write_b128 v2, v[244:247] offset:2048
    v_max3_u32 v30, v30, v244, v245
    v_max3_u32 v30, v30, v246, v247
    v_cmp_eq_u32 vcc, -1, v30
    s_waitcnt lgkmcnt(0)
    s_cbranch_vccz x3ok_fD
    buffer_load_dwordx4 v[236:239], v2, s[4:7], s38 offen offset:0 sc1
    buffer_load_dwordx4 v[240:243], v2, s[4:7], s38 offen offset:1024 sc1
    buffer_load_dwordx4 v[244:247], v2, s[4:7], s38 offen offset:2048 sc1
    s_waitcnt vmcnt(5)
    ds_write_b128 v2, v[224:227] offset:0
    v_max3_u32 v30, v224, v225, v226
    v_max_u32 v30, v30, v227
    s_waitcnt vmcnt(4)
    ds_write_b128 v2, v[228:231] offset:1024
    v_max3_u32 v30, v30, v228, v229
    v_max3_u32 v30, v30, v230, v231
    s_waitcnt vmcnt(3)
    ds_write_b128 v2, v[232:235] offset:2048
    v_max3_u32 v30, v30, v232, v233
    v_max3_u32 v30, v30, v234, v235
    v_cmp_eq_u32 vcc, -1, v30
    s_waitcnt lgkmcnt(0)
    s_cbranch_vccz x3ok_fD
    s_sub_u32 s36, s36, 1
    s_cbranch_scc0 x3s_fD
    s_mov_b32 s46, 1
    s_branch chain_abort
qks_fD:
qkt_fD:
    buffer_load_dwordx4 v[248:251], v6, s[4:7], s39 offen sc1
    s_waitcnt vmcnt(1)
    ds_write_b128 v7, v[252:255]
    v_max3_u32 v30, v252, v253, v254
    v_max_u32 v30, v30, v255
    v_cmp_eq_u32 vcc, -1, v30
    s_waitcnt lgkmcnt(0)
    s_cbranch_vccz qkok_fD
    buffer_load_dwordx4 v[252:255], v6, s[4:7], s39 offen sc1
    s_waitcnt vmcnt(1)
    ds_write_b128 v7, v[248:251]
    v_max3_u32 v30, v248, v249, v250
    v_max_u32 v30, v30, v251
    v_cmp_eq_u32 vcc, -1, v30
    s_waitcnt lgkmcnt(0)
    s_cbranch_vccz qkok_fD
    s_sub_u32 s36, s36, 1
    s_cbranch_scc0 qkt_fD
    s_mov_b32 s46, 2
    s_branch chain_abort
pvs_fD:
pvt_fD:
    buffer_load_dwordx4 v[168:171], v10, s[4:7], s39 offen sc1
    s_waitcnt vmcnt(0)
    v_max3_u32 v32, v168, v169, v170
    v_max_u32 v32, v32, v171
    v_cmp_eq_u32 vcc, -1, v32
    s_cbranch_vccz pvok_fD
    s_sub_u32 s36, s36, 1
    s_cbranch_scc0 pvt_fD
    s_mov_b32 s46, 3
    s_branch chain_abort
smx_fD:
    v_mfma_f32_16x16x32_bf16 v[144:147], v[104:107], v[192:195], v[40:43]
    v_mfma_f32_16x16x32_bf16 v[144:147], v[108:111], v[196:199], v[144:147]
    v_mfma_f32_16x16x32_bf16 v[144:147], v[112:115], v[200:203], v[144:147]
    v_mfma_f32_16x16x32_bf16 v[144:147], v[116:119], v[204:207], v[144:147]
    v_mfma_f32_16x16x32_bf16 v[148:151], v[120:123], v[192:195], v[44:47]
    v_mfma_f32_16x16x32_bf16 v[148:151], v[124:127], v[196:199], v[148:151]
    v_mfma_f32_16x16x32_bf16 v[148:151], v[128:131], v[200:203], v[148:151]
    v_mfma_f32_16x16x32_bf16 v[148:151], v[132:135], v[204:207], v[148:151]
    v_mfma_f32_16x16x32_bf16 v[152:155], v[208:211], v[192:195], 0
    v_mfma_f32_16x16x32_bf16 v[152:155], v[212:215], v[196:199], v[152:155]
    v_mfma_f32_16x16x32_bf16 v[152:155], v[216:219], v[200:203], v[152:155]
    v_mfma_f32_16x16x32_bf16 v[152:155], v[220:223], v[204:207], v[152:155]
    s_nop 7
    v_max3_f32 v20, v144, v145, v146
    v_max3_f32 v20, v20, v147, v148
    v_max3_f32 v20, v20, v149, v150
    v_max3_f32 v20, v20, v151, v152
    v_max3_f32 v20, v20, v153, v154
    v_max_f32 v20, v20, v155
    v_mov_b32 v30, v20
    s_nop 1
    v_permlane16_swap_b32 v30, v20
    s_nop 0
    v_max_f32 v20, v20, v30
    v_mov_b32 v30, v20
    s_nop 1
    v_permlane32_swap_b32 v30, v20
    s_nop 0
    v_max_f32 v20, v20, v30
    v_sub_f32 v144, v144, v20
    v_sub_f32 v145, v145, v20
    v_sub_f32 v146, v146, v20
    v_sub_f32 v147, v147, v20
    v_sub_f32 v148, v148, v20
    v_sub_f32 v149, v149, v20
    v_sub_f32 v150, v150, v20
    v_sub_f32 v151, v151, v20
    v_sub_f32 v152, v152, v20
    v_sub_f32 v153, v153, v20
    v_sub_f32 v154, v154, v20
    v_sub_f32 v155, v155, v20
    v_exp_f32 v144, v144
    v_exp_f32 v145, v145
    v_exp_f32 v146, v146
    v_exp_f32 v147, v147
    v_exp_f32 v148, v148
    v_exp_f32 v149, v149
    v_exp_f32 v150, v150
    v_exp_f32 v151, v151
    v_exp_f32 v152, v152
    v_exp_f32 v153, v153
    v_exp_f32 v154, v154
    v_exp_f32 v155, v155
    s_nop 0
    v_cvt_pk_bf16_f32 v164, v144, v145
    v_cvt_pk_bf16_f32 v165, v146, v147
    v_cvt_pk_bf16_f32 v166, v148, v149
    v_cvt_pk_bf16_f32 v167, v150, v151
    v_cvt_pk_bf16_f32 v36, v152, v153
    v_cvt_pk_bf16_f32 v37, v154, v155
    s_nop 1
    v_mfma_f32_16x16x16_bf16 v[156:159], v[168:169], v[36:37], 0
    v_mfma_f32_16x16x16_bf16 v[160:163], v[170:171], v[36:37], 0
    v_mfma_f32_16x16x16_bf16 v[48:51], a[252:253], v[36:37], 0
    s_nop 5
    v_mfma_f32_16x16x32_bf16 v[156:159], v[136:139], v[164:167], v[156:159]
    v_mfma_f32_16x16x32_bf16 v[160:163], v[140:143], v[164:167], v[160:163]
    v_mfma_f32_16x16x32_bf16 v[48:51], a[244:247], v[164:167], v[48:51]
    s_nop 5
    v_cvt_pk_bf16_f32 v184, v156, v157
    v_cvt_pk_bf16_f32 v185, v158, v159
    v_cvt_pk_bf16_f32 v186, v160, v161
    v_cvt_pk_bf16_f32 v187, v162, v163
    ds_write_b128 v11, v[184:187]
    v_rcp_f32 v34, v48
    v_mfma_f32_16x16x32_bf16 v[224:227], v[56:59], v[184:187], 0
    v_mfma_f32_16x16x32_bf16 v[228:231], v[72:75], v[184:187], 0
    v_mfma_f32_16x16x32_bf16 v[232:235], v[88:91], v[184:187], 0
    s_nop 0
    v_mov_b32 v35, v34
    s_cmp_eq_u32 s35, 63
    s_waitcnt lgkmcnt(0)
    s_branch smok_fD
z1_fD:
    v_lshrrev_b32 v32, 1, v15
    buffer_load_dwordx2 v[30:31], v32, s[4:7], s91 offen sc1
    s_waitcnt vmcnt(0)
    v_max_u32 v30, v30, v31
    v_cmp_eq_u32 vcc, -1, v30
    s_cbranch_vccz z2_fD
    s_sub_u32 s36, s36, 1
    s_cbranch_scc0 z1_fD
    s_mov_b32 s46, 8
    s_branch chain_abort
z2_fD:
    s_add_u32 s91, s91, 512
    s_cmp_eq_u32 s90, 2
    s_cselect_b32 s90, 7, 23
    s_branch z1ok_fD
entry_fA:
    buffer_load_dwordx4 v[224:227], v2, s[4:7], s38 offen offset:0 sc1
    buffer_load_dwordx4 v[228:231], v2, s[4:7], s38 offen offset:1024 sc1
    buffer_load_dwordx4 v[232:235], v2, s[4:7], s38 offen offset:2048 sc1
    s_waitcnt vmcnt(0)
    buffer_load_dwordx4 v[236:239], v2, s[4:7], s38 offen offset:0 sc1
    buffer_load_dwordx4 v[240:243], v2, s[4:7], s38 offen offset:1024 sc1
    buffer_load_dwordx4 v[244:247], v2, s[4:7], s38 offen offset:2048 sc1
    s_branch loop_fA
.p2align 6
loop_fA:
    s_waitcnt vmcnt(5)
    ds_write_b128 v2, v[224:227] offset:0
    v_max3_u32 v30, v224, v225, v226
    v_max_u32 v30, v30, v227
    s_waitcnt vmcnt(4)
    ds_write_b128 v2, v[228:231] offset:1024
    v_max3_u32 v30, v30, v228, v229
    v_max3_u32 v30, v30, v230, v231
    s_waitcnt vmcnt(3)
    ds_write_b128 v2, v[232:235] offset:2048
    v_max3_u32 v30, v30, v232, v233
    v_max3_u32 v30, v30, v234, v235
    v_cmp_eq_u32 vcc, -1, v30
    s_waitcnt lgkmcnt(0)
    s_cbranch_vccnz x3s_fA
x3ok_fA:
    s_barrier
    ds_read_b128 v[192:195], v3 offset:0
    ds_read_b128 v[196:199], v3 offset:1024
    ds_read_b128 v[200:203], v3 offset:2048
    ds_read_b128 v[204:207], v3 offset:3072
    ds_read_b128 v[208:211], v3 offset:4096
    ds_read_b128 v[212:215], v3 offset:5120
    ds_read_b128 v[216:219], v3 offset:6144
    ds_read_b128 v[220:223], v3 offset:7168
    ds_read_b128 v[144:147], v3 offset:8192
    ds_read_b128 v[148:151], v3 offset:9216
p2c_fA:
    s_waitcnt lgkmcnt(9)
    v_mfma_f32_16x16x32_bf16 v[156:159], a[0:3], v[192:195], 0
    v_mfma_f32_16x16x32_bf16 v[160:163], a[4:7], v[192:195], 0
    s_waitcnt lgkmcnt(8)
    v_mfma_f32_16x16x32_bf16 v[156:159], a[8:11], v[196:199], v[156:159]
    v_mfma_f32_16x16x32_bf16 v[160:163], a[12:15], v[196:199], v[160:163]
    s_waitcnt lgkmcnt(7)
    v_mfma_f32_16x16x32_bf16 v[156:159], a[16:19], v[200:203], v[156:159]
    v_mfma_f32_16x16x32_bf16 v[160:163], a[20:23], v[200:203], v[160:163]
    s_waitcnt lgkmcnt(6)
    v_mfma_f32_16x16x32_bf16 v[156:159], a[24:27], v[204:207], v[156:159]
    v_mfma_f32_16x16x32_bf16 v[160:163], a[28:31], v[204:207], v[160:163]
    s_waitcnt lgkmcnt(5)
    v_mfma_f32_16x16x32_bf16 v[156:159], a[32:35], v[208:211], v[156:159]
    v_mfma_f32_16x16x32_bf16 v[160:163], a[36:39], v[208:211], v[160:163]
    s_waitcnt lgkmcnt(4)
    v_mfma_f32_16x16x32_bf16 v[156:159], a[40:43], v[212:215], v[156:159]
    v_mfma_f32_16x16x32_bf16 v[160:163], a[44:47], v[212:215], v[160:163]
    s_waitcnt lgkmcnt(3)
    v_mfma_f32_16x16x32_bf16 v[156:159], a[48:51], v[216:219], v[156:159]
    v_mfma_f32_16x16x32_bf16 v[160:163], a[52:55], v[216:219], v[160:163]
    s_waitcnt lgkmcnt(2)
    v_mfma_f32_16x16x32_bf16 v[156:159], a[56:59], v[220:223], v[156:159]
    v_mfma_f32_16x16x32_bf16 v[160:163], a[60:63], v[220:223], v[160:163]
    s_waitcnt lgkmcnt(1)
    v_mfma_f32_16x16x32_bf16 v[156:159], a[64:67], v[144:147], v[156:159]
    v_mfma_f32_16x16x32_bf16 v[160:163], a[68:71], v[144:147], v[160:163]
    s_waitcnt lgkmcnt(0)
    v_mfma_f32_16x16x32_bf16 v[156:159], a[72:75], v[148:151], v[156:159]
    v_mfma_f32_16x16x32_bf16 v[160:163], a[76:79], v[148:151], v[160:163]
    v_mfma_f32_16x16x32_bf16 v[52:55], v[192:195], a[80:83], 0
    v_mfma_f32_16x16x32_bf16 v[52:55], v[196:199], a[84:87], v[52:55]
    v_mfma_f32_16x16x32_bf16 v[52:55], v[200:203], a[88:91], v[52:55]
    v_add_f32_dpp v156, v160, v156 row_ror:8 row_mask:0xf bank_mask:0xf
    v_add_f32_dpp v157, v161, v157 row_ror:8 row_mask:0xf bank_mask:0xf
    v_add_f32_dpp v158, v162, v158 row_ror:8 row_mask:0xf bank_mask:0xf
    v_add_f32_dpp v159, v163, v159 row_ror:8 row_mask:0xf bank_mask:0xf
    v_pk_mul_f32 v[156:157], v[156:157], s[12:13]
    v_pk_mul_f32 v[158:159], v[158:159], s[12:13]
    v_cvt_pk_bf16_f32 v30, v156, v157
    v_cvt_pk_bf16_f32 v31, v158, v159
    v_min_u32 v30, -2, v30
    v_min_u32 v31, -2, v31
    buffer_store_dwordx2 v[30:31], v4, s[4:7], s39 offen
    v_mfma_f32_16x16x32_bf16 v[52:55], v[204:207], a[92:95], v[52:55]
    v_mfma_f32_16x16x32_bf16 v[52:55], v[208:211], a[96:99], v[52:55]
    v_mfma_f32_16x16x32_bf16 v[52:55], v[212:215], a[100:103], v[52:55]
    v_mfma_f32_16x16x32_bf16 v[52:55], v[216:219], a[104:107], v[52:55]
    v_mfma_f32_16x16x32_bf16 v[52:55], v[220:223], a[108:111], v[52:55]
    buffer_load_dwordx4 v[248:251], v6, s[4:7], s39 offen sc1
    v_mfma_f32_16x16x32_bf16 v[52:55], v[144:147], a[112:115], v[52:55]
    v_mfma_f32_16x16x32_bf16 v[52:55], v[148:151], a[116:119], v[52:55]
    ds_read_b128 v[104:107], v15 offset:24576
    ds_read_b128 v[108:111], v15 offset:25600
    ds_read_b128 v[112:115], v15 offset:26624
    ds_read_b128 v[116:119], v15 offset:27648
    ds_read_b128 v[120:123], v15 offset:28672
    ds_read_b128 v[124:127], v15 offset:29696
    ds_read_b128 v[128:131], v15 offset:30720
    ds_read_b128 v[132:135], v15 offset:31744
    v_cvt_pk_bf16_f32 v32, v52, v53
    v_cvt_pk_bf16_f32 v33, v54, v55
    v_min_u32 v32, -2, v32
    v_min_u32 v33, -2, v33
    buffer_store_dwordx2 v[32:33], v5, s[4:7], s39 offen
    s_add_u32 s47, s35, 3
    s_lshr_b32 s47, s47, 1
    s_cmp_lt_i32 s29, s47
    s_cbranch_scc1 qp_fA
qpok_fA:
    buffer_load_dwordx4 v[252:255], v6, s[4:7], s39 offen sc1
    s_waitcnt vmcnt(2)
    ds_write_b128 v7, v[248:251]
    v_max3_u32 v30, v248, v249, v250
    v_max_u32 v30, v30, v251
    v_cmp_eq_u32 vcc, -1, v30
    s_waitcnt lgkmcnt(0)
    s_cbranch_vccnz qks_fA
qkok_fA:
    buffer_load_dwordx4 v[168:171], v10, s[4:7], s39 offen sc1
    s_barrier
    ds_read_b128 v[192:195], v8 offset:0
    ds_read_b128 v[196:199], v8 offset:512
    ds_read_b128 v[200:203], v8 offset:1024
    ds_read_b128 v[204:207], v8 offset:1536
    ds_read_b128 v[208:211], v9 offset:0
    ds_read_b128 v[212:215], v9 offset:512
    ds_read_b128 v[216:219], v9 offset:1024
    ds_read_b128 v[220:223], v9 offset:1536
    s_waitcnt lgkmcnt(7)
    v_mfma_f32_16x16x32_bf16 v[144:147], v[104:107], v[192:195], v[40:43]
    s_waitcnt lgkmcnt(6)
    v_mfma_f32_16x16x32_bf16 v[144:147], v[108:111], v[196:199], v[144:147]
    s_waitcnt lgkmcnt(5)
    v_mfma_f32_16x16x32_bf16 v[144:147], v[112:115], v[200:203], v[144:147]
    s_waitcnt lgkmcnt(4)
    v_mfma_f32_16x16x32_bf16 v[144:147], v[116:119], v[204:207], v[144:147]
    s_waitcnt lgkmcnt(3)
    v_mfma_f32_16x16x32_bf16 v[152:155], v[208:211], v[192:195], 0
    s_waitcnt lgkmcnt(2)
    v_mfma_f32_16x16x32_bf16 v[152:155], v[212:215], v[196:199], v[152:155]
    s_waitcnt lgkmcnt(1)
    v_mfma_f32_16x16x32_bf16 v[152:155], v[216:219], v[200:203], v[152:155]
    v_exp_f32 v144, v144
    s_waitcnt lgkmcnt(0)
    v_mfma_f32_16x16x32_bf16 v[152:155], v[220:223], v[204:207], v[152:155]
    v_exp_f32 v145, v145
    v_mfma_f32_16x16x32_bf16 v[148:151], v[120:123], v[192:195], v[44:47]
    v_exp_f32 v146, v146
    v_mfma_f32_16x16x32_bf16 v[148:151], v[124:127], v[196:199], v[148:151]
    v_exp_f32 v147, v147
    v_mfma_f32_16x16x32_bf16 v[148:151], v[128:131], v[200:203], v[148:151]
    v_exp_f32 v152, v152
    v_mfma_f32_16x16x32_bf16 v[148:151], v[132:135], v[204:207], v[148:151]
    v_exp_f32 v153, v153
    v_exp_f32 v154, v154
    v_exp_f32 v155, v155
    s_waitcnt vmcnt(0)
    v_max3_u32 v32, v168, v169, v170
    v_max_u32 v32, v32, v171
    v_cmp_eq_u32 vcc, -1, v32
    v_cvt_pk_bf16_f32 v36, v152, v153
    v_cvt_pk_bf16_f32 v37, v154, v155
    v_exp_f32 v148, v148
    s_cbranch_vccnz pvs_fA
pvok_fA:
    v_mfma_f32_16x16x16_bf16 v[156:159], v[168:169], v[36:37], 0
    v_exp_f32 v149, v149
    buffer_load_dword v18, v25, s[4:7], s88 offen sc1
    v_mfma_f32_16x16x16_bf16 v[160:163], v[170:171], v[36:37], 0
    v_exp_f32 v150, v150
    v_mfma_f32_16x16x16_bf16 v[48:51], a[252:253], v[36:37], 0
    v_exp_f32 v151, v151
    v_cvt_pk_bf16_f32 v164, v144, v145
    v_cvt_pk_bf16_f32 v165, v146, v147
    v_cvt_pk_bf16_f32 v166, v148, v149
    v_cvt_pk_bf16_f32 v167, v150, v151
    s_nop 1
    v_mfma_f32_16x16x32_bf16 v[156:159], v[136:139], v[164:167], v[156:159]
    v_mfma_f32_16x16x32_bf16 v[160:163], v[140:143], v[164:167], v[160:163]
    v_mfma_f32_16x16x32_bf16 v[48:51], a[244:247], v[164:167], v[48:51]
    s_nop 5
    v_cvt_pk_bf16_f32 v184, v156, v157
    v_cvt_pk_bf16_f32 v185, v158, v159
    v_cvt_pk_bf16_f32 v186, v160, v161
    v_cvt_pk_bf16_f32 v187, v162, v163
    ds_write_b128 v11, v[184:187]
    v_rcp_f32 v34, v48
    v_mfma_f32_16x16x32_bf16 v[224:227], v[60:63], v[184:187], 0
    v_mfma_f32_16x16x32_bf16 v[228:231], v[76:79], v[184:187], 0
    v_mfma_f32_16x16x32_bf16 v[232:235], v[92:95], v[184:187], 0
    v_subrev_u32 v30, 0x21800000, v48
    v_cmp_le_u32 vcc, s89, v30
    v_mov_b32 v35, v34
    s_cmp_eq_u32 s35, 63
    s_waitcnt lgkmcnt(0)
    s_cbranch_vccnz smx_fA
smok_fA:
    s_cbranch_scc1 last_fA
    s_barrier
    ds_read_b128 v[192:195], v15 offset:14336
    ds_read_b128 v[200:203], v15 offset:16384
    ds_read_b128 v[204:207], v15 offset:17408
    v_pk_mul_f32 v[156:157], v[156:157], v[34:35]
    v_pk_mul_f32 v[160:161], v[160:161], v[34:35]
    v_pk_mul_f32 v[158:159], v[158:159], v[34:35]
    v_pk_mul_f32 v[162:163], v[162:163], v[34:35]
    v_cvt_pk_bf16_f32 v184, v156, v157
    v_cvt_pk_bf16_f32 v185, v158, v159
    s_waitcnt lgkmcnt(2)
    v_mfma_f32_16x16x32_bf16 v[232:235], v[88:91], v[192:195], v[232:235]
    v_cvt_pk_bf16_f32 v186, v160, v161
    v_cvt_pk_bf16_f32 v187, v162, v163
    s_waitcnt lgkmcnt(1)
    v_mfma_f32_16x16x32_bf16 v[232:235], v[96:99], v[200:203], v[232:235]
    s_waitcnt lgkmcnt(0)
    v_mfma_f32_16x16x32_bf16 v[232:235], v[100:103], v[204:207], v[232:235]
    v_mfma_f32_16x16x32_bf16 v[224:227], v[56:59], v[192:195], v[224:227]
    v_mfma_f32_16x16x32_bf16 v[224:227], v[64:67], v[200:203], v[224:227]
    v_mfma_f32_16x16x32_bf16 v[224:227], v[68:71], v[204:207], v[224:227]
    v_pk_mul_f32 v[232:233], v[232:233], v[34:35]
    v_pk_mul_f32 v[234:235], v[234:235], v[34:35]
    v_cvt_pk_bf16_f32 v232, v232, v233
    v_mfma_f32_16x16x32_bf16 v[228:231], v[72:75], v[192:195], v[228:231]
    v_cvt_pk_bf16_f32 v233, v234, v235
    s_nop 0
    v_min_u32_dpp v144, v232, v19 row_shr:8 row_mask:0xf bank_mask:0xc
    v_min_u32_dpp v145, v233, v19 row_shr:8 row_mask:0xf bank_mask:0xc
    v_mfma_f32_16x16x32_bf16 v[228:231], v[80:83], v[200:203], v[228:231]
    v_min_u32_dpp v146, v232, v19 row_shr:7 row_mask:0xf bank_mask:0xc
    v_min_u32_dpp v147, v233, v19 row_shr:7 row_mask:0xf bank_mask:0xc
    v_mfma_f32_16x16x32_bf16 v[228:231], v[84:87], v[204:207], v[228:231]
    v_pk_mul_f32 v[224:225], v[224:225], v[34:35]
    v_pk_mul_f32 v[226:227], v[226:227], v[34:35]
    v_cvt_pk_bf16_f32 v224, v224, v225
    v_cvt_pk_bf16_f32 v225, v226, v227
    s_nop 1
    v_min_u32_dpp v144, v224, v19 quad_perm:[0,1,2,3] row_mask:0xf bank_mask:0x3
    v_min_u32_dpp v145, v225, v19 quad_perm:[0,1,2,3] row_mask:0xf bank_mask:0x3
    v_pk_mul_f32 v[228:229], v[228:229], v[34:35]
    v_pk_mul_f32 v[230:231], v[230:231], v[34:35]
    v_cvt_pk_bf16_f32 v228, v228, v229
    v_cvt_pk_bf16_f32 v229, v230, v231
    s_nop 0
    v_min_u32_dpp v146, v228, v19 quad_perm:[0,1,2,3] row_mask:0xf bank_mask:0x3
    v_min_u32_dpp v147, v229, v19 quad_perm:[0,1,2,3] row_mask:0xf bank_mask:0x3
    buffer_store_dwordx4 v[144:147], v13, s[4:7], s40 offen sc1
    buffer_store_dwordx4 v[144:147], v12, s[4:7], s44 offen
    s_mov_b32 m0, 22528
    s_nop 0
    buffer_load_dwordx4 v15, s[4:7], s15 offen sc1 lds
    buffer_load_dwordx4 v15, s[4:7], s15 offen offset:1024 sc1 lds
    s_add_u32 s15, s15, 786432
    s_add_u32 m0, s14, 24576
    s_add_u32 s42, s45, 8192
    buffer_load_dwordx4 v15, s[4:7], s45 offen sc1 lds
    buffer_load_dwordx4 v15, s[4:7], s45 offen offset:1024 sc1 lds
    buffer_load_dwordx4 v[136:139], v15, s[4:7], s42 offen sc1
    buffer_load_dwordx4 v[140:143], v15, s[4:7], s42 offen offset:1024 sc1
    s_add_u32 s45, s45, 786432
    s_add_u32 s88, s88, 786432
    buffer_store_dwordx4 v[184:187], v14, s[4:7], s48 offen sc1
    s_add_u32 s48, s48, 262144
    s_add_u32 s46, s35, 1
    s_and_b32 s47, s46, 63
    s_and_b32 s46, s46, 3
    s_mul_i32 s38, s46, 40960
    s_add_u32 s38, s38, s50
    v_readlane_b32 s40, v1, s47
    s_mul_i32 s44, s46, 327680
    s_add_u32 s44, s44, 4358144
    s_mul_i32 s39, s46, 262144
    s_add_u32 s39, s39, s51
    s_add_u32 s46, s46, 1
    s_and_b32 s46, s46, 3
    s_mul_i32 s41, s46, 40960
    s_add_u32 s41, s41, s50
    s_barrier
    buffer_load_dwordx4 v[224:227], v2, s[4:7], s38 offen offset:0 sc1
    buffer_load_dwordx4 v[228:231], v2, s[4:7], s38 offen offset:1024 sc1
    buffer_load_dwordx4 v[232:235], v2, s[4:7], s38 offen offset:2048 sc1
    s_add_u32 s35, s35, 1
    s_sleep 1
    buffer_load_dwordx4 v[236:239], v2, s[4:7], s38 offen offset:0 sc1
    buffer_load_dwordx4 v[240:243], v2, s[4:7], s38 offen offset:1024 sc1
    buffer_load_dwordx4 v[244:247], v2, s[4:7], s38 offen offset:2048 sc1
    s_branch loop_fA
last_fA:
    v_pk_mul_f32 v[156:157], v[156:157], v[34:35]
    v_pk_mul_f32 v[160:161], v[160:161], v[34:35]
    v_pk_mul_f32 v[158:159], v[158:159], v[34:35]
    v_pk_mul_f32 v[162:163], v[162:163], v[34:35]
    v_cvt_pk_bf16_f32 v184, v156, v157
    v_cvt_pk_bf16_f32 v185, v158, v159
    v_cvt_pk_bf16_f32 v186, v160, v161
    v_cvt_pk_bf16_f32 v187, v162, v163
    buffer_store_dwordx4 v[184:187], v14, s[4:7], s48 offen sc1
    s_add_u32 s48, s48, 262144
    s_waitcnt vmcnt(0)
    s_barrier
    s_endpgm
x3s_fA:
    buffer_load_dwordx4 v[224:227], v2, s[4:7], s38 offen offset:0 sc1
    buffer_load_dwordx4 v[228:231], v2, s[4:7], s38 offen offset:1024 sc1
    buffer_load_dwordx4 v[232:235], v2, s[4:7], s38 offen offset:2048 sc1
    s_waitcnt vmcnt(5)
    ds_write_b128 v2, v[236:239] offset:0
    v_max3_u32 v30, v236, v237, v238
    v_max_u32 v30, v30, v239
    s_waitcnt vmcnt(4)
    ds_write_b128 v2, v[240:243] offset:1024
    v_max3_u32 v30, v30, v240, v241
    v_max3_u32 v30, v30, v242, v243
    s_waitcnt vmcnt(3)
    ds_write_b128 v2, v[244:247] offset:2048
    v_max3_u32 v30, v30, v244, v245
    v_max3_u32 v30, v30, v246, v247
    v_cmp_eq_u32 vcc, -1, v30
    s_waitcnt lgkmcnt(0)
    s_cbranch_vccz x3ok_fA
    buffer_load_dwordx4 v[236:239], v2, s[4:7], s38 offen offset:0 sc1
    buffer_load_dwordx4 v[240:243], v2, s[4:7], s38 offen offset:1024 sc1
    buffer_load_dwordx4 v[244:247], v2, s[4:7], s38 offen offset:2048 sc1
    s_waitcnt vmcnt(5)
    ds_write_b128 v2, v[224:227] offset:0
    v_max3_u32 v30, v224, v225, v226
    v_max_u32 v30, v30, v227
    s_waitcnt vmcnt(4)
    ds_write_b128 v2, v[228:231] offset:1024
    v_max3_u32 v30, v30, v228, v229
    v_max3_u32 v30, v30, v230, v231
    s_waitcnt vmcnt(3)
    ds_write_b128 v2, v[232:235] offset:2048
    v_max3_u32 v30, v30, v232, v233
    v_max3_u32 v30, v30, v234, v235
    v_cmp_eq_u32 vcc, -1, v30
    s_waitcnt lgkmcnt(0)
    s_cbranch_vccz x3ok_fA
    s_sub_u32 s36, s36, 1
    s_cbranch_scc0 x3s_fA
    s_mov_b32 s46, 1
    s_branch chain_abort
qp_fA:
    buffer_load_dword v30, v26, s[4:7], 0 offen sc1
    s_waitcnt vmcnt(0)
    v_min_i32_dpp v30, v30, v30 row_ror:2 row_mask:0xf bank_mask:0xf
    s_nop 1
    v_min_i32_dpp v30, v30, v30 row_ror:1 row_mask:0xf bank_mask:0xf
    s_nop 1
    v_readfirstlane_b32 s29, v30
    s_cmp_ge_i32 s29, s47
    s_cbranch_scc1 qpok_fA
    s_sub_u32 s36, s36, 1
    s_cbranch_scc0 qp_fA
    s_mov_b32 s46, 9
    s_branch chain_abort
qks_fA:
qkt_fA:
    buffer_load_dwordx4 v[248:251], v6, s[4:7], s39 offen sc1
    s_waitcnt vmcnt(1)
    ds_write_b128 v7, v[252:255]
    v_max3_u32 v30, v252, v253, v254
    v_max_u32 v30, v30, v255
    v_cmp_eq_u32 vcc, -1, v30
    s_waitcnt lgkmcnt(0)
    s_cbranch_vccz qkok_fA
    buffer_load_dwordx4 v[252:255], v6, s[4:7], s39 offen sc1
    s_waitcnt vmcnt(1)
    ds_write_b128 v7, v[248:251]
    v_max3_u32 v30, v248, v249, v250
    v_max_u32 v30, v30, v251
    v_cmp_eq_u32 vcc, -1, v30
    s_waitcnt lgkmcnt(0)
    s_cbranch_vccz qkok_fA
    s_sub_u32 s36, s36, 1
    s_cbranch_scc0 qkt_fA
    s_mov_b32 s46, 2
    s_branch chain_abort
pvs_fA:
pvt_fA:
    buffer_load_dwordx4 v[168:171], v10, s[4:7], s39 offen sc1
    s_waitcnt vmcnt(0)
    v_max3_u32 v32, v168, v169, v170
    v_max_u32 v32, v32, v171
    v_cmp_eq_u32 vcc, -1, v32
    s_cbranch_vccz pvok_fA
    s_sub_u32 s36, s36, 1
    s_cbranch_scc0 pvt_fA
    s_mov_b32 s46, 3
    s_branch chain_abort
smx_fA:
    v_mfma_f32_16x16x32_bf16 v[144:147], v[104:107], v[192:195], v[40:43]
    v_mfma_f32_16x16x32_bf16 v[144:147], v[108:111], v[196:199], v[144:147]
    v_mfma_f32_16x16x32_bf16 v[144:147], v[112:115], v[200:203], v[144:147]
    v_mfma_f32_16x16x32_bf16 v[144:147], v[116:119], v[204:207], v[144:147]
    v_mfma_f32_16x16x32_bf16 v[148:151], v[120:123], v[192:195], v[44:47]
    v_mfma_f32_16x16x32_bf16 v[148:151], v[124:127], v[196:199], v[148:151]
    v_mfma_f32_16x16x32_bf16 v[148:151], v[128:131], v[200:203], v[148:151]
    v_mfma_f32_16x16x32_bf16 v[148:151], v[132:135], v[204:207], v[148:151]
    v_mfma_f32_16x16x32_bf16 v[152:155], v[208:211], v[192:195], 0
    v_mfma_f32_16x16x32_bf16 v[152:155], v[212:215], v[196:199], v[152:155]
    v_mfma_f32_16x16x32_bf16 v[152:155], v[216:219], v[200:203], v[152:155]
    v_mfma_f32_16x16x32_bf16 v[152:155], v[220:223], v[204:207], v[152:155]
    s_nop 7
    v_max3_f32 v20, v144, v145, v146
    v_max3_f32 v20, v20, v147, v148
    v_max3_f32 v20, v20, v149, v150
    v_max3_f32 v20, v20, v151, v152
    v_max3_f32 v20, v20, v153, v154
    v_max_f32 v20, v20, v155
    v_mov_b32 v30, v20
    s_nop 1
    v_permlane16_swap_b32 v30, v20
    s_nop 0
    v_max_f32 v20, v20, v30
    v_mov_b32 v30, v20
    s_nop 1
    v_permlane32_swap_b32 v30, v20
    s_nop 0
    v_max_f32 v20, v20, v30
    v_sub_f32 v144, v144, v20
    v_sub_f32 v145, v145, v20
    v_sub_f32 v146, v146, v20
    v_sub_f32 v147, v147, v20
    v_sub_f32 v148, v148, v20
    v_sub_f32 v149, v149, v20
    v_sub_f32 v150, v150, v20
    v_sub_f32 v151, v151, v20
    v_sub_f32 v152, v152, v20
    v_sub_f32 v153, v153, v20
    v_sub_f32 v154, v154, v20
    v_sub_f32 v155, v155, v20
    v_exp_f32 v144, v144
    v_exp_f32 v145, v145
    v_exp_f32 v146, v146
    v_exp_f32 v147, v147
    v_exp_f32 v148, v148
    v_exp_f32 v149, v149
    v_exp_f32 v150, v150
    v_exp_f32 v151, v151
    v_exp_f32 v152, v152
    v_exp_f32 v153, v153
    v_exp_f32 v154, v154
    v_exp_f32 v155, v155
    s_nop 0
    v_cvt_pk_bf16_f32 v164, v144, v145
    v_cvt_pk_bf16_f32 v165, v146, v147
    v_cvt_pk_bf16_f32 v166, v148, v149
    v_cvt_pk_bf16_f32 v167, v150, v151
    v_cvt_pk_bf16_f32 v36, v152, v153
    v_cvt_pk_bf16_f32 v37, v154, v155
    s_nop 1
    v_mfma_f32_16x16x16_bf16 v[156:159], v[168:169], v[36:37], 0
    v_mfma_f32_16x16x16_bf16 v[160:163], v[170:171], v[36:37], 0
    v_mfma_f32_16x16x16_bf16 v[48:51], a[252:253], v[36:37], 0
    s_nop 5
    v_mfma_f32_16x16x32_bf16 v[156:159], v[136:139], v[164:167], v[156:159]
    v_mfma_f32_16x16x32_bf16 v[160:163], v[140:143], v[164:167], v[160:163]
    v_mfma_f32_16x16x32_bf16 v[48:51], a[244:247], v[164:167], v[48:51]
    s_nop 5
    v_cvt_pk_bf16_f32 v184, v156, v157
    v_cvt_pk_bf16_f32 v185, v158, v159
    v_cvt_pk_bf16_f32 v186, v160, v161
    v_cvt_pk_bf16_f32 v187, v162, v163
    ds_write_b128 v11, v[184:187]
    v_rcp_f32 v34, v48
    v_mfma_f32_16x16x32_bf16 v[224:227], v[60:63], v[184:187], 0
    v_mfma_f32_16x16x32_bf16 v[228:231], v[76:79], v[184:187], 0
    v_mfma_f32_16x16x32_bf16 v[232:235], v[92:95], v[184:187], 0
    s_nop 0
    v_mov_b32 v35, v34
    s_cmp_eq_u32 s35, 63
    s_waitcnt lgkmcnt(0)
    s_branch smok_fA
entry_fB:
    buffer_load_dwordx4 v[224:227], v2, s[4:7], s38 offen offset:0 sc1
    buffer_load_dwordx4 v[228:231], v2, s[4:7], s38 offen offset:1024 sc1
    s_waitcnt vmcnt(0)
    buffer_load_dwordx4 v[236:239], v2, s[4:7], s38 offen offset:0 sc1
    buffer_load_dwordx4 v[240:243], v2, s[4:7], s38 offen offset:1024 sc1
    s_branch loop_fB
.p2align 6
loop_fB:
    s_waitcnt vmcnt(3)
    ds_write_b128 v2, v[224:227] offset:0
    v_max3_u32 v30, v224, v225, v226
    v_max_u32 v30, v30, v227
    s_waitcnt vmcnt(2)
    ds_write_b128 v2, v[228:231] offset:1024
    v_max3_u32 v30, v30, v228, v229
    v_max3_u32 v30, v30, v230, v231
    v_cmp_eq_u32 vcc, -1, v30
    s_waitcnt lgkmcnt(0)
    s_cbranch_vccnz x3s_fB
x3ok_fB:
    s_barrier
    ds_read_b128 v[192:195], v3 offset:0
    ds_read_b128 v[196:199], v3 offset:1024
    ds_read_b128 v[200:203], v3 offset:2048
    ds_read_b128 v[204:207], v3 offset:3072
    ds_read_b128 v[208:211], v3 offset:4096
    ds_read_b128 v[212:215], v3 offset:5120
    ds_read_b128 v[216:219], v3 offset:6144
    ds_read_b128 v[220:223], v3 offset:7168
    ds_read_b128 v[144:147], v3 offset:8192
    ds_read_b128 v[148:151], v3 offset:9216
p2c_fB:
    s_waitcnt lgkmcnt(9)
    v_mfma_f32_16x16x32_bf16 v[156:159], a[0:3], v[192:195], 0
    v_mfma_f32_16x16x32_bf16 v[160:163], a[4:7], v[192:195], 0
    s_waitcnt lgkmcnt(8)
    v_mfma_f32_16x16x32_bf16 v[156:159], a[8:11], v[196:199], v[156:159]
    v_mfma_f32_16x16x32_bf16 v[160:163], a[12:15], v[196:199], v[160:163]
    s_waitcnt lgkmcnt(7)
    v_mfma_f32_16x16x32_bf16 v[156:159], a[16:19], v[200:203], v[156:159]
    v_mfma_f32_16x16x32_bf16 v[160:163], a[20:23], v[200:203], v[160:163]
    s_waitcnt lgkmcnt(6)
    v_mfma_f32_16x16x32_bf16 v[156:159], a[24:27], v[204:207], v[156:159]
    v_mfma_f32_16x16x32_bf16 v[160:163], a[28:31], v[204:207], v[160:163]
    s_waitcnt lgkmcnt(5)
    v_mfma_f32_16x16x32_bf16 v[156:159], a[32:35], v[208:211], v[156:159]
    v_mfma_f32_16x16x32_bf16 v[160:163], a[36:39], v[208:211], v[160:163]
    s_waitcnt lgkmcnt(4)
    v_mfma_f32_16x16x32_bf16 v[156:159], a[40:43], v[212:215], v[156:159]
    v_mfma_f32_16x16x32_bf16 v[160:163], a[44:47], v[212:215], v[160:163]
    s_waitcnt lgkmcnt(3)
    v_mfma_f32_16x16x32_bf16 v[156:159], a[48:51], v[216:219], v[156:159]
    v_mfma_f32_16x16x32_bf16 v[160:163], a[52:55], v[216:219], v[160:163]
    s_waitcnt lgkmcnt(2)
    v_mfma_f32_16x16x32_bf16 v[156:159], a[56:59], v[220:223], v[156:159]
    v_mfma_f32_16x16x32_bf16 v[160:163], a[60:63], v[220:223], v[160:163]
    s_waitcnt lgkmcnt(1)
    v_mfma_f32_16x16x32_bf16 v[156:159], a[64:67], v[144:147], v[156:159]
    v_mfma_f32_16x16x32_bf16 v[160:163], a[68:71], v[144:147], v[160:163]
    s_waitcnt lgkmcnt(0)
    v_mfma_f32_16x16x32_bf16 v[156:159], a[72:75], v[148:151], v[156:159]
    v_mfma_f32_16x16x32_bf16 v[160:163], a[76:79], v[148:151], v[160:163]
    v_mfma_f32_16x16x32_bf16 v[52:55], v[192:195], a[80:83], 0
    v_mfma_f32_16x16x32_bf16 v[52:55], v[196:199], a[84:87], v[52:55]
    v_mfma_f32_16x16x32_bf16 v[52:55], v[200:203], a[88:91], v[52:55]
    v_add_f32_dpp v156, v160, v156 row_ror:8 row_mask:0xf bank_mask:0xf
    v_add_f32_dpp v157, v161, v157 row_ror:8 row_mask:0xf bank_mask:0xf
    v_add_f32_dpp v158, v162, v158 row_ror:8 row_mask:0xf bank_mask:0xf
    v_add_f32_dpp v159, v163, v159 row_ror:8 row_mask:0xf bank_mask:0xf
    v_cvt_pk_bf16_f32 v30, v156, v157
    v_cvt_pk_bf16_f32 v31, v158, v159
    v_min_u32 v30, -2, v30
    v_min_u32 v31, -2, v31
    buffer_store_dwordx2 v[30:31], v4, s[4:7], s39 offen
    v_mfma_f32_16x16x32_bf16 v[52:55], v[204:207], a[92:95], v[52:55]
    v_mfma_f32_16x16x32_bf16 v[52:55], v[208:211], a[96:99], v[52:55]
    v_mfma_f32_16x16x32_bf16 v[52:55], v[212:215], a[100:103], v[52:55]
    v_mfma_f32_16x16x32_bf16 v[52:55], v[216:219], a[104:107], v[52:55]
    v_mfma_f32_16x16x32_bf16 v[52:55], v[220:223], a[108:111], v[52:55]
    buffer_load_dwordx4 v[248:251], v6, s[4:7], s39 offen sc1
    v_mfma_f32_16x16x32_bf16 v[52:55], v[144:147], a[112:115], v[52:55]
    v_mfma_f32_16x16x32_bf16 v[52:55], v[148:151], a[116:119], v[52:55]
    ds_read_b128 v[104:107], v15 offset:24576
    ds_read_b128 v[108:111], v15 offset:25600
    ds_read_b128 v[112:115], v15 offset:26624
    ds_read_b128 v[116:119], v15 offset:27648
    ds_read_b128 v[120:123], v15 offset:28672
    ds_read_b128 v[124:127], v15 offset:29696
    ds_read_b128 v[128:131], v15 offset:30720
    ds_read_b128 v[132:135], v15 offset:31744
    v_cvt_pk_bf16_f32 v32, v52, v53
    v_cvt_pk_bf16_f32 v33, v54, v55
    v_min_u32 v32, -2, v32
    v_min_u32 v33, -2, v33
    buffer_store_dwordx2 v[32:33], v5, s[4:7], s39 offen
    buffer_load_dwordx4 v[252:255], v6, s[4:7], s39 offen sc1
    s_waitcnt vmcnt(2)
    ds_write_b128 v7, v[248:251]
    v_max3_u32 v30, v248, v249, v250
    v_max_u32 v30, v30, v251
    v_cmp_eq_u32 vcc, -1, v30
    s_waitcnt lgkmcnt(0)
    s_cbranch_vccnz qks_fB
qkok_fB:
    buffer_load_dwordx4 v[168:171], v10, s[4:7], s39 offen sc1
    s_barrier
    ds_read_b128 v[192:195], v8 offset:0
    ds_read_b128 v[196:199], v8 offset:512
    ds_read_b128 v[200:203], v8 offset:1024
    ds_read_b128 v[204:207], v8 offset:1536
    ds_read_b128 v[208:211], v9 offset:0
    ds_read_b128 v[212:215], v9 offset:512
    ds_read_b128 v[216:219], v9 offset:1024
    ds_read_b128 v[220:223], v9 offset:1536
    s_waitcnt lgkmcnt(7)
    v_mfma_f32_16x16x32_bf16 v[144:147], v[104:107], v[192:195], v[40:43]
    s_waitcnt lgkmcnt(6)
    v_mfma_f32_16x16x32_bf16 v[144:147], v[108:111], v[196:199], v[144:147]
    s_waitcnt lgkmcnt(5)
    v_mfma_f32_16x16x32_bf16 v[144:147], v[112:115], v[200:203], v[144:147]
    s_waitcnt lgkmcnt(4)
    v_mfma_f32_16x16x32_bf16 v[144:147], v[116:119], v[204:207], v[144:147]
    s_waitcnt lgkmcnt(3)
    v_mfma_f32_16x16x32_bf16 v[152:155], v[208:211], v[192:195], 0
    s_waitcnt lgkmcnt(2)
    v_mfma_f32_16x16x32_bf16 v[152:155], v[212:215], v[196:199], v[152:155]
    s_waitcnt lgkmcnt(1)
    v_mfma_f32_16x16x32_bf16 v[152:155], v[216:219], v[200:203], v[152:155]
    v_exp_f32 v144, v144
    s_waitcnt lgkmcnt(0)
    v_mfma_f32_16x16x32_bf16 v[152:155], v[220:223], v[204:207], v[152:155]
    v_exp_f32 v145, v145
    v_mfma_f32_16x16x32_bf16 v[148:151], v[120:123], v[192:195], v[44:47]
    v_exp_f32 v146, v146
    v_mfma_f32_16x16x32_bf16 v[148:151], v[124:127], v[196:199], v[148:151]
    v_exp_f32 v147, v147
    v_mfma_f32_16x16x32_bf16 v[148:151], v[128:131], v[200:203], v[148:151]
    v_exp_f32 v152, v152
    v_mfma_f32_16x16x32_bf16 v[148:151], v[132:135], v[204:207], v[148:151]
    v_exp_f32 v153, v153
    v_exp_f32 v154, v154
    v_exp_f32 v155, v155
    s_waitcnt vmcnt(0)
    v_max3_u32 v32, v168, v169, v170
    v_max_u32 v32, v32, v171
    v_cmp_eq_u32 vcc, -1, v32
    v_cvt_pk_bf16_f32 v36, v152, v153
    v_cvt_pk_bf16_f32 v37, v154, v155
    v_exp_f32 v148, v148
    s_cbranch_vccnz pvs_fB
pvok_fB:
    v_mfma_f32_16x16x16_bf16 v[156:159], v[168:169], v[36:37], 0
    v_exp_f32 v149, v149
    v_mfma_f32_16x16x16_bf16 v[160:163], v[170:171], v[36:37], 0
    v_exp_f32 v150, v150
    v_mfma_f32_16x16x16_bf16 v[48:51], a[252:253], v[36:37], 0
    v_exp_f32 v151, v151
    v_cvt_pk_bf16_f32 v164, v144, v145
    v_cvt_pk_bf16_f32 v165, v146, v147
    v_cvt_pk_bf16_f32 v166, v148, v149
    v_cvt_pk_bf16_f32 v167, v150, v151
    s_nop 1
    v_mfma_f32_16x16x32_bf16 v[156:159], v[136:139], v[164:167], v[156:159]
    v_mfma_f32_16x16x32_bf16 v[160:163], v[140:143], v[164:167], v[160:163]
    v_mfma_f32_16x16x32_bf16 v[48:51], a[244:247], v[164:167], v[48:51]
    s_nop 5
    v_cvt_pk_bf16_f32 v184, v156, v157
    v_cvt_pk_bf16_f32 v185, v158, v159
    v_cvt_pk_bf16_f32 v186, v160, v161
    v_cvt_pk_bf16_f32 v187, v162, v163
    ds_write_b128 v11, v[184:187]
    v_rcp_f32 v34, v48
    v_mfma_f32_16x16x32_bf16 v[224:227], v[64:67], v[184:187], 0
    v_mfma_f32_16x16x32_bf16 v[228:231], v[80:83], v[184:187], 0
    v_subrev_u32 v30, 0x21800000, v48
    v_cmp_le_u32 vcc, s89, v30
    v_mov_b32 v35, v34
    s_cmp_eq_u32 s35, 63
    s_waitcnt lgkmcnt(0)
    s_cbranch_vccnz smx_fB
smok_fB:
    s_cbranch_scc1 last_fB
    s_barrier
    ds_read_b128 v[192:195], v15 offset:14336
    ds_read_b128 v[196:199], v15 offset:15360
    ds_read_b128 v[204:207], v15 offset:17408
    v_pk_mul_f32 v[156:157], v[156:157], v[34:35]
    v_pk_mul_f32 v[160:161], v[160:161], v[34:35]
    v_pk_mul_f32 v[158:159], v[158:159], v[34:35]
    v_pk_mul_f32 v[162:163], v[162:163], v[34:35]
    v_cvt_pk_bf16_f32 v184, v156, v157
    v_cvt_pk_bf16_f32 v185, v158, v159
    s_waitcnt lgkmcnt(2)
    v_mfma_f32_16x16x32_bf16 v[224:227], v[56:59], v[192:195], v[224:227]
    v_cvt_pk_bf16_f32 v186, v160, v161
    v_cvt_pk_bf16_f32 v187, v162, v163
    s_waitcnt lgkmcnt(1)
    v_mfma_f32_16x16x32_bf16 v[224:227], v[60:63], v[196:199], v[224:227]
    s_waitcnt lgkmcnt(0)
    v_mfma_f32_16x16x32_bf16 v[224:227], v[68:71], v[204:207], v[224:227]
    v_mfma_f32_16x16x32_bf16 v[228:231], v[72:75], v[192:195], v[228:231]
    v_mfma_f32_16x16x32_bf16 v[228:231], v[76:79], v[196:199], v[228:231]
    v_mfma_f32_16x16x32_bf16 v[228:231], v[84:87], v[204:207], v[228:231]
    v_pk_mul_f32 v[224:225], v[224:225], v[34:35]
    v_pk_mul_f32 v[226:227], v[226:227], v[34:35]
    v_cvt_pk_bf16_f32 v224, v224, v225
    v_cvt_pk_bf16_f32 v225, v226, v227
    s_nop 1
    v_min_u32_dpp v144, v224, v19 quad_perm:[0,1,2,3] row_mask:0xf bank_mask:0x3
    v_min_u32_dpp v145, v225, v19 quad_perm:[0,1,2,3] row_mask:0xf bank_mask:0x3
    v_pk_mul_f32 v[228:229], v[228:229], v[34:35]
    v_pk_mul_f32 v[230:231], v[230:231], v[34:35]
    v_cvt_pk_bf16_f32 v228, v228, v229
    v_cvt_pk_bf16_f32 v229, v230, v231
    s_nop 0
    v_min_u32_dpp v146, v228, v19 quad_perm:[0,1,2,3] row_mask:0xf bank_mask:0x3
    v_min_u32_dpp v147, v229, v19 quad_perm:[0,1,2,3] row_mask:0xf bank_mask:0x3
    buffer_store_dwordx4 v[144:147], v13, s[4:7], s40 offen sc1
    buffer_store_dwordx4 v[144:147], v12, s[4:7], s44 offen
    s_sleep 2
    s_add_u32 m0, s14, 24576
    s_add_u32 s42, s45, 8192
    buffer_load_dwordx4 v15, s[4:7], s45 offen sc1 lds
    buffer_load_dwordx4 v15, s[4:7], s45 offen offset:1024 sc1 lds
    buffer_load_dwordx4 v[136:139], v15, s[4:7], s42 offen sc1
    buffer_load_dwordx4 v[140:143], v15, s[4:7], s42 offen offset:1024 sc1
    s_add_u32 s45, s45, 786432
    s_sleep 3
    buffer_load_dwordx4 v[116:119], v24, s[4:7], s44 offen sc1
    buffer_load_dwordx4 v[104:107], v21, s[4:7], s40 offen sc1
    buffer_load_dwordx4 v[108:111], v22, s[4:7], s40 offen sc1
    buffer_load_dwordx4 v[112:115], v23, s[4:7], s40 offen sc1
    buffer_store_dwordx4 v[184:187], v14, s[4:7], s48 offen sc1
    s_add_u32 s48, s48, 262144
    s_waitcnt vmcnt(4)
    v_mfma_f32_16x16x32_bf16 v[156:159], a[240:243], v[116:119], 0
    v_max3_u32 v30, v116, v117, v118
    v_max_u32 v30, v30, v119
    s_waitcnt vmcnt(3)
    v_mfma_f32_16x16x32_bf16 v[156:159], a[240:243], v[104:107], v[156:159]
    v_max3_u32 v30, v30, v104, v105
    v_max3_u32 v30, v30, v106, v107
    s_waitcnt vmcnt(2)
    v_mfma_f32_16x16x32_bf16 v[156:159], a[240:243], v[108:111], v[156:159]
    v_max3_u32 v30, v30, v108, v109
    v_max3_u32 v30, v30, v110, v111
    s_waitcnt vmcnt(1)
    v_mfma_f32_16x16x32_bf16 v[156:159], a[240:243], v[112:115], v[156:159]
    v_max3_u32 v30, v30, v112, v113
    v_max3_u32 v30, v30, v114, v115
    v_cmp_eq_u32 vcc, -1, v30
    s_nop 3
    s_cbranch_vccnz x2s_fB
x2ok_fB:
    v_add_f32_dpp v160, v156, v156 row_ror:8 row_mask:0xf bank_mask:0xf
    v_add_f32_dpp v161, v157, v157 row_ror:8 row_mask:0xf bank_mask:0xf
    v_add_f32_dpp v162, v158, v158 row_ror:8 row_mask:0xf bank_mask:0xf
    v_add_f32_dpp v163, v159, v159 row_ror:8 row_mask:0xf bank_mask:0xf
    v_cvt_pk_bf16_f32 v30, v160, v161
    v_cvt_pk_bf16_f32 v31, v162, v163
    v_min_u32 v30, -2, v30
    v_min_u32 v31, -2, v31
    buffer_store_dwordx2 v[30:31], v29, s[4:7], s41 offen
    s_barrier
    s_add_u32 s46, s35, 1
    s_and_b32 s47, s46, 63
    s_and_b32 s46, s46, 3
    s_mul_i32 s38, s46, 40960
    s_add_u32 s38, s38, s50
    buffer_load_dwordx4 v[224:227], v2, s[4:7], s38 offen offset:0 sc1
    buffer_load_dwordx4 v[228:231], v2, s[4:7], s38 offen offset:1024 sc1
    v_readlane_b32 s40, v1, s47
    s_mul_i32 s44, s46, 327680
    s_add_u32 s44, s44, 4358144
    s_mul_i32 s39, s46, 262144
    s_add_u32 s39, s39, s51
    s_add_u32 s46, s46, 1
    s_and_b32 s46, s46, 3
    s_mul_i32 s41, s46, 40960
    s_add_u32 s41, s41, s50
    s_add_u32 s35, s35, 1
    s_sleep 1
    buffer_load_dwordx4 v[236:239], v2, s[4:7], s38 offen offset:0 sc1
    buffer_load_dwordx4 v[240:243], v2, s[4:7], s38 offen offset:1024 sc1
    s_branch loop_fB
last_fB:
    v_pk_mul_f32 v[156:157], v[156:157], v[34:35]
    v_pk_mul_f32 v[160:161], v[160:161], v[34:35]
    v_pk_mul_f32 v[158:159], v[158:159], v[34:35]
    v_pk_mul_f32 v[162:163], v[162:163], v[34:35]
    v_cvt_pk_bf16_f32 v184, v156, v157
    v_cvt_pk_bf16_f32 v185, v158, v159
    v_cvt_pk_bf16_f32 v186, v160, v161
    v_cvt_pk_bf16_f32 v187, v162, v163
    buffer_store_dwordx4 v[184:187], v14, s[4:7], s48 offen sc1
    s_add_u32 s48, s48, 262144
    s_waitcnt vmcnt(0)
    s_barrier
    s_endpgm
x3s_fB:
    buffer_load_dwordx4 v[224:227], v2, s[4:7], s38 offen offset:0 sc1
    buffer_load_dwordx4 v[228:231], v2, s[4:7], s38 offen offset:1024 sc1
    s_waitcnt vmcnt(3)
    ds_write_b128 v2, v[236:239] offset:0
    v_max3_u32 v30, v236, v237, v238
    v_max_u32 v30, v30, v239
    s_waitcnt vmcnt(2)
    ds_write_b128 v2, v[240:243] offset:1024
    v_max3_u32 v30, v30, v240, v241
    v_max3_u32 v30, v30, v242, v243
    v_cmp_eq_u32 vcc, -1, v30
    s_waitcnt lgkmcnt(0)
    s_cbranch_vccz x3ok_fB
    buffer_load_dwordx4 v[236:239], v2, s[4:7], s38 offen offset:0 sc1
    buffer_load_dwordx4 v[240:243], v2, s[4:7], s38 offen offset:1024 sc1
    s_waitcnt vmcnt(3)
    ds_write_b128 v2, v[224:227] offset:0
    v_max3_u32 v30, v224, v225, v226
    v_max_u32 v30, v30, v227
    s_waitcnt vmcnt(2)
    ds_write_b128 v2, v[228:231] offset:1024
    v_max3_u32 v30, v30, v228, v229
    v_max3_u32 v30, v30, v230, v231
    v_cmp_eq_u32 vcc, -1, v30
    s_waitcnt lgkmcnt(0)
    s_cbranch_vccz x3ok_fB
    s_sub_u32 s36, s36, 1
    s_cbranch_scc0 x3s_fB
    s_mov_b32 s46, 1
    s_branch chain_abort
qks_fB:
qkt_fB:
    buffer_load_dwordx4 v[248:251], v6, s[4:7], s39 offen sc1
    s_waitcnt vmcnt(1)
    ds_write_b128 v7, v[252:255]
    v_max3_u32 v30, v252, v253, v254
    v_max_u32 v30, v30, v255
    v_cmp_eq_u32 vcc, -1, v30
    s_waitcnt lgkmcnt(0)
    s_cbranch_vccz qkok_fB
    buffer_load_dwordx4 v[252:255], v6, s[4:7], s39 offen sc1
    s_waitcnt vmcnt(1)
    ds_write_b128 v7, v[248:251]
    v_max3_u32 v30, v248, v249, v250
    v_max_u32 v30, v30, v251
    v_cmp_eq_u32 vcc, -1, v30
    s_waitcnt lgkmcnt(0)
    s_cbranch_vccz qkok_fB
    s_sub_u32 s36, s36, 1
    s_cbranch_scc0 qkt_fB
    s_mov_b32 s46, 2
    s_branch chain_abort
pvs_fB:
pvt_fB:
    buffer_load_dwordx4 v[168:171], v10, s[4:7], s39 offen sc1
    s_waitcnt vmcnt(0)
    v_max3_u32 v32, v168, v169, v170
    v_max_u32 v32, v32, v171
    v_cmp_eq_u32 vcc, -1, v32
    s_cbranch_vccz pvok_fB
    s_sub_u32 s36, s36, 1
    s_cbranch_scc0 pvt_fB
    s_mov_b32 s46, 3
    s_branch chain_abort
smx_fB:
    v_mfma_f32_16x16x32_bf16 v[144:147], v[104:107], v[192:195], v[40:43]
    v_mfma_f32_16x16x32_bf16 v[144:147], v[108:111], v[196:199], v[144:147]
    v_mfma_f32_16x16x32_bf16 v[144:147], v[112:115], v[200:203], v[144:147]
    v_mfma_f32_16x16x32_bf16 v[144:147], v[116:119], v[204:207], v[144:147]
    v_mfma_f32_16x16x32_bf16 v[148:151], v[120:123], v[192:195], v[44:47]
    v_mfma_f32_16x16x32_bf16 v[148:151], v[124:127], v[196:199], v[148:151]
    v_mfma_f32_16x16x32_bf16 v[148:151], v[128:131], v[200:203], v[148:151]
    v_mfma_f32_16x16x32_bf16 v[148:151], v[132:135], v[204:207], v[148:151]
    v_mfma_f32_16x16x32_bf16 v[152:155], v[208:211], v[192:195], 0
    v_mfma_f32_16x16x32_bf16 v[152:155], v[212:215], v[196:199], v[152:155]
    v_mfma_f32_16x16x32_bf16 v[152:155], v[216:219], v[200:203], v[152:155]
    v_mfma_f32_16x16x32_bf16 v[152:155], v[220:223], v[204:207], v[152:155]
    s_nop 7
    v_max3_f32 v20, v144, v145, v146
    v_max3_f32 v20, v20, v147, v148
    v_max3_f32 v20, v20, v149, v150
    v_max3_f32 v20, v20, v151, v152
    v_max3_f32 v20, v20, v153, v154
    v_max_f32 v20, v20, v155
    v_mov_b32 v30, v20
    s_nop 1
    v_permlane16_swap_b32 v30, v20
    s_nop 0
    v_max_f32 v20, v20, v30
    v_mov_b32 v30, v20
    s_nop 1
    v_permlane32_swap_b32 v30, v20
    s_nop 0
    v_max_f32 v20, v20, v30
    v_sub_f32 v144, v144, v20
    v_sub_f32 v145, v145, v20
    v_sub_f32 v146, v146, v20
    v_sub_f32 v147, v147, v20
    v_sub_f32 v148, v148, v20
    v_sub_f32 v149, v149, v20
    v_sub_f32 v150, v150, v20
    v_sub_f32 v151, v151, v20
    v_sub_f32 v152, v152, v20
    v_sub_f32 v153, v153, v20
    v_sub_f32 v154, v154, v20
    v_sub_f32 v155, v155, v20
    v_exp_f32 v144, v144
    v_exp_f32 v145, v145
    v_exp_f32 v146, v146
    v_exp_f32 v147, v147
    v_exp_f32 v148, v148
    v_exp_f32 v149, v149
    v_exp_f32 v150, v150
    v_exp_f32 v151, v151
    v_exp_f32 v152, v152
    v_exp_f32 v153, v153
    v_exp_f32 v154, v154
    v_exp_f32 v155, v155
    s_nop 0
    v_cvt_pk_bf16_f32 v164, v144, v145
    v_cvt_pk_bf16_f32 v165, v146, v147
    v_cvt_pk_bf16_f32 v166, v148, v149
    v_cvt_pk_bf16_f32 v167, v150, v151
    v_cvt_pk_bf16_f32 v36, v152, v153
    v_cvt_pk_bf16_f32 v37, v154, v155
    s_nop 1
    v_mfma_f32_16x16x16_bf16 v[156:159], v[168:169], v[36:37], 0
    v_mfma_f32_16x16x16_bf16 v[160:163], v[170:171], v[36:37], 0
    v_mfma_f32_16x16x16_bf16 v[48:51], a[252:253], v[36:37], 0
    s_nop 5
    v_mfma_f32_16x16x32_bf16 v[156:159], v[136:139], v[164:167], v[156:159]
    v_mfma_f32_16x16x32_bf16 v[160:163], v[140:143], v[164:167], v[160:163]
    v_mfma_f32_16x16x32_bf16 v[48:51], a[244:247], v[164:167], v[48:51]
    s_nop 5
    v_cvt_pk_bf16_f32 v184, v156, v157
    v_cvt_pk_bf16_f32 v185, v158, v159
    v_cvt_pk_bf16_f32 v186, v160, v161
    v_cvt_pk_bf16_f32 v187, v162, v163
    ds_write_b128 v11, v[184:187]
    v_rcp_f32 v34, v48
    v_mfma_f32_16x16x32_bf16 v[224:227], v[64:67], v[184:187], 0
    v_mfma_f32_16x16x32_bf16 v[228:231], v[80:83], v[184:187], 0
    s_nop 0
    v_mov_b32 v35, v34
    s_cmp_eq_u32 s35, 63
    s_waitcnt lgkmcnt(0)
    s_branch smok_fB
x2s_fB:
x2t_fB:
    buffer_load_dwordx4 v[116:119], v24, s[4:7], s44 offen sc1
    buffer_load_dwordx4 v[104:107], v21, s[4:7], s40 offen sc1
    buffer_load_dwordx4 v[108:111], v22, s[4:7], s40 offen sc1
    buffer_load_dwordx4 v[112:115], v23, s[4:7], s40 offen sc1
    s_waitcnt vmcnt(3)
    v_mfma_f32_16x16x32_bf16 v[156:159], a[240:243], v[116:119], 0
    v_max3_u32 v30, v116, v117, v118
    v_max_u32 v30, v30, v119
    s_waitcnt vmcnt(2)
    v_mfma_f32_16x16x32_bf16 v[156:159], a[240:243], v[104:107], v[156:159]
    v_max3_u32 v30, v30, v104, v105
    v_max3_u32 v30, v30, v106, v107
    s_waitcnt vmcnt(1)
    v_mfma_f32_16x16x32_bf16 v[156:159], a[240:243], v[108:111], v[156:159]
    v_max3_u32 v30, v30, v108, v109
    v_max3_u32 v30, v30, v110, v111
    s_waitcnt vmcnt(0)
    v_mfma_f32_16x16x32_bf16 v[156:159], a[240:243], v[112:115], v[156:159]
    v_max3_u32 v30, v30, v112, v113
    v_max3_u32 v30, v30, v114, v115
    v_cmp_eq_u32 vcc, -1, v30
    s_nop 3
    s_cbranch_vccz x2ok_fB
    s_sub_u32 s36, s36, 1
    s_cbranch_scc0 x2t_fB
    s_mov_b32 s46, 4
    s_branch chain_abort
entry_fE:
    buffer_load_dwordx4 v[224:227], v2, s[4:7], s38 offen offset:0 sc1
    buffer_load_dwordx4 v[228:231], v2, s[4:7], s38 offen offset:1024 sc1
    buffer_load_dwordx4 v[232:235], v2, s[4:7], s38 offen offset:2048 sc1
    s_waitcnt vmcnt(0)
    buffer_load_dwordx4 v[236:239], v2, s[4:7], s38 offen offset:0 sc1
    buffer_load_dwordx4 v[240:243], v2, s[4:7], s38 offen offset:1024 sc1
    buffer_load_dwordx4 v[244:247], v2, s[4:7], s38 offen offset:2048 sc1
    s_branch loop_fE
.p2align 6
loop_fE:
    s_waitcnt vmcnt(5)
    ds_write_b128 v2, v[224:227] offset:0
    v_max3_u32 v30, v224, v225, v226
    v_max_u32 v30, v30, v227
    s_waitcnt vmcnt(4)
    ds_write_b128 v2, v[228:231] offset:1024
    v_max3_u32 v30, v30, v228, v229
    v_max3_u32 v30, v30, v230, v231
    s_waitcnt vmcnt(3)
    ds_write_b128 v2, v[232:235] offset:2048
    v_max3_u32 v30, v30, v232, v233
    v_max3_u32 v30, v30, v234, v235
    v_cmp_eq_u32 vcc, -1, v30
    s_waitcnt lgkmcnt(0)
    s_cbranch_vccnz x3s_fE
x3ok_fE:
    s_barrier
    ds_read_b128 v[192:195], v3 offset:0
    ds_read_b128 v[196:199], v3 offset:1024
    ds_read_b128 v[200:203], v3 offset:2048
    ds_read_b128 v[204:207], v3 offset:3072
    ds_read_b128 v[208:211], v3 offset:4096
    ds_read_b128 v[212:215], v3 offset:5120
    ds_read_b128 v[216:219], v3 offset:6144
    ds_read_b128 v[220:223], v3 offset:7168
    ds_read_b128 v[144:147], v3 offset:8192
    ds_read_b128 v[148:151], v3 offset:9216
p2c_fE:
    s_waitcnt lgkmcnt(9)
    v_mfma_f32_16x16x32_bf16 v[156:159], a[0:3], v[192:195], 0
    v_mfma_f32_16x16x32_bf16 v[160:163], a[4:7], v[192:195], 0
    s_waitcnt lgkmcnt(8)
    v_mfma_f32_16x16x32_bf16 v[156:159], a[8:11], v[196:199], v[156:159]
    v_mfma_f32_16x16x32_bf16 v[160:163], a[12:15], v[196:199], v[160:163]
    s_waitcnt lgkmcnt(7)
    v_mfma_f32_16x16x32_bf16 v[156:159], a[16:19], v[200:203], v[156:159]
    v_mfma_f32_16x16x32_bf16 v[160:163], a[20:23], v[200:203], v[160:163]
    s_waitcnt lgkmcnt(6)
    v_mfma_f32_16x16x32_bf16 v[156:159], a[24:27], v[204:207], v[156:159]
    v_mfma_f32_16x16x32_bf16 v[160:163], a[28:31], v[204:207], v[160:163]
    s_waitcnt lgkmcnt(5)
    v_mfma_f32_16x16x32_bf16 v[156:159], a[32:35], v[208:211], v[156:159]
    v_mfma_f32_16x16x32_bf16 v[160:163], a[36:39], v[208:211], v[160:163]
    s_waitcnt lgkmcnt(4)
    v_mfma_f32_16x16x32_bf16 v[156:159], a[40:43], v[212:215], v[156:159]
    v_mfma_f32_16x16x32_bf16 v[160:163], a[44:47], v[212:215], v[160:163]
    s_waitcnt lgkmcnt(3)
    v_mfma_f32_16x16x32_bf16 v[156:159], a[48:51], v[216:219], v[156:159]
    v_mfma_f32_16x16x32_bf16 v[160:163], a[52:55], v[216:219], v[160:163]
    s_waitcnt lgkmcnt(2)
    v_mfma_f32_16x16x32_bf16 v[156:159], a[56:59], v[220:223], v[156:159]
    v_mfma_f32_16x16x32_bf16 v[160:163], a[60:63], v[220:223], v[160:163]
    s_waitcnt lgkmcnt(1)
    v_mfma_f32_16x16x32_bf16 v[156:159], a[64:67], v[144:147], v[156:159]
    v_mfma_f32_16x16x32_bf16 v[160:163], a[68:71], v[144:147], v[160:163]
    s_waitcnt lgkmcnt(0)
    v_mfma_f32_16x16x32_bf16 v[156:159], a[72:75], v[148:151], v[156:159]
    v_mfma_f32_16x16x32_bf16 v[160:163], a[76:79], v[148:151], v[160:163]
    v_mfma_f32_16x16x32_bf16 v[52:55], v[192:195], a[80:83], 0
    v_mfma_f32_16x16x32_bf16 v[52:55], v[196:199], a[84:87], v[52:55]
    v_mfma_f32_16x16x32_bf16 v[52:55], v[200:203], a[88:91], v[52:55]
    v_add_f32_dpp v156, v160, v156 row_ror:8 row_mask:0xf bank_mask:0xf
    v_add_f32_dpp v157, v161, v157 row_ror:8 row_mask:0xf bank_mask:0xf
    v_add_f32_dpp v158, v162, v158 row_ror:8 row_mask:0xf bank_mask:0xf
    v_add_f32_dpp v159, v163, v159 row_ror:8 row_mask:0xf bank_mask:0xf
    v_pk_mul_f32 v[156:157], v[156:157], s[12:13]
    v_pk_mul_f32 v[158:159], v[158:159], s[12:13]
    v_cvt_pk_bf16_f32 v30, v156, v157
    v_cvt_pk_bf16_f32 v31, v158, v159
    v_min_u32 v30, -2, v30
    v_min_u32 v31, -2, v31
    buffer_store_dwordx2 v[30:31], v4, s[4:7], s39 offen
    v_mfma_f32_16x16x32_bf16 v[52:55], v[204:207], a[92:95], v[52:55]
    v_mfma_f32_16x16x32_bf16 v[52:55], v[208:211], a[96:99], v[52:55]
    v_mfma_f32_16x16x32_bf16 v[52:55], v[212:215], a[100:103], v[52:55]
    v_mfma_f32_16x16x32_bf16 v[52:55], v[216:219], a[104:107], v[52:55]
    v_mfma_f32_16x16x32_bf16 v[52:55], v[220:223], a[108:111], v[52:55]
    buffer_load_dwordx4 v[248:251], v6, s[4:7], s39 offen sc1
    v_mfma_f32_16x16x32_bf16 v[52:55], v[144:147], a[112:115], v[52:55]
    v_mfma_f32_16x16x32_bf16 v[52:55], v[148:151], a[116:119], v[52:55]
    ds_read_b128 v[104:107], v15 offset:24576
    ds_read_b128 v[108:111], v15 offset:25600
    ds_read_b128 v[112:115], v15 offset:26624
    ds_read_b128 v[116:119], v15 offset:27648
    ds_read_b128 v[120:123], v15 offset:28672
    ds_read_b128 v[124:127], v15 offset:29696
    ds_read_b128 v[128:131], v15 offset:30720
    ds_read_b128 v[132:135], v15 offset:31744
    v_cvt_pk_bf16_f32 v32, v52, v53
    v_cvt_pk_bf16_f32 v33, v54, v55
    v_min_u32 v32, -2, v32
    v_min_u32 v33, -2, v33
    buffer_store_dwordx2 v[32:33], v5, s[4:7], s39 offen
    s_add_u32 s47, s35, 3
    s_lshr_b32 s47, s47, 1
    s_cmp_lt_i32 s29, s47
    s_cbranch_scc1 qp_fE
qpok_fE:
    buffer_load_dwordx4 v[252:255], v6, s[4:7], s39 offen sc1
    s_waitcnt vmcnt(2)
    ds_write_b128 v7, v[248:251]
    v_max3_u32 v30, v248, v249, v250
    v_max_u32 v30, v30, v251
    v_cmp_eq_u32 vcc, -1, v30
    s_waitcnt lgkmcnt(0)
    s_cbranch_vccnz qks_fE
qkok_fE:
    buffer_load_dwordx4 v[168:171], v10, s[4:7], s39 offen sc1
    s_barrier
    ds_read_b128 v[192:195], v8 offset:0
    ds_read_b128 v[196:199], v8 offset:512
    ds_read_b128 v[200:203], v8 offset:1024
    ds_read_b128 v[204:207], v8 offset:1536
    ds_read_b128 v[208:211], v9 offset:0
    ds_read_b128 v[212:215], v9 offset:512
    ds_read_b128 v[216:219], v9 offset:1024
    ds_read_b128 v[220:223], v9 offset:1536
    s_waitcnt lgkmcnt(7)
    v_mfma_f32_16x16x32_bf16 v[144:147], v[104:107], v[192:195], v[40:43]
    s_waitcnt lgkmcnt(6)
    v_mfma_f32_16x16x32_bf16 v[144:147], v[108:111], v[196:199], v[144:147]
    s_waitcnt lgkmcnt(5)
    v_mfma_f32_16x16x32_bf16 v[144:147], v[112:115], v[200:203], v[144:147]
    s_waitcnt lgkmcnt(4)
    v_mfma_f32_16x16x32_bf16 v[144:147], v[116:119], v[204:207], v[144:147]
    s_waitcnt lgkmcnt(3)
    v_mfma_f32_16x16x32_bf16 v[152:155], v[208:211], v[192:195], 0
    s_waitcnt lgkmcnt(2)
    v_mfma_f32_16x16x32_bf16 v[152:155], v[212:215], v[196:199], v[152:155]
    s_waitcnt lgkmcnt(1)
    v_mfma_f32_16x16x32_bf16 v[152:155], v[216:219], v[200:203], v[152:155]
    v_exp_f32 v144, v144
    s_waitcnt lgkmcnt(0)
    v_mfma_f32_16x16x32_bf16 v[152:155], v[220:223], v[204:207], v[152:155]
    v_exp_f32 v145, v145
    v_mfma_f32_16x16x32_bf16 v[148:151], v[120:123], v[192:195], v[44:47]
    v_exp_f32 v146, v146
    v_mfma_f32_16x16x32_bf16 v[148:151], v[124:127], v[196:199], v[148:151]
    v_exp_f32 v147, v147
    v_mfma_f32_16x16x32_bf16 v[148:151], v[128:131], v[200:203], v[148:151]
    v_exp_f32 v152, v152
    v_mfma_f32_16x16x32_bf16 v[148:151], v[132:135], v[204:207], v[148:151]
    v_exp_f32 v153, v153
    v_exp_f32 v154, v154
    v_exp_f32 v155, v155
    s_waitcnt vmcnt(0)
    v_max3_u32 v32, v168, v169, v170
    v_max_u32 v32, v32, v171
    v_cmp_eq_u32 vcc, -1, v32
    v_cvt_pk_bf16_f32 v36, v152, v153
    v_cvt_pk_bf16_f32 v37, v154, v155
    v_exp_f32 v148, v148
    s_cbranch_vccnz pvs_fE
pvok_fE:
    v_mfma_f32_16x16x16_bf16 v[156:159], v[168:169], v[36:37], 0
    v_exp_f32 v149, v149
    buffer_load_dword v18, v25, s[4:7], s88 offen sc1
    v_mfma_f32_16x16x16_bf16 v[160:163], v[170:171], v[36:37], 0
    v_exp_f32 v150, v150
    v_mfma_f32_16x16x16_bf16 v[48:51], a[252:253], v[36:37], 0
    v_exp_f32 v151, v151
    v_cvt_pk_bf16_f32 v164, v144, v145
    v_cvt_pk_bf16_f32 v165, v146, v147
    v_cvt_pk_bf16_f32 v166, v148, v149
    v_cvt_pk_bf16_f32 v167, v150, v151
    s_nop 1
    v_mfma_f32_16x16x32_bf16 v[156:159], v[136:139], v[164:167], v[156:159]
    v_mfma_f32_16x16x32_bf16 v[160:163], v[140:143], v[164:167], v[160:163]
    v_mfma_f32_16x16x32_bf16 v[48:51], a[244:247], v[164:167], v[48:51]
    s_nop 5
    v_cvt_pk_bf16_f32 v184, v156, v157
    v_cvt_pk_bf16_f32 v185, v158, v159
    v_cvt_pk_bf16_f32 v186, v160, v161
    v_cvt_pk_bf16_f32 v187, v162, v163
    ds_write_b128 v11, v[184:187]
    v_rcp_f32 v34, v48
    v_mfma_f32_16x16x32_bf16 v[224:227], v[60:63], v[184:187], 0
    v_mfma_f32_16x16x32_bf16 v[228:231], v[76:79], v[184:187], 0
    v_mfma_f32_16x16x32_bf16 v[232:235], v[92:95], v[184:187], 0
    v_subrev_u32 v30, 0x21800000, v48
    v_cmp_le_u32 vcc, s89, v30
    v_mov_b32 v35, v34
    s_cmp_eq_u32 s35, 63
    s_waitcnt lgkmcnt(0)
    s_cbranch_vccnz smx_fE
smok_fE:
    s_cbranch_scc1 last_fE
    s_barrier
    ds_read_b128 v[192:195], v15 offset:14336
    ds_read_b128 v[200:203], v15 offset:16384
    ds_read_b128 v[204:207], v15 offset:17408
    v_pk_mul_f32 v[156:157], v[156:157], v[34:35]
    v_pk_mul_f32 v[160:161], v[160:161], v[34:35]
    v_pk_mul_f32 v[158:159], v[158:159], v[34:35]
    v_pk_mul_f32 v[162:163], v[162:163], v[34:35]
    v_cvt_pk_bf16_f32 v184, v156, v157
    v_cvt_pk_bf16_f32 v185, v158, v159
    s_waitcnt lgkmcnt(2)
    v_mfma_f32_16x16x32_bf16 v[232:235], v[88:91], v[192:195], v[232:235]
    v_cvt_pk_bf16_f32 v186, v160, v161
    v_cvt_pk_bf16_f32 v187, v162, v163
    s_waitcnt lgkmcnt(1)
    v_mfma_f32_16x16x32_bf16 v[232:235], v[96:99], v[200:203], v[232:235]
    s_waitcnt lgkmcnt(0)
    v_mfma_f32_16x16x32_bf16 v[232:235], v[100:103], v[204:207], v[232:235]
    v_mfma_f32_16x16x32_bf16 v[224:227], v[56:59], v[192:195], v[224:227]
    v_mfma_f32_16x16x32_bf16 v[224:227], v[64:67], v[200:203], v[224:227]
    v_mfma_f32_16x16x32_bf16 v[224:227], v[68:71], v[204:207], v[224:227]
    v_pk_mul_f32 v[232:233], v[232:233], v[34:35]
    v_pk_mul_f32 v[234:235], v[234:235], v[34:35]
    v_cvt_pk_bf16_f32 v232, v232, v233
    v_mfma_f32_16x16x32_bf16 v[228:231], v[72:75], v[192:195], v[228:231]
    v_cvt_pk_bf16_f32 v233, v234, v235
    s_nop 0
    v_min_u32_dpp v144, v232, v19 row_shr:8 row_mask:0xf bank_mask:0xc
    v_min_u32_dpp v145, v233, v19 row_shr:8 row_mask:0xf bank_mask:0xc
    v_mfma_f32_16x16x32_bf16 v[228:231], v[80:83], v[200:203], v[228:231]
    v_min_u32_dpp v146, v232, v19 row_shr:7 row_mask:0xf bank_mask:0xc
    v_min_u32_dpp v147, v233, v19 row_shr:7 row_mask:0xf bank_mask:0xc
    v_mfma_f32_16x16x32_bf16 v[228:231], v[84:87], v[204:207], v[228:231]
    v_pk_mul_f32 v[224:225], v[224:225], v[34:35]
    v_pk_mul_f32 v[226:227], v[226:227], v[34:35]
    v_cvt_pk_bf16_f32 v224, v224, v225
    v_cvt_pk_bf16_f32 v225, v226, v227
    s_nop 1
    v_min_u32_dpp v144, v224, v19 quad_perm:[0,1,2,3] row_mask:0xf bank_mask:0x3
    v_min_u32_dpp v145, v225, v19 quad_perm:[0,1,2,3] row_mask:0xf bank_mask:0x3
    v_pk_mul_f32 v[228:229], v[228:229], v[34:35]
    v_pk_mul_f32 v[230:231], v[230:231], v[34:35]
    v_cvt_pk_bf16_f32 v228, v228, v229
    v_cvt_pk_bf16_f32 v229, v230, v231
    s_nop 0
    v_min_u32_dpp v146, v228, v19 quad_perm:[0,1,2,3] row_mask:0xf bank_mask:0x3
    v_min_u32_dpp v147, v229, v19 quad_perm:[0,1,2,3] row_mask:0xf bank_mask:0x3
    buffer_store_dwordx4 v[144:147], v13, s[4:7], s40 offen sc1
    buffer_store_dwordx4 v[144:147], v12, s[4:7], s44 offen
    s_mov_b32 m0, 22528
    s_nop 0
    buffer_load_dwordx4 v15, s[4:7], s15 offen sc1 lds
    buffer_load_dwordx4 v15, s[4:7], s15 offen offset:1024 sc1 lds
    s_add_u32 s15, s15, 786432
    s_add_u32 m0, s14, 24576
    s_add_u32 s42, s45, 8192
    buffer_load_dwordx4 v15, s[4:7], s45 offen sc1 lds
    buffer_load_dwordx4 v15, s[4:7], s45 offen offset:1024 sc1 lds
    buffer_load_dwordx4 v[136:139], v15, s[4:7], s42 offen sc1
    buffer_load_dwordx4 v[140:143], v15, s[4:7], s42 offen offset:1024 sc1
    s_add_u32 s45, s45, 786432
    s_add_u32 s88, s88, 786432
    s_sleep 3
    buffer_load_dwordx4 v[116:119], v24, s[4:7], s44 offen sc1
    buffer_load_dwordx4 v[104:107], v21, s[4:7], s40 offen sc1
    buffer_load_dwordx4 v[108:111], v22, s[4:7], s40 offen sc1
    buffer_load_dwordx4 v[112:115], v23, s[4:7], s40 offen sc1
    buffer_store_dwordx4 v[184:187], v14, s[4:7], s48 offen sc1
    s_add_u32 s48, s48, 262144
    s_waitcnt vmcnt(4)
    v_mfma_f32_16x16x32_bf16 v[156:159], a[240:243], v[116:119], 0
    v_max3_u32 v30, v116, v117, v118
    v_max_u32 v30, v30, v119
    s_waitcnt vmcnt(3)
    v_mfma_f32_16x16x32_bf16 v[156:159], a[240:243], v[104:107], v[156:159]
    v_max3_u32 v30, v30, v104, v105
    v_max3_u32 v30, v30, v106, v107
    s_waitcnt vmcnt(2)
    v_mfma_f32_16x16x32_bf16 v[156:159], a[240:243], v[108:111], v[156:159]
    v_max3_u32 v30, v30, v108, v109
    v_max3_u32 v30, v30, v110, v111
    s_waitcnt vmcnt(1)
    v_mfma_f32_16x16x32_bf16 v[156:159], a[240:243], v[112:115], v[156:159]
    v_max3_u32 v30, v30, v112, v113
    v_max3_u32 v30, v30, v114, v115
    v_cmp_eq_u32 vcc, -1, v30
    s_nop 3
    s_cbranch_vccnz x2s_fE
x2ok_fE:
    v_add_f32_dpp v160, v156, v156 row_ror:8 row_mask:0xf bank_mask:0xf
    v_add_f32_dpp v161, v157, v157 row_ror:8 row_mask:0xf bank_mask:0xf
    v_add_f32_dpp v162, v158, v158 row_ror:8 row_mask:0xf bank_mask:0xf
    v_add_f32_dpp v163, v159, v159 row_ror:8 row_mask:0xf bank_mask:0xf
    v_cvt_pk_bf16_f32 v30, v160, v161
    v_cvt_pk_bf16_f32 v31, v162, v163
    v_min_u32 v30, -2, v30
    v_min_u32 v31, -2, v31
    buffer_store_dwordx2 v[30:31], v29, s[4:7], s41 offen
    s_barrier
    s_add_u32 s46, s35, 1
    s_and_b32 s47, s46, 63
    s_and_b32 s46, s46, 3
    s_mul_i32 s38, s46, 40960
    s_add_u32 s38, s38, s50
    buffer_load_dwordx4 v[224:227], v2, s[4:7], s38 offen offset:0 sc1
    buffer_load_dwordx4 v[228:231], v2, s[4:7], s38 offen offset:1024 sc1
    buffer_load_dwordx4 v[232:235], v2, s[4:7], s38 offen offset:2048 sc1
    v_readlane_b32 s40, v1, s47
    s_mul_i32 s44, s46, 327680
    s_add_u32 s44, s44, 4358144
    s_mul_i32 s39, s46, 262144
    s_add_u32 s39, s39, s51
    s_add_u32 s46, s46, 1
    s_and_b32 s46, s46, 3
    s_mul_i32 s41, s46, 40960
    s_add_u32 s41, s41, s50
    s_add_u32 s35, s35, 1
    s_sleep 1
    buffer_load_dwordx4 v[236:239], v2, s[4:7], s38 offen offset:0 sc1
    buffer_load_dwordx4 v[240:243], v2, s[4:7], s38 offen offset:1024 sc1
    buffer_load_dwordx4 v[244:247], v2, s[4:7], s38 offen offset:2048 sc1
    s_branch loop_fE
last_fE:
    v_pk_mul_f32 v[156:157], v[156:157], v[34:35]
    v_pk_mul_f32 v[160:161], v[160:161], v[34:35]
    v_pk_mul_f32 v[158:159], v[158:159], v[34:35]
    v_pk_mul_f32 v[162:163], v[162:163], v[34:35]
    v_cvt_pk_bf16_f32 v184, v156, v157
    v_cvt_pk_bf16_f32 v185, v158, v159
    v_cvt_pk_bf16_f32 v186, v160, v161
    v_cvt_pk_bf16_f32 v187, v162, v163
    buffer_store_dwordx4 v[184:187], v14, s[4:7], s48 offen sc1
    s_add_u32 s48, s48, 262144
    s_waitcnt vmcnt(0)
    s_barrier
    s_endpgm
x3s_fE:
    buffer_load_dwordx4 v[224:227], v2, s[4:7], s38 offen offset:0 sc1
    buffer_load_dwordx4 v[228:231], v2, s[4:7], s38 offen offset:1024 sc1
    buffer_load_dwordx4 v[232:235], v2, s[4:7], s38 offen offset:2048 sc1
    s_waitcnt vmcnt(5)
    ds_write_b128 v2, v[236:239] offset:0
    v_max3_u32 v30, v236, v237, v238
    v_max_u32 v30, v30, v239
    s_waitcnt vmcnt(4)
    ds_write_b128 v2, v[240:243] offset:1024
    v_max3_u32 v30, v30, v240, v241
    v_max3_u32 v30, v30, v242, v243
    s_waitcnt vmcnt(3)
    ds_write_b128 v2, v[244:247] offset:2048
    v_max3_u32 v30, v30, v244, v245
    v_max3_u32 v30, v30, v246, v247
    v_cmp_eq_u32 vcc, -1, v30
    s_waitcnt lgkmcnt(0)
    s_cbranch_vccz x3ok_fE
    buffer_load_dwordx4 v[236:239], v2, s[4:7], s38 offen offset:0 sc1
    buffer_load_dwordx4 v[240:243], v2, s[4:7], s38 offen offset:1024 sc1
    buffer_load_dwordx4 v[244:247], v2, s[4:7], s38 offen offset:2048 sc1
    s_waitcnt vmcnt(5)
    ds_write_b128 v2, v[224:227] offset:0
    v_max3_u32 v30, v224, v225, v226
    v_max_u32 v30, v30, v227
    s_waitcnt vmcnt(4)
    ds_write_b128 v2, v[228:231] offset:1024
    v_max3_u32 v30, v30, v228, v229
    v_max3_u32 v30, v30, v230, v231
    s_waitcnt vmcnt(3)
    ds_write_b128 v2, v[232:235] offset:2048
    v_max3_u32 v30, v30, v232, v233
    v_max3_u32 v30, v30, v234, v235
    v_cmp_eq_u32 vcc, -1, v30
    s_waitcnt lgkmcnt(0)
    s_cbranch_vccz x3ok_fE
    s_sub_u32 s36, s36, 1
    s_cbranch_scc0 x3s_fE
    s_mov_b32 s46, 1
    s_branch chain_abort
qp_fE:
    buffer_load_dword v30, v26, s[4:7], 0 offen sc1
    s_waitcnt vmcnt(0)
    v_min_i32_dpp v30, v30, v30 row_ror:2 row_mask:0xf bank_mask:0xf
    s_nop 1
    v_min_i32_dpp v30, v30, v30 row_ror:1 row_mask:0xf bank_mask:0xf
    s_nop 1
    v_readfirstlane_b32 s29, v30
    s_cmp_ge_i32 s29, s47
    s_cbranch_scc1 qpok_fE
    s_sub_u32 s36, s36, 1
    s_cbranch_scc0 qp_fE
    s_mov_b32 s46, 9
    s_branch chain_abort
qks_fE:
qkt_fE:
    buffer_load_dwordx4 v[248:251], v6, s[4:7], s39 offen sc1
    s_waitcnt vmcnt(1)
    ds_write_b128 v7, v[252:255]
    v_max3_u32 v30, v252, v253, v254
    v_max_u32 v30, v30, v255
    v_cmp_eq_u32 vcc, -1, v30
    s_waitcnt lgkmcnt(0)
    s_cbranch_vccz qkok_fE
    buffer_load_dwordx4 v[252:255], v6, s[4:7], s39 offen sc1
    s_waitcnt vmcnt(1)
    ds_write_b128 v7, v[248:251]
    v_max3_u32 v30, v248, v249, v250
    v_max_u32 v30, v30, v251
    v_cmp_eq_u32 vcc, -1, v30
    s_waitcnt lgkmcnt(0)
    s_cbranch_vccz qkok_fE
    s_sub_u32 s36, s36, 1
    s_cbranch_scc0 qkt_fE
    s_mov_b32 s46, 2
    s_branch chain_abort
pvs_fE:
pvt_fE:
    buffer_load_dwordx4 v[168:171], v10, s[4:7], s39 offen sc1
    s_waitcnt vmcnt(0)
    v_max3_u32 v32, v168, v169, v170
    v_max_u32 v32, v32, v171
    v_cmp_eq_u32 vcc, -1, v32
    s_cbranch_vccz pvok_fE
    s_sub_u32 s36, s36, 1
    s_cbranch_scc0 pvt_fE
    s_mov_b32 s46, 3
    s_branch chain_abort
smx_fE:
    v_mfma_f32_16x16x32_bf16 v[144:147], v[104:107], v[192:195], v[40:43]
    v_mfma_f32_16x16x32_bf16 v[144:147], v[108:111], v[196:199], v[144:147]
    v_mfma_f32_16x16x32_bf16 v[144:147], v[112:115], v[200:203], v[144:147]
    v_mfma_f32_16x16x32_bf16 v[144:147], v[116:119], v[204:207], v[144:147]
    v_mfma_f32_16x16x32_bf16 v[148:151], v[120:123], v[192:195], v[44:47]
    v_mfma_f32_16x16x32_bf16 v[148:151], v[124:127], v[196:199], v[148:151]
    v_mfma_f32_16x16x32_bf16 v[148:151], v[128:131], v[200:203], v[148:151]
    v_mfma_f32_16x16x32_bf16 v[148:151], v[132:135], v[204:207], v[148:151]
    v_mfma_f32_16x16x32_bf16 v[152:155], v[208:211], v[192:195], 0
    v_mfma_f32_16x16x32_bf16 v[152:155], v[212:215], v[196:199], v[152:155]
    v_mfma_f32_16x16x32_bf16 v[152:155], v[216:219], v[200:203], v[152:155]
    v_mfma_f32_16x16x32_bf16 v[152:155], v[220:223], v[204:207], v[152:155]
    s_nop 7
    v_max3_f32 v20, v144, v145, v146
    v_max3_f32 v20, v20, v147, v148
    v_max3_f32 v20, v20, v149, v150
    v_max3_f32 v20, v20, v151, v152
    v_max3_f32 v20, v20, v153, v154
    v_max_f32 v20, v20, v155
    v_mov_b32 v30, v20
    s_nop 1
    v_permlane16_swap_b32 v30, v20
    s_nop 0
    v_max_f32 v20, v20, v30
    v_mov_b32 v30, v20
    s_nop 1
    v_permlane32_swap_b32 v30, v20
    s_nop 0
    v_max_f32 v20, v20, v30
    v_sub_f32 v144, v144, v20
    v_sub_f32 v145, v145, v20
    v_sub_f32 v146, v146, v20
    v_sub_f32 v147, v147, v20
    v_sub_f32 v148, v148, v20
    v_sub_f32 v149, v149, v20
    v_sub_f32 v150, v150, v20
    v_sub_f32 v151, v151, v20
    v_sub_f32 v152, v152, v20
    v_sub_f32 v153, v153, v20
    v_sub_f32 v154, v154, v20
    v_sub_f32 v155, v155, v20
    v_exp_f32 v144, v144
    v_exp_f32 v145, v145
    v_exp_f32 v146, v146
    v_exp_f32 v147, v147
    v_exp_f32 v148, v148
    v_exp_f32 v149, v149
    v_exp_f32 v150, v150
    v_exp_f32 v151, v151
    v_exp_f32 v152, v152
    v_exp_f32 v153, v153
    v_exp_f32 v154, v154
    v_exp_f32 v155, v155
    s_nop 0
    v_cvt_pk_bf16_f32 v164, v144, v145
    v_cvt_pk_bf16_f32 v165, v146, v147
    v_cvt_pk_bf16_f32 v166, v148, v149
    v_cvt_pk_bf16_f32 v167, v150, v151
    v_cvt_pk_bf16_f32 v36, v152, v153
    v_cvt_pk_bf16_f32 v37, v154, v155
    s_nop 1
    v_mfma_f32_16x16x16_bf16 v[156:159], v[168:169], v[36:37], 0
    v_mfma_f32_16x16x16_bf16 v[160:163], v[170:171], v[36:37], 0
    v_mfma_f32_16x16x16_bf16 v[48:51], a[252:253], v[36:37], 0
    s_nop 5
    v_mfma_f32_16x16x32_bf16 v[156:159], v[136:139], v[164:167], v[156:159]
    v_mfma_f32_16x16x32_bf16 v[160:163], v[140:143], v[164:167], v[160:163]
    v_mfma_f32_16x16x32_bf16 v[48:51], a[244:247], v[164:167], v[48:51]
    s_nop 5
    v_cvt_pk_bf16_f32 v184, v156, v157
    v_cvt_pk_bf16_f32 v185, v158, v159
    v_cvt_pk_bf16_f32 v186, v160, v161
    v_cvt_pk_bf16_f32 v187, v162, v163
    ds_write_b128 v11, v[184:187]
    v_rcp_f32 v34, v48
    v_mfma_f32_16x16x32_bf16 v[224:227], v[60:63], v[184:187], 0
    v_mfma_f32_16x16x32_bf16 v[228:231], v[76:79], v[184:187], 0
    v_mfma_f32_16x16x32_bf16 v[232:235], v[92:95], v[184:187], 0
    s_nop 0
    v_mov_b32 v35, v34
    s_cmp_eq_u32 s35, 63
    s_waitcnt lgkmcnt(0)
    s_branch smok_fE
x2s_fE:
x2t_fE:
    buffer_load_dwordx4 v[116:119], v24, s[4:7], s44 offen sc1
    buffer_load_dwordx4 v[104:107], v21, s[4:7], s40 offen sc1
    buffer_load_dwordx4 v[108:111], v22, s[4:7], s40 offen sc1
    buffer_load_dwordx4 v[112:115], v23, s[4:7], s40 offen sc1
    s_waitcnt vmcnt(3)
    v_mfma_f32_16x16x32_bf16 v[156:159], a[240:243], v[116:119], 0
    v_max3_u32 v30, v116, v117, v118
    v_max_u32 v30, v30, v119
    s_waitcnt vmcnt(2)
    v_mfma_f32_16x16x32_bf16 v[156:159], a[240:243], v[104:107], v[156:159]
    v_max3_u32 v30, v30, v104, v105
    v_max3_u32 v30, v30, v106, v107
    s_waitcnt vmcnt(1)
    v_mfma_f32_16x16x32_bf16 v[156:159], a[240:243], v[108:111], v[156:159]
    v_max3_u32 v30, v30, v108, v109
    v_max3_u32 v30, v30, v110, v111
    s_waitcnt vmcnt(0)
    v_mfma_f32_16x16x32_bf16 v[156:159], a[240:243], v[112:115], v[156:159]
    v_max3_u32 v30, v30, v112, v113
    v_max3_u32 v30, v30, v114, v115
    v_cmp_eq_u32 vcc, -1, v30
    s_nop 3
    s_cbranch_vccz x2ok_fE
    s_sub_u32 s36, s36, 1
    s_cbranch_scc0 x2t_fE
    s_mov_b32 s46, 4
    s_branch chain_abort
entry_fC:
    buffer_load_dwordx4 v[224:227], v2, s[4:7], s38 offen offset:0 sc1
    buffer_load_dwordx4 v[228:231], v2, s[4:7], s38 offen offset:1024 sc1
    s_waitcnt vmcnt(0)
    buffer_load_dwordx4 v[236:239], v2, s[4:7], s38 offen offset:0 sc1
    buffer_load_dwordx4 v[240:243], v2, s[4:7], s38 offen offset:1024 sc1
    s_branch loop_fC
.p2align 6
loop_fC:
    s_waitcnt vmcnt(3)
    ds_write_b128 v2, v[224:227] offset:0
    v_max3_u32 v30, v224, v225, v226
    v_max_u32 v30, v30, v227
    s_waitcnt vmcnt(2)
    ds_write_b128 v2, v[228:231] offset:1024
    v_max3_u32 v30, v30, v228, v229
    v_max3_u32 v30, v30, v230, v231
    v_cmp_eq_u32 vcc, -1, v30
    s_waitcnt lgkmcnt(0)
    s_cbranch_vccnz x3s_fC
x3ok_fC:
    s_barrier
    ds_read_b128 v[192:195], v3 offset:0
    ds_read_b128 v[196:199], v3 offset:1024
    ds_read_b128 v[200:203], v3 offset:2048
    ds_read_b128 v[204:207], v3 offset:3072
    ds_read_b128 v[208:211], v3 offset:4096
    ds_read_b128 v[212:215], v3 offset:5120
    ds_read_b128 v[216:219], v3 offset:6144
    ds_read_b128 v[220:223], v3 offset:7168
    ds_read_b128 v[144:147], v3 offset:8192
    ds_read_b128 v[148:151], v3 offset:9216
p2c_fC:
    s_waitcnt lgkmcnt(9)
    v_mfma_f32_16x16x32_bf16 v[156:159], a[0:3], v[192:195], 0
    v_mfma_f32_16x16x32_bf16 v[160:163], a[4:7], v[192:195], 0
    s_waitcnt lgkmcnt(8)
    v_mfma_f32_16x16x32_bf16 v[156:159], a[8:11], v[196:199], v[156:159]
    v_mfma_f32_16x16x32_bf16 v[160:163], a[12:15], v[196:199], v[160:163]
    s_waitcnt lgkmcnt(7)
    v_mfma_f32_16x16x32_bf16 v[156:159], a[16:19], v[200:203], v[156:159]
    v_mfma_f32_16x16x32_bf16 v[160:163], a[20:23], v[200:203], v[160:163]
    s_waitcnt lgkmcnt(6)
    v_mfma_f32_16x16x32_bf16 v[156:159], a[24:27], v[204:207], v[156:159]
    v_mfma_f32_16x16x32_bf16 v[160:163], a[28:31], v[204:207], v[160:163]
    s_waitcnt lgkmcnt(5)
    v_mfma_f32_16x16x32_bf16 v[156:159], a[32:35], v[208:211], v[156:159]
    v_mfma_f32_16x16x32_bf16 v[160:163], a[36:39], v[208:211], v[160:163]
    s_waitcnt lgkmcnt(4)
    v_mfma_f32_16x16x32_bf16 v[156:159], a[40:43], v[212:215], v[156:159]
    v_mfma_f32_16x16x32_bf16 v[160:163], a[44:47], v[212:215], v[160:163]
    s_waitcnt lgkmcnt(3)
    v_mfma_f32_16x16x32_bf16 v[156:159], a[48:51], v[216:219], v[156:159]
    v_mfma_f32_16x16x32_bf16 v[160:163], a[52:55], v[216:219], v[160:163]
    s_waitcnt lgkmcnt(2)
    v_mfma_f32_16x16x32_bf16 v[156:159], a[56:59], v[220:223], v[156:159]
    v_mfma_f32_16x16x32_bf16 v[160:163], a[60:63], v[220:223], v[160:163]
    s_waitcnt lgkmcnt(1)
    v_mfma_f32_16x16x32_bf16 v[156:159], a[64:67], v[144:147], v[156:159]
    v_mfma_f32_16x16x32_bf16 v[160:163], a[68:71], v[144:147], v[160:163]
    s_waitcnt lgkmcnt(0)
    v_mfma_f32_16x16x32_bf16 v[156:159], a[72:75], v[148:151], v[156:159]
    v_mfma_f32_16x16x32_bf16 v[160:163], a[76:79], v[148:151], v[160:163]
    v_mfma_f32_16x16x32_bf16 v[52:55], v[192:195], a[80:83], 0
    v_mfma_f32_16x16x32_bf16 v[52:55], v[196:199], a[84:87], v[52:55]
    v_mfma_f32_16x16x32_bf16 v[52:55], v[200:203], a[88:91], v[52:55]
    v_add_f32_dpp v156, v160, v156 row_ror:8 row_mask:0xf bank_mask:0xf
    v_add_f32_dpp v157, v161, v157 row_ror:8 row_mask:0xf bank_mask:0xf
    v_add_f32_dpp v158, v162, v158 row_ror:8 row_mask:0xf bank_mask:0xf
    v_add_f32_dpp v159, v163, v159 row_ror:8 row_mask:0xf bank_mask:0xf
    v_cvt_pk_bf16_f32 v30, v156, v157
    v_cvt_pk_bf16_f32 v31, v158, v159
    v_min_u32 v30, -2, v30
    v_min_u32 v31, -2, v31
    buffer_store_dwordx2 v[30:31], v4, s[4:7], s39 offen
    v_mfma_f32_16x16x32_bf16 v[52:55], v[204:207], a[92:95], v[52:55]
    v_mfma_f32_16x16x32_bf16 v[52:55], v[208:211], a[96:99], v[52:55]
    v_mfma_f32_16x16x32_bf16 v[52:55], v[212:215], a[100:103], v[52:55]
    v_mfma_f32_16x16x32_bf16 v[52:55], v[216:219], a[104:107], v[52:55]
    v_mfma_f32_16x16x32_bf16 v[52:55], v[220:223], a[108:111], v[52:55]
    buffer_load_dwordx4 v[248:251], v6, s[4:7], s39 offen sc1
    v_mfma_f32_16x16x32_bf16 v[52:55], v[144:147], a[112:115], v[52:55]
    v_mfma_f32_16x16x32_bf16 v[52:55], v[148:151], a[116:119], v[52:55]
    ds_read_b128 v[104:107], v15 offset:24576
    ds_read_b128 v[108:111], v15 offset:25600
    ds_read_b128 v[112:115], v15 offset:26624
    ds_read_b128 v[116:119], v15 offset:27648
    ds_read_b128 v[120:123], v15 offset:28672
    ds_read_b128 v[124:127], v15 offset:29696
    ds_read_b128 v[128:131], v15 offset:30720
    ds_read_b128 v[132:135], v15 offset:31744
    v_cvt_pk_bf16_f32 v32, v52, v53
    v_cvt_pk_bf16_f32 v33, v54, v55
    v_min_u32 v32, -2, v32
    v_min_u32 v33, -2, v33
    buffer_store_dwordx2 v[32:33], v5, s[4:7], s39 offen
    buffer_load_dwordx4 v[252:255], v6, s[4:7], s39 offen sc1
    s_waitcnt vmcnt(2)
    ds_write_b128 v7, v[248:251]
    v_max3_u32 v30, v248, v249, v250
    v_max_u32 v30, v30, v251
    v_cmp_eq_u32 vcc, -1, v30
    s_waitcnt lgkmcnt(0)
    s_cbranch_vccnz qks_fC
qkok_fC:
    buffer_load_dwordx4 v[168:171], v10, s[4:7], s39 offen sc1
    s_barrier
    ds_read_b128 v[192:195], v8 offset:0
    ds_read_b128 v[196:199], v8 offset:512
    ds_read_b128 v[200:203], v8 offset:1024
    ds_read_b128 v[204:207], v8 offset:1536
    ds_read_b128 v[208:211], v9 offset:0
    ds_read_b128 v[212:215], v9 offset:512
    ds_read_b128 v[216:219], v9 offset:1024
    ds_read_b128 v[220:223], v9 offset:1536
    s_waitcnt lgkmcnt(7)
    v_mfma_f32_16x16x32_bf16 v[144:147], v[104:107], v[192:195], v[40:43]
    s_waitcnt lgkmcnt(6)
    v_mfma_f32_16x16x32_bf16 v[144:147], v[108:111], v[196:199], v[144:147]
    s_waitcnt lgkmcnt(5)
    v_mfma_f32_16x16x32_bf16 v[144:147], v[112:115], v[200:203], v[144:147]
    s_waitcnt lgkmcnt(4)
    v_mfma_f32_16x16x32_bf16 v[144:147], v[116:119], v[204:207], v[144:147]
    s_waitcnt lgkmcnt(3)
    v_mfma_f32_16x16x32_bf16 v[152:155], v[208:211], v[192:195], 0
    s_waitcnt lgkmcnt(2)
    v_mfma_f32_16x16x32_bf16 v[152:155], v[212:215], v[196:199], v[152:155]
    s_waitcnt lgkmcnt(1)
    v_mfma_f32_16x16x32_bf16 v[152:155], v[216:219], v[200:203], v[152:155]
    v_exp_f32 v144, v144
    s_waitcnt lgkmcnt(0)
    v_mfma_f32_16x16x32_bf16 v[152:155], v[220:223], v[204:207], v[152:155]
    v_exp_f32 v145, v145
    v_mfma_f32_16x16x32_bf16 v[148:151], v[120:123], v[192:195], v[44:47]
    v_exp_f32 v146, v146
    v_mfma_f32_16x16x32_bf16 v[148:151], v[124:127], v[196:199], v[148:151]
    v_exp_f32 v147, v147
    v_mfma_f32_16x16x32_bf16 v[148:151], v[128:131], v[200:203], v[148:151]
    v_exp_f32 v152, v152
    v_mfma_f32_16x16x32_bf16 v[148:151], v[132:135], v[204:207], v[148:151]
    v_exp_f32 v153, v153
    v_exp_f32 v154, v154
    v_exp_f32 v155, v155
    s_waitcnt vmcnt(0)
    v_max3_u32 v32, v168, v169, v170
    v_max_u32 v32, v32, v171
    v_cmp_eq_u32 vcc, -1, v32
    v_cvt_pk_bf16_f32 v36, v152, v153
    v_cvt_pk_bf16_f32 v37, v154, v155
    v_exp_f32 v148, v148
    s_cbranch_vccnz pvs_fC
pvok_fC:
    v_mfma_f32_16x16x16_bf16 v[156:159], v[168:169], v[36:37], 0
    v_exp_f32 v149, v149
    v_mfma_f32_16x16x16_bf16 v[160:163], v[170:171], v[36:37], 0
    v_exp_f32 v150, v150
    v_mfma_f32_16x16x16_bf16 v[48:51], a[252:253], v[36:37], 0
    v_exp_f32 v151, v151
    v_cvt_pk_bf16_f32 v164, v144, v145
    v_cvt_pk_bf16_f32 v165, v146, v147
    v_cvt_pk_bf16_f32 v166, v148, v149
    v_cvt_pk_bf16_f32 v167, v150, v151
    s_nop 1
    v_mfma_f32_16x16x32_bf16 v[156:159], v[136:139], v[164:167], v[156:159]
    v_mfma_f32_16x16x32_bf16 v[160:163], v[140:143], v[164:167], v[160:163]
    v_mfma_f32_16x16x32_bf16 v[48:51], a[244:247], v[164:167], v[48:51]
    s_nop 5
    v_cvt_pk_bf16_f32 v184, v156, v157
    v_cvt_pk_bf16_f32 v185, v158, v159
    v_cvt_pk_bf16_f32 v186, v160, v161
    v_cvt_pk_bf16_f32 v187, v162, v163
    ds_write_b128 v11, v[184:187]
    v_rcp_f32 v34, v48
    v_mfma_f32_16x16x32_bf16 v[224:227], v[68:71], v[184:187], 0
    v_mfma_f32_16x16x32_bf16 v[228:231], v[84:87], v[184:187], 0
    v_subrev_u32 v30, 0x21800000, v48
    v_cmp_le_u32 vcc, s89, v30
    v_mov_b32 v35, v34
    s_cmp_eq_u32 s35, 63
    s_waitcnt lgkmcnt(0)
    s_cbranch_vccnz smx_fC
smok_fC:
    s_cbranch_scc1 last_fC
    s_barrier
    ds_read_b128 v[192:195], v15 offset:14336
    ds_read_b128 v[196:199], v15 offset:15360
    ds_read_b128 v[200:203], v15 offset:16384
    v_pk_mul_f32 v[156:157], v[156:157], v[34:35]
    v_pk_mul_f32 v[160:161], v[160:161], v[34:35]
    v_pk_mul_f32 v[158:159], v[158:159], v[34:35]
    v_pk_mul_f32 v[162:163], v[162:163], v[34:35]
    v_cvt_pk_bf16_f32 v184, v156, v157
    v_cvt_pk_bf16_f32 v185, v158, v159
    s_waitcnt lgkmcnt(2)
    v_mfma_f32_16x16x32_bf16 v[224:227], v[56:59], v[192:195], v[224:227]
    v_cvt_pk_bf16_f32 v186, v160, v161
    v_cvt_pk_bf16_f32 v187, v162, v163
    s_waitcnt lgkmcnt(1)
    v_mfma_f32_16x16x32_bf16 v[224:227], v[60:63], v[196:199], v[224:227]
    s_waitcnt lgkmcnt(0)
    v_mfma_f32_16x16x32_bf16 v[224:227], v[64:67], v[200:203], v[224:227]
    v_mfma_f32_16x16x32_bf16 v[228:231], v[72:75], v[192:195], v[228:231]
    v_mfma_f32_16x16x32_bf16 v[228:231], v[76:79], v[196:199], v[228:231]
    v_mfma_f32_16x16x32_bf16 v[228:231], v[80:83], v[200:203], v[228:231]
    v_pk_mul_f32 v[224:225], v[224:225], v[34:35]
    v_pk_mul_f32 v[226:227], v[226:227], v[34:35]
    v_cvt_pk_bf16_f32 v224, v224, v225
    v_cvt_pk_bf16_f32 v225, v226, v227
    s_nop 1
    v_min_u32_dpp v144, v224, v19 quad_perm:[0,1,2,3] row_mask:0xf bank_mask:0x3
    v_min_u32_dpp v145, v225, v19 quad_perm:[0,1,2,3] row_mask:0xf bank_mask:0x3
    v_pk_mul_f32 v[228:229], v[228:229], v[34:35]
    v_pk_mul_f32 v[230:231], v[230:231], v[34:35]
    v_cvt_pk_bf16_f32 v228, v228, v229
    v_cvt_pk_bf16_f32 v229, v230, v231
    s_nop 0
    v_min_u32_dpp v146, v228, v19 quad_perm:[0,1,2,3] row_mask:0xf bank_mask:0x3
    v_min_u32_dpp v147, v229, v19 quad_perm:[0,1,2,3] row_mask:0xf bank_mask:0x3
    buffer_store_dwordx4 v[144:147], v13, s[4:7], s40 offen sc1
    buffer_store_dwordx4 v[144:147], v12, s[4:7], s44 offen
    s_sleep 2
    s_add_u32 m0, s14, 24576
    s_add_u32 s42, s45, 8192
    buffer_load_dwordx4 v15, s[4:7], s45 offen sc1 lds
    buffer_load_dwordx4 v15, s[4:7], s45 offen offset:1024 sc1 lds
    buffer_load_dwordx4 v[136:139], v15, s[4:7], s42 offen sc1
    buffer_load_dwordx4 v[140:143], v15, s[4:7], s42 offen offset:1024 sc1
    s_add_u32 s45, s45, 786432
    s_sleep 3
    buffer_load_dwordx4 v[116:119], v24, s[4:7], s44 offen sc1
    buffer_load_dwordx4 v[104:107], v21, s[4:7], s40 offen sc1
    buffer_load_dwordx4 v[108:111], v22, s[4:7], s40 offen sc1
    buffer_load_dwordx4 v[112:115], v23, s[4:7], s40 offen sc1
    buffer_store_dwordx4 v[184:187], v14, s[4:7], s48 offen sc1
    s_add_u32 s48, s48, 262144
    s_waitcnt vmcnt(4)
    v_mfma_f32_16x16x32_bf16 v[156:159], a[240:243], v[116:119], 0
    v_max3_u32 v30, v116, v117, v118
    v_max_u32 v30, v30, v119
    s_waitcnt vmcnt(3)
    v_mfma_f32_16x16x32_bf16 v[156:159], a[240:243], v[104:107], v[156:159]
    v_max3_u32 v30, v30, v104, v105
    v_max3_u32 v30, v30, v106, v107
    s_waitcnt vmcnt(2)
    v_mfma_f32_16x16x32_bf16 v[156:159], a[240:243], v[108:111], v[156:159]
    v_max3_u32 v30, v30, v108, v109
    v_max3_u32 v30, v30, v110, v111
    s_waitcnt vmcnt(1)
    v_mfma_f32_16x16x32_bf16 v[156:159], a[240:243], v[112:115], v[156:159]
    v_max3_u32 v30, v30, v112, v113
    v_max3_u32 v30, v30, v114, v115
    v_cmp_eq_u32 vcc, -1, v30
    s_nop 3
    s_cbranch_vccnz x2s_fC
x2ok_fC:
    v_add_f32_dpp v160, v156, v156 row_ror:8 row_mask:0xf bank_mask:0xf
    v_add_f32_dpp v161, v157, v157 row_ror:8 row_mask:0xf bank_mask:0xf
    v_add_f32_dpp v162, v158, v158 row_ror:8 row_mask:0xf bank_mask:0xf
    v_add_f32_dpp v163, v159, v159 row_ror:8 row_mask:0xf bank_mask:0xf
    v_cvt_pk_bf16_f32 v30, v160, v161
    v_cvt_pk_bf16_f32 v31, v162, v163
    v_min_u32 v30, -2, v30
    v_min_u32 v31, -2, v31
    buffer_store_dwordx2 v[30:31], v29, s[4:7], s41 offen
    s_barrier
    s_add_u32 s46, s35, 1
    s_and_b32 s47, s46, 63
    s_and_b32 s46, s46, 3
    s_mul_i32 s38, s46, 40960
    s_add_u32 s38, s38, s50
    buffer_load_dwordx4 v[224:227], v2, s[4:7], s38 offen offset:0 sc1
    buffer_load_dwordx4 v[228:231], v2, s[4:7], s38 offen offset:1024 sc1
    v_readlane_b32 s40, v1, s47
    s_mul_i32 s44, s46, 327680
    s_add_u32 s44, s44, 4358144
    s_mul_i32 s39, s46, 262144
    s_add_u32 s39, s39, s51
    s_add_u32 s46, s46, 1
    s_and_b32 s46, s46, 3
    s_mul_i32 s41, s46, 40960
    s_add_u32 s41, s41, s50
    s_add_u32 s35, s35, 1
    s_sleep 1
    buffer_load_dwordx4 v[236:239], v2, s[4:7], s38 offen offset:0 sc1
    buffer_load_dwordx4 v[240:243], v2, s[4:7], s38 offen offset:1024 sc1
    s_branch loop_fC
last_fC:
    v_pk_mul_f32 v[156:157], v[156:157], v[34:35]
    v_pk_mul_f32 v[160:161], v[160:161], v[34:35]
    v_pk_mul_f32 v[158:159], v[158:159], v[34:35]
    v_pk_mul_f32 v[162:163], v[162:163], v[34:35]
    v_cvt_pk_bf16_f32 v184, v156, v157
    v_cvt_pk_bf16_f32 v185, v158, v159
    v_cvt_pk_bf16_f32 v186, v160, v161
    v_cvt_pk_bf16_f32 v187, v162, v163
    buffer_store_dwordx4 v[184:187], v14, s[4:7], s48 offen sc1
    s_add_u32 s48, s48, 262144
    s_waitcnt vmcnt(0)
    s_barrier
    s_endpgm
x3s_fC:
    buffer_load_dwordx4 v[224:227], v2, s[4:7], s38 offen offset:0 sc1
    buffer_load_dwordx4 v[228:231], v2, s[4:7], s38 offen offset:1024 sc1
    s_waitcnt vmcnt(3)
    ds_write_b128 v2, v[236:239] offset:0
    v_max3_u32 v30, v236, v237, v238
    v_max_u32 v30, v30, v239
    s_waitcnt vmcnt(2)
    ds_write_b128 v2, v[240:243] offset:1024
    v_max3_u32 v30, v30, v240, v241
    v_max3_u32 v30, v30, v242, v243
    v_cmp_eq_u32 vcc, -1, v30
    s_waitcnt lgkmcnt(0)
    s_cbranch_vccz x3ok_fC
    buffer_load_dwordx4 v[236:239], v2, s[4:7], s38 offen offset:0 sc1
    buffer_load_dwordx4 v[240:243], v2, s[4:7], s38 offen offset:1024 sc1
    s_waitcnt vmcnt(3)
    ds_write_b128 v2, v[224:227] offset:0
    v_max3_u32 v30, v224, v225, v226
    v_max_u32 v30, v30, v227
    s_waitcnt vmcnt(2)
    ds_write_b128 v2, v[228:231] offset:1024
    v_max3_u32 v30, v30, v228, v229
    v_max3_u32 v30, v30, v230, v231
    v_cmp_eq_u32 vcc, -1, v30
    s_waitcnt lgkmcnt(0)
    s_cbranch_vccz x3ok_fC
    s_sub_u32 s36, s36, 1
    s_cbranch_scc0 x3s_fC
    s_mov_b32 s46, 1
    s_branch chain_abort
qks_fC:
qkt_fC:
    buffer_load_dwordx4 v[248:251], v6, s[4:7], s39 offen sc1
    s_waitcnt vmcnt(1)
    ds_write_b128 v7, v[252:255]
    v_max3_u32 v30, v252, v253, v254
    v_max_u32 v30, v30, v255
    v_cmp_eq_u32 vcc, -1, v30
    s_waitcnt lgkmcnt(0)
    s_cbranch_vccz qkok_fC
    buffer_load_dwordx4 v[252:255], v6, s[4:7], s39 offen sc1
    s_waitcnt vmcnt(1)
    ds_write_b128 v7, v[248:251]
    v_max3_u32 v30, v248, v249, v250
    v_max_u32 v30, v30, v251
    v_cmp_eq_u32 vcc, -1, v30
    s_waitcnt lgkmcnt(0)
    s_cbranch_vccz qkok_fC
    s_sub_u32 s36, s36, 1
    s_cbranch_scc0 qkt_fC
    s_mov_b32 s46, 2
    s_branch chain_abort
pvs_fC:
pvt_fC:
    buffer_load_dwordx4 v[168:171], v10, s[4:7], s39 offen sc1
    s_waitcnt vmcnt(0)
    v_max3_u32 v32, v168, v169, v170
    v_max_u32 v32, v32, v171
    v_cmp_eq_u32 vcc, -1, v32
    s_cbranch_vccz pvok_fC
    s_sub_u32 s36, s36, 1
    s_cbranch_scc0 pvt_fC
    s_mov_b32 s46, 3
    s_branch chain_abort
smx_fC:
    v_mfma_f32_16x16x32_bf16 v[144:147], v[104:107], v[192:195], v[40:43]
    v_mfma_f32_16x16x32_bf16 v[144:147], v[108:111], v[196:199], v[144:147]
    v_mfma_f32_16x16x32_bf16 v[144:147], v[112:115], v[200:203], v[144:147]
    v_mfma_f32_16x16x32_bf16 v[144:147], v[116:119], v[204:207], v[144:147]
    v_mfma_f32_16x16x32_bf16 v[148:151], v[120:123], v[192:195], v[44:47]
    v_mfma_f32_16x16x32_bf16 v[148:151], v[124:127], v[196:199], v[148:151]
    v_mfma_f32_16x16x32_bf16 v[148:151], v[128:131], v[200:203], v[148:151]
    v_mfma_f32_16x16x32_bf16 v[148:151], v[132:135], v[204:207], v[148:151]
    v_mfma_f32_16x16x32_bf16 v[152:155], v[208:211], v[192:195], 0
    v_mfma_f32_16x16x32_bf16 v[152:155], v[212:215], v[196:199], v[152:155]
    v_mfma_f32_16x16x32_bf16 v[152:155], v[216:219], v[200:203], v[152:155]
    v_mfma_f32_16x16x32_bf16 v[152:155], v[220:223], v[204:207], v[152:155]
    s_nop 7
    v_max3_f32 v20, v144, v145, v146
    v_max3_f32 v20, v20, v147, v148
    v_max3_f32 v20, v20, v149, v150
    v_max3_f32 v20, v20, v151, v152
    v_max3_f32 v20, v20, v153, v154
    v_max_f32 v20, v20, v155
    v_mov_b32 v30, v20
    s_nop 1
    v_permlane16_swap_b32 v30, v20
    s_nop 0
    v_max_f32 v20, v20, v30
    v_mov_b32 v30, v20
    s_nop 1
    v_permlane32_swap_b32 v30, v20
    s_nop 0
    v_max_f32 v20, v20, v30
    v_sub_f32 v144, v144, v20
    v_sub_f32 v145, v145, v20
    v_sub_f32 v146, v146, v20
    v_sub_f32 v147, v147, v20
    v_sub_f32 v148, v148, v20
    v_sub_f32 v149, v149, v20
    v_sub_f32 v150, v150, v20
    v_sub_f32 v151, v151, v20
    v_sub_f32 v152, v152, v20
    v_sub_f32 v153, v153, v20
    v_sub_f32 v154, v154, v20
    v_sub_f32 v155, v155, v20
    v_exp_f32 v144, v144
    v_exp_f32 v145, v145
    v_exp_f32 v146, v146
    v_exp_f32 v147, v147
    v_exp_f32 v148, v148
    v_exp_f32 v149, v149
    v_exp_f32 v150, v150
    v_exp_f32 v151, v151
    v_exp_f32 v152, v152
    v_exp_f32 v153, v153
    v_exp_f32 v154, v154
    v_exp_f32 v155, v155
    s_nop 0
    v_cvt_pk_bf16_f32 v164, v144, v145
    v_cvt_pk_bf16_f32 v165, v146, v147
    v_cvt_pk_bf16_f32 v166, v148, v149
    v_cvt_pk_bf16_f32 v167, v150, v151
    v_cvt_pk_bf16_f32 v36, v152, v153
    v_cvt_pk_bf16_f32 v37, v154, v155
    s_nop 1
    v_mfma_f32_16x16x16_bf16 v[156:159], v[168:169], v[36:37], 0
    v_mfma_f32_16x16x16_bf16 v[160:163], v[170:171], v[36:37], 0
    v_mfma_f32_16x16x16_bf16 v[48:51], a[252:253], v[36:37], 0
    s_nop 5
    v_mfma_f32_16x16x32_bf16 v[156:159], v[136:139], v[164:167], v[156:159]
    v_mfma_f32_16x16x32_bf16 v[160:163], v[140:143], v[164:167], v[160:163]
    v_mfma_f32_16x16x32_bf16 v[48:51], a[244:247], v[164:167], v[48:51]
    s_nop 5
    v_cvt_pk_bf16_f32 v184, v156, v157
    v_cvt_pk_bf16_f32 v185, v158, v159
    v_cvt_pk_bf16_f32 v186, v160, v161
    v_cvt_pk_bf16_f32 v187, v162, v163
    ds_write_b128 v11, v[184:187]
    v_rcp_f32 v34, v48
    v_mfma_f32_16x16x32_bf16 v[224:227], v[68:71], v[184:187], 0
    v_mfma_f32_16x16x32_bf16 v[228:231], v[84:87], v[184:187], 0
    s_nop 0
    v_mov_b32 v35, v34
    s_cmp_eq_u32 s35, 63
    s_waitcnt lgkmcnt(0)
    s_branch smok_fC
x2s_fC:
x2t_fC:
    buffer_load_dwordx4 v[116:119], v24, s[4:7], s44 offen sc1
    buffer_load_dwordx4 v[104:107], v21, s[4:7], s40 offen sc1
    buffer_load_dwordx4 v[108:111], v22, s[4:7], s40 offen sc1
    buffer_load_dwordx4 v[112:115], v23, s[4:7], s40 offen sc1
    s_waitcnt vmcnt(3)
    v_mfma_f32_16x16x32_bf16 v[156:159], a[240:243], v[116:119], 0
    v_max3_u32 v30, v116, v117, v118
    v_max_u32 v30, v30, v119
    s_waitcnt vmcnt(2)
    v_mfma_f32_16x16x32_bf16 v[156:159], a[240:243], v[104:107], v[156:159]
    v_max3_u32 v30, v30, v104, v105
    v_max3_u32 v30, v30, v106, v107
    s_waitcnt vmcnt(1)
    v_mfma_f32_16x16x32_bf16 v[156:159], a[240:243], v[108:111], v[156:159]
    v_max3_u32 v30, v30, v108, v109
    v_max3_u32 v30, v30, v110, v111
    s_waitcnt vmcnt(0)
    v_mfma_f32_16x16x32_bf16 v[156:159], a[240:243], v[112:115], v[156:159]
    v_max3_u32 v30, v30, v112, v113
    v_max3_u32 v30, v30, v114, v115
    v_cmp_eq_u32 vcc, -1, v30
    s_nop 3
    s_cbranch_vccz x2ok_fC
    s_sub_u32 s36, s36, 1
    s_cbranch_scc0 x2t_fC
    s_mov_b32 s46, 4
    s_branch chain_abort
entry_sD:
    buffer_load_dwordx4 v[224:227], v2, s[4:7], s38 offen offset:0 sc1
    buffer_load_dwordx4 v[228:231], v2, s[4:7], s38 offen offset:1024 sc1
    buffer_load_dwordx4 v[232:235], v2, s[4:7], s38 offen offset:2048 sc1
    s_waitcnt vmcnt(0)
    buffer_load_dwordx4 v[236:239], v2, s[4:7], s38 offen offset:0 sc1
    buffer_load_dwordx4 v[240:243], v2, s[4:7], s38 offen offset:1024 sc1
    buffer_load_dwordx4 v[244:247], v2, s[4:7], s38 offen offset:2048 sc1
    s_branch loop_sD
.p2align 6
loop_sD:
    s_waitcnt vmcnt(5)
    ds_write_b128 v2, v[224:227] offset:0
    v_max3_u32 v30, v224, v225, v226
    v_max_u32 v30, v30, v227
    s_waitcnt vmcnt(4)
    ds_write_b128 v2, v[228:231] offset:1024
    v_max3_u32 v30, v30, v228, v229
    v_max3_u32 v30, v30, v230, v231
    s_waitcnt vmcnt(3)
    ds_write_b128 v2, v[232:235] offset:2048
    v_max3_u32 v30, v30, v232, v233
    v_max3_u32 v30, v30, v234, v235
    v_cmp_eq_u32 vcc, -1, v30
    s_waitcnt lgkmcnt(0)
    s_cbranch_vccnz x3s_sD
x3ok_sD:
    s_barrier
    ds_read_b128 v[192:195], v3 offset:0
    ds_read_b128 v[196:199], v3 offset:1024
    ds_read_b128 v[200:203], v3 offset:2048
    ds_read_b128 v[204:207], v3 offset:3072
    ds_read_b128 v[208:211], v3 offset:4096
    ds_read_b128 v[212:215], v3 offset:5120
    ds_read_b128 v[216:219], v3 offset:6144
    ds_read_b128 v[220:223], v3 offset:7168
    ds_read_b128 v[144:147], v3 offset:8192
    ds_read_b128 v[148:151], v3 offset:9216
p2c_sD:
    s_waitcnt lgkmcnt(9)
    v_mfma_f32_16x16x32_bf16 v[156:159], a[0:3], v[192:195], 0
    v_mfma_f32_16x16x32_bf16 v[160:163], a[4:7], v[192:195], 0
    s_waitcnt lgkmcnt(8)
    v_mfma_f32_16x16x32_bf16 v[156:159], a[8:11], v[196:199], v[156:159]
    v_mfma_f32_16x16x32_bf16 v[160:163], a[12:15], v[196:199], v[160:163]
    s_waitcnt lgkmcnt(7)
    v_mfma_f32_16x16x32_bf16 v[156:159], a[16:19], v[200:203], v[156:159]
    v_mfma_f32_16x16x32_bf16 v[160:163], a[20:23], v[200:203], v[160:163]
    s_waitcnt lgkmcnt(6)
    v_mfma_f32_16x16x32_bf16 v[156:159], a[24:27], v[204:207], v[156:159]
    v_mfma_f32_16x16x32_bf16 v[160:163], a[28:31], v[204:207], v[160:163]
    s_waitcnt lgkmcnt(5)
    v_mfma_f32_16x16x32_bf16 v[156:159], a[32:35], v[208:211], v[156:159]
    v_mfma_f32_16x16x32_bf16 v[160:163], a[36:39], v[208:211], v[160:163]
    s_waitcnt lgkmcnt(4)
    v_mfma_f32_16x16x32_bf16 v[156:159], a[40:43], v[212:215], v[156:159]
    v_mfma_f32_16x16x32_bf16 v[160:163], a[44:47], v[212:215], v[160:163]
    s_waitcnt lgkmcnt(3)
    v_mfma_f32_16x16x32_bf16 v[156:159], a[48:51], v[216:219], v[156:159]
    v_mfma_f32_16x16x32_bf16 v[160:163], a[52:55], v[216:219], v[160:163]
    s_waitcnt lgkmcnt(2)
    v_mfma_f32_16x16x32_bf16 v[156:159], a[56:59], v[220:223], v[156:159]
    v_mfma_f32_16x16x32_bf16 v[160:163], a[60:63], v[220:223], v[160:163]
    s_waitcnt lgkmcnt(1)
    v_mfma_f32_16x16x32_bf16 v[156:159], a[64:67], v[144:147], v[156:159]
    v_mfma_f32_16x16x32_bf16 v[160:163], a[68:71], v[144:147], v[160:163]
    s_waitcnt lgkmcnt(0)
    v_mfma_f32_16x16x32_bf16 v[156:159], a[72:75], v[148:151], v[156:159]
    v_mfma_f32_16x16x32_bf16 v[160:163], a[76:79], v[148:151], v[160:163]
    v_mfma_f32_16x16x32_bf16 v[52:55], v[192:195], a[80:83], 0
    v_mfma_f32_16x16x32_bf16 v[52:55], v[196:199], a[84:87], v[52:55]
    v_mfma_f32_16x16x32_bf16 v[52:55], v[200:203], a[88:91], v[52:55]
    v_add_f32_dpp v156, v160, v156 row_ror:8 row_mask:0xf bank_mask:0xf
    v_add_f32_dpp v157, v161, v157 row_ror:8 row_mask:0xf bank_mask:0xf
    v_add_f32_dpp v158, v162, v158 row_ror:8 row_mask:0xf bank_mask:0xf
    v_add_f32_dpp v159, v163, v159 row_ror:8 row_mask:0xf bank_mask:0xf
    v_pk_mul_f32 v[156:157], v[156:157], s[12:13]
    v_pk_mul_f32 v[158:159], v[158:159], s[12:13]
    v_cvt_pk_bf16_f32 v30, v156, v157
    v_cvt_pk_bf16_f32 v31, v158, v159
    v_min_u32 v30, -2, v30
    v_min_u32 v31, -2, v31
    buffer_store_dwordx2 v[30:31], v4, s[4:7], s39 offen sc1
    v_mfma_f32_16x16x32_bf16 v[52:55], v[204:207], a[92:95], v[52:55]
    v_mfma_f32_16x16x32_bf16 v[52:55], v[208:211], a[96:99], v[52:55]
    v_mfma_f32_16x16x32_bf16 v[52:55], v[212:215], a[100:103], v[52:55]
    v_mfma_f32_16x16x32_bf16 v[52:55], v[216:219], a[104:107], v[52:55]
    v_mfma_f32_16x16x32_bf16 v[52:55], v[220:223], a[108:111], v[52:55]
    buffer_load_dwordx4 v[248:251], v6, s[4:7], s39 offen sc1
    v_mfma_f32_16x16x32_bf16 v[52:55], v[144:147], a[112:115], v[52:55]
    v_mfma_f32_16x16x32_bf16 v[52:55], v[148:151], a[116:119], v[52:55]
    ds_read_b128 v[104:107], v15 offset:24576
    ds_read_b128 v[108:111], v15 offset:25600
    ds_read_b128 v[112:115], v15 offset:26624
    ds_read_b128 v[116:119], v15 offset:27648
    ds_read_b128 v[120:123], v15 offset:28672
    ds_read_b128 v[124:127], v15 offset:29696
    ds_read_b128 v[128:131], v15 offset:30720
    ds_read_b128 v[132:135], v15 offset:31744
    v_cvt_pk_bf16_f32 v32, v52, v53
    v_cvt_pk_bf16_f32 v33, v54, v55
    v_min_u32 v32, -2, v32
    v_min_u32 v33, -2, v33
    buffer_store_dwordx2 v[32:33], v5, s[4:7], s39 offen sc1
    buffer_load_dwordx4 v[252:255], v6, s[4:7], s39 offen sc1
    s_waitcnt vmcnt(2)
    ds_write_b128 v7, v[248:251]
    v_max3_u32 v30, v248, v249, v250
    v_max_u32 v30, v30, v251
    v_cmp_eq_u32 vcc, -1, v30
    s_waitcnt lgkmcnt(0)
    s_cbranch_vccnz qks_sD
qkok_sD:
    buffer_load_dwordx4 v[168:171], v10, s[4:7], s39 offen sc1
    s_barrier
    ds_read_b128 v[192:195], v8 offset:0
    ds_read_b128 v[196:199], v8 offset:512
    ds_read_b128 v[200:203], v8 offset:1024
    ds_read_b128 v[204:207], v8 offset:1536
    ds_read_b128 v[208:211], v9 offset:0
    ds_read_b128 v[212:215], v9 offset:512
    ds_read_b128 v[216:219], v9 offset:1024
    ds_read_b128 v[220:223], v9 offset:1536
    s_waitcnt lgkmcnt(7)
    v_mfma_f32_16x16x32_bf16 v[144:147], v[104:107], v[192:195], v[40:43]
    s_waitcnt lgkmcnt(6)
    v_mfma_f32_16x16x32_bf16 v[144:147], v[108:111], v[196:199], v[144:147]
    s_waitcnt lgkmcnt(5)
    v_mfma_f32_16x16x32_bf16 v[144:147], v[112:115], v[200:203], v[144:147]
    s_waitcnt lgkmcnt(4)
    v_mfma_f32_16x16x32_bf16 v[144:147], v[116:119], v[204:207], v[144:147]
    s_waitcnt lgkmcnt(3)
    v_mfma_f32_16x16x32_bf16 v[152:155], v[208:211], v[192:195], 0
    s_waitcnt lgkmcnt(2)
    v_mfma_f32_16x16x32_bf16 v[152:155], v[212:215], v[196:199], v[152:155]
    s_waitcnt lgkmcnt(1)
    v_mfma_f32_16x16x32_bf16 v[152:155], v[216:219], v[200:203], v[152:155]
    v_exp_f32 v144, v144
    s_waitcnt lgkmcnt(0)
    v_mfma_f32_16x16x32_bf16 v[152:155], v[220:223], v[204:207], v[152:155]
    v_exp_f32 v145, v145
    v_mfma_f32_16x16x32_bf16 v[148:151], v[120:123], v[192:195], v[44:47]
    v_exp_f32 v146, v146
    v_mfma_f32_16x16x32_bf16 v[148:151], v[124:127], v[196:199], v[148:151]
    v_exp_f32 v147, v147
    v_mfma_f32_16x16x32_bf16 v[148:151], v[128:131], v[200:203], v[148:151]
    v_exp_f32 v152, v152
    v_mfma_f32_16x16x32_bf16 v[148:151], v[132:135], v[204:207], v[148:151]
    v_exp_f32 v153, v153
    v_exp_f32 v154, v154
    v_exp_f32 v155, v155
    s_waitcnt vmcnt(0)
    v_max3_u32 v32, v168, v169, v170
    v_max_u32 v32, v32, v171
    v_cmp_eq_u32 vcc, -1, v32
    v_cvt_pk_bf16_f32 v36, v152, v153
    v_cvt_pk_bf16_f32 v37, v154, v155
    v_exp_f32 v148, v148
    s_cbranch_vccnz pvs_sD
pvok_sD:
    v_mfma_f32_16x16x16_bf16 v[156:159], v[168:169], v[36:37], 0
    v_exp_f32 v149, v149
    buffer_load_dword v18, v27, s[4:7], s37 offen sc1
    v_mfma_f32_16x16x16_bf16 v[160:163], v[170:171], v[36:37], 0
    v_exp_f32 v150, v150
    v_mfma_f32_16x16x16_bf16 v[48:51], a[252:253], v[36:37], 0
    v_exp_f32 v151, v151
    v_cvt_pk_bf16_f32 v164, v144, v145
    v_cvt_pk_bf16_f32 v165, v146, v147
    v_cvt_pk_bf16_f32 v166, v148, v149
    v_cvt_pk_bf16_f32 v167, v150, v151
    s_nop 1
    v_mfma_f32_16x16x32_bf16 v[156:159], v[136:139], v[164:167], v[156:159]
    v_mfma_f32_16x16x32_bf16 v[160:163], v[140:143], v[164:167], v[160:163]
    v_mfma_f32_16x16x32_bf16 v[48:51], a[244:247], v[164:167], v[48:51]
    s_nop 5
    v_cvt_pk_bf16_f32 v184, v156, v157
    v_cvt_pk_bf16_f32 v185, v158, v159
    v_cvt_pk_bf16_f32 v186, v160, v161
    v_cvt_pk_bf16_f32 v187, v162, v163
    ds_write_b128 v11, v[184:187]
    v_rcp_f32 v34, v48
    v_mfma_f32_16x16x32_bf16 v[224:227], v[56:59], v[184:187], 0
    v_mfma_f32_16x16x32_bf16 v[228:231], v[72:75], v[184:187], 0
    v_mfma_f32_16x16x32_bf16 v[232:235], v[88:91], v[184:187], 0
    v_subrev_u32 v30, 0x21800000, v48
    v_cmp_le_u32 vcc, s89, v30
    v_mov_b32 v35, v34
    s_cmp_eq_u32 s35, 63
    s_waitcnt lgkmcnt(0)
    s_cbranch_vccnz smx_sD
smok_sD:
    s_cbranch_scc1 last_sD
    s_barrier
    ds_read_b128 v[196:199], v15 offset:15360
    ds_read_b128 v[200:203], v15 offset:16384
    ds_read_b128 v[204:207], v15 offset:17408
    v_pk_mul_f32 v[156:157], v[156:157], v[34:35]
    v_pk_mul_f32 v[160:161], v[160:161], v[34:35]
    v_pk_mul_f32 v[158:159], v[158:159], v[34:35]
    v_pk_mul_f32 v[162:163], v[162:163], v[34:35]
    v_cvt_pk_bf16_f32 v184, v156, v157
    v_cvt_pk_bf16_f32 v185, v158, v159
    s_waitcnt lgkmcnt(2)
    v_mfma_f32_16x16x32_bf16 v[232:235], v[92:95], v[196:199], v[232:235]
    v_cvt_pk_bf16_f32 v186, v160, v161
    v_cvt_pk_bf16_f32 v187, v162, v163
    s_waitcnt lgkmcnt(1)
    v_mfma_f32_16x16x32_bf16 v[232:235], v[96:99], v[200:203], v[232:235]
    s_waitcnt lgkmcnt(0)
    v_mfma_f32_16x16x32_bf16 v[232:235], v[100:103], v[204:207], v[232:235]
    v_mfma_f32_16x16x32_bf16 v[224:227], v[60:63], v[196:199], v[224:227]
    v_mfma_f32_16x16x32_bf16 v[224:227], v[64:67], v[200:203], v[224:227]
    v_mfma_f32_16x16x32_bf16 v[224:227], v[68:71], v[204:207], v[224:227]
    v_pk_mul_f32 v[232:233], v[232:233], v[34:35]
    v_pk_mul_f32 v[234:235], v[234:235], v[34:35]
    v_cvt_pk_bf16_f32 v232, v232, v233
    v_mfma_f32_16x16x32_bf16 v[228:231], v[76:79], v[196:199], v[228:231]
    v_cvt_pk_bf16_f32 v233, v234, v235
    s_nop 0
    v_min_u32_dpp v144, v232, v19 row_shr:8 row_mask:0xf bank_mask:0xc
    v_min_u32_dpp v145, v233, v19 row_shr:8 row_mask:0xf bank_mask:0xc
    v_mfma_f32_16x16x32_bf16 v[228:231], v[80:83], v[200:203], v[228:231]
    v_min_u32_dpp v146, v232, v19 row_shr:7 row_mask:0xf bank_mask:0xc
    v_min_u32_dpp v147, v233, v19 row_shr:7 row_mask:0xf bank_mask:0xc
    v_mfma_f32_16x16x32_bf16 v[228:231], v[84:87], v[204:207], v[228:231]
    v_pk_mul_f32 v[224:225], v[224:225], v[34:35]
    v_pk_mul_f32 v[226:227], v[226:227], v[34:35]
    v_cvt_pk_bf16_f32 v224, v224, v225
    v_cvt_pk_bf16_f32 v225, v226, v227
    s_nop 1
    v_min_u32_dpp v144, v224, v19 quad_perm:[0,1,2,3] row_mask:0xf bank_mask:0x3
    v_min_u32_dpp v145, v225, v19 quad_perm:[0,1,2,3] row_mask:0xf bank_mask:0x3
    v_pk_mul_f32 v[228:229], v[228:229], v[34:35]
    v_pk_mul_f32 v[230:231], v[230:231], v[34:35]
    v_cvt_pk_bf16_f32 v228, v228, v229
    v_cvt_pk_bf16_f32 v229, v230, v231
    s_nop 0
    v_min_u32_dpp v146, v228, v19 quad_perm:[0,1,2,3] row_mask:0xf bank_mask:0x3
    v_min_u32_dpp v147, v229, v19 quad_perm:[0,1,2,3] row_mask:0xf bank_mask:0x3
    buffer_store_dwordx4 v[144:147], v13, s[4:7], s40 offen sc1
    buffer_store_dwordx4 v[144:147], v12, s[4:7], s44 offen sc1
    s_cmp_eq_u32 s35, s90
    s_cbranch_scc1 z1_sD
z1ok_sD:
    s_add_u32 m0, s14, 24576
    s_add_u32 s42, s45, 8192
    buffer_load_dwordx4 v15, s[4:7], s45 offen sc1 lds
    buffer_load_dwordx4 v15, s[4:7], s45 offen offset:1024 sc1 lds
    buffer_load_dwordx4 v[136:139], v15, s[4:7], s42 offen sc1
    buffer_load_dwordx4 v[140:143], v15, s[4:7], s42 offen offset:1024 sc1
    s_add_u32 s45, s45, 786432
    buffer_store_dwordx4 v[184:187], v14, s[4:7], s48 offen sc1
    s_add_u32 s48, s48, 262144
    s_add_u32 s55, s35, 2
    s_and_b32 s55, s55, 3
    s_mul_i32 s46, s55, 327680
    s_add_u32 s46, s46, 4358144
    buffer_store_dwordx4 v[188:191], v21, s[4:7], s46 offen sc1
    s_add_u32 s46, s46, 32768
    buffer_store_dwordx4 v[188:191], v21, s[4:7], s46 offen sc1
    s_add_u32 s46, s46, 32768
    buffer_store_dwordx4 v[188:191], v22, s[4:7], s46 offen sc1
    s_mul_i32 s47, s55, 262144
    s_add_u32 s47, s47, s51
    buffer_store_dwordx4 v[188:191], v23, s[4:7], s47 offen sc1
    buffer_store_dwordx4 v[188:191], v23, s[4:7], s47 offen offset:1024 sc1
    s_add_u32 s55, s55, 1
    s_and_b32 s55, s55, 3
    s_mul_i32 s47, s55, 40960
    s_add_u32 s47, s47, s50
    buffer_store_dwordx4 v[188:191], v24, s[4:7], s47 offen sc1
    s_add_u32 s46, s35, 5
    s_min_u32 s46, s46, 63
    v_readlane_b32 s37, v1, s46
    s_xor_b32 s37, s37, 8192
    s_lshl_b32 s46, s35, 7
    s_add_u32 s46, s46, 5676800
    buffer_store_dword v19, v26, s[4:7], s46 offen sc1
    s_add_u32 s46, s35, 1
    s_and_b32 s47, s46, 63
    s_and_b32 s46, s46, 3
    s_mul_i32 s38, s46, 40960
    s_add_u32 s38, s38, s50
    v_readlane_b32 s40, v1, s47
    s_mul_i32 s44, s46, 327680
    s_add_u32 s44, s44, 4358144
    s_mul_i32 s39, s46, 262144
    s_add_u32 s39, s39, s51
    s_add_u32 s46, s46, 1
    s_and_b32 s46, s46, 3
    s_mul_i32 s41, s46, 40960
    s_add_u32 s41, s41, s50
    s_barrier
    buffer_load_dwordx4 v[224:227], v2, s[4:7], s38 offen offset:0 sc1
    buffer_load_dwordx4 v[228:231], v2, s[4:7], s38 offen offset:1024 sc1
    buffer_load_dwordx4 v[232:235], v2, s[4:7], s38 offen offset:2048 sc1
    s_add_u32 s35, s35, 1
    s_sleep 1
    buffer_load_dwordx4 v[236:239], v2, s[4:7], s38 offen offset:0 sc1
    buffer_load_dwordx4 v[240:243], v2, s[4:7], s38 offen offset:1024 sc1
    buffer_load_dwordx4 v[244:247], v2, s[4:7], s38 offen offset:2048 sc1
    s_branch loop_sD
last_sD:
    v_pk_mul_f32 v[156:157], v[156:157], v[34:35]
    v_pk_mul_f32 v[160:161], v[160:161], v[34:35]
    v_pk_mul_f32 v[158:159], v[158:159], v[34:35]
    v_pk_mul_f32 v[162:163], v[162:163], v[34:35]
    v_cvt_pk_bf16_f32 v184, v156, v157
    v_cvt_pk_bf16_f32 v185, v158, v159
    v_cvt_pk_bf16_f32 v186, v160, v161
    v_cvt_pk_bf16_f32 v187, v162, v163
    buffer_store_dwordx4 v[184:187], v14, s[4:7], s48 offen sc1
    s_add_u32 s48, s48, 262144
    s_mov_b32 s46, 5684864
    buffer_store_dword v19, v26, s[4:7], s46 offen sc1
    s_waitcnt vmcnt(0)
    s_barrier
    s_lshl_b32 s46, s31, 5
    s_add_u32 s46, s46, s32
    s_lshl_b32 s46, s46, 2
    s_add_u32 s46, s46, 5669888
    v_cmp_eq_u32 vcc, 0, v15
    v_mov_b32 v30, 0x40000000
    s_nop 1
    v_cndmask_b32 v30, v30, 0, vcc
    buffer_store_dword v19, v30, s[4:7], s46 offen sc1
    s_endpgm
x3s_sD:
    buffer_load_dwordx4 v[224:227], v2, s[4:7], s38 offen offset:0 sc1
    buffer_load_dwordx4 v[228:231], v2, s[4:7], s38 offen offset:1024 sc1
    buffer_load_dwordx4 v[232:235], v2, s[4:7], s38 offen offset:2048 sc1
    s_waitcnt vmcnt(5)
    ds_write_b128 v2, v[236:239] offset:0
    v_max3_u32 v30, v236, v237, v238
    v_max_u32 v30, v30, v239
    s_waitcnt vmcnt(4)
    ds_write_b128 v2, v[240:243] offset:1024
    v_max3_u32 v30, v30, v240, v241
    v_max3_u32 v30, v30, v242, v243
    s_waitcnt vmcnt(3)
    ds_write_b128 v2, v[244:247] offset:2048
    v_max3_u32 v30, v30, v244, v245
    v_max3_u32 v30, v30, v246, v247
    v_cmp_eq_u32 vcc, -1, v30
    s_waitcnt lgkmcnt(0)
    s_cbranch_vccz x3ok_sD
    buffer_load_dwordx4 v[236:239], v2, s[4:7], s38 offen offset:0 sc1
    buffer_load_dwordx4 v[240:243], v2, s[4:7], s38 offen offset:1024 sc1
    buffer_load_dwordx4 v[244:247], v2, s[4:7], s38 offen offset:2048 sc1
    s_waitcnt vmcnt(5)
    ds_write_b128 v2, v[224:227] offset:0
    v_max3_u32 v30, v224, v225, v226
    v_max_u32 v30, v30, v227
    s_waitcnt vmcnt(4)
    ds_write_b128 v2, v[228:231] offset:1024
    v_max3_u32 v30, v30, v228, v229
    v_max3_u32 v30, v30, v230, v231
    s_waitcnt vmcnt(3)
    ds_write_b128 v2, v[232:235] offset:2048
    v_max3_u32 v30, v30, v232, v233
    v_max3_u32 v30, v30, v234, v235
    v_cmp_eq_u32 vcc, -1, v30
    s_waitcnt lgkmcnt(0)
    s_cbranch_vccz x3ok_sD
    s_sub_u32 s36, s36, 1
    s_cbranch_scc0 x3s_sD
    s_mov_b32 s46, 1
    s_branch chain_abort
qks_sD:
qkt_sD:
    buffer_load_dwordx4 v[248:251], v6, s[4:7], s39 offen sc1
    s_waitcnt vmcnt(1)
    ds_write_b128 v7, v[252:255]
    v_max3_u32 v30, v252, v253, v254
    v_max_u32 v30, v30, v255
    v_cmp_eq_u32 vcc, -1, v30
    s_waitcnt lgkmcnt(0)
    s_cbranch_vccz qkok_sD
    buffer_load_dwordx4 v[252:255], v6, s[4:7], s39 offen sc1
    s_waitcnt vmcnt(1)
    ds_write_b128 v7, v[248:251]
    v_max3_u32 v30, v248, v249, v250
    v_max_u32 v30, v30, v251
    v_cmp_eq_u32 vcc, -1, v30
    s_waitcnt lgkmcnt(0)
    s_cbranch_vccz qkok_sD
    s_sub_u32 s36, s36, 1
    s_cbranch_scc0 qkt_sD
    s_mov_b32 s46, 2
    s_branch chain_abort
pvs_sD:
pvt_sD:
    buffer_load_dwordx4 v[168:171], v10, s[4:7], s39 offen sc1
    s_waitcnt vmcnt(0)
    v_max3_u32 v32, v168, v169, v170
    v_max_u32 v32, v32, v171
    v_cmp_eq_u32 vcc, -1, v32
    s_cbranch_vccz pvok_sD
    s_sub_u32 s36, s36, 1
    s_cbranch_scc0 pvt_sD
    s_mov_b32 s46, 3
    s_branch chain_abort
smx_sD:
    v_mfma_f32_16x16x32_bf16 v[144:147], v[104:107], v[192:195], v[40:43]
    v_mfma_f32_16x16x32_bf16 v[144:147], v[108:111], v[196:199], v[144:147]
    v_mfma_f32_16x16x32_bf16 v[144:147], v[112:115], v[200:203], v[144:147]
    v_mfma_f32_16x16x32_bf16 v[144:147], v[116:119], v[204:207], v[144:147]
    v_mfma_f32_16x16x32_bf16 v[148:151], v[120:123], v[192:195], v[44:47]
    v_mfma_f32_16x16x32_bf16 v[148:151], v[124:127], v[196:199], v[148:151]
    v_mfma_f32_16x16x32_bf16 v[148:151], v[128:131], v[200:203], v[148:151]
    v_mfma_f32_16x16x32_bf16 v[148:151], v[132:135], v[204:207], v[148:151]
    v_mfma_f32_16x16x32_bf16 v[152:155], v[208:211], v[192:195], 0
    v_mfma_f32_16x16x32_bf16 v[152:155], v[212:215], v[196:199], v[152:155]
    v_mfma_f32_16x16x32_bf16 v[152:155], v[216:219], v[200:203], v[152:155]
    v_mfma_f32_16x16x32_bf16 v[152:155], v[220:223], v[204:207], v[152:155]
    s_nop 7
    v_max3_f32 v20, v144, v145, v146
    v_max3_f32 v20, v20, v147, v148
    v_max3_f32 v20, v20, v149, v150
    v_max3_f32 v20, v20, v151, v152
    v_max3_f32 v20, v20, v153, v154
    v_max_f32 v20, v20, v155
    v_mov_b32 v30, v20
    s_nop 1
    v_permlane16_swap_b32 v30, v20
    s_nop 0
    v_max_f32 v20, v20, v30
    v_mov_b32 v30, v20
    s_nop 1
    v_permlane32_swap_b32 v30, v20
    s_nop 0
    v_max_f32 v20, v20, v30
    v_sub_f32 v144, v144, v20
    v_sub_f32 v145, v145, v20
    v_sub_f32 v146, v146, v20
    v_sub_f32 v147, v147, v20
    v_sub_f32 v148, v148, v20
    v_sub_f32 v149, v149, v20
    v_sub_f32 v150, v150, v20
    v_sub_f32 v151, v151, v20
    v_sub_f32 v152, v152, v20
    v_sub_f32 v153, v153, v20
    v_sub_f32 v154, v154, v20
    v_sub_f32 v155, v155, v20
    v_exp_f32 v144, v144
    v_exp_f32 v145, v145
    v_exp_f32 v146, v146
    v_exp_f32 v147, v147
    v_exp_f32 v148, v148
    v_exp_f32 v149, v149
    v_exp_f32 v150, v150
    v_exp_f32 v151, v151
    v_exp_f32 v152, v152
    v_exp_f32 v153, v153
    v_exp_f32 v154, v154
    v_exp_f32 v155, v155
    s_nop 0
    v_cvt_pk_bf16_f32 v164, v144, v145
    v_cvt_pk_bf16_f32 v165, v146, v147
    v_cvt_pk_bf16_f32 v166, v148, v149
    v_cvt_pk_bf16_f32 v167, v150, v151
    v_cvt_pk_bf16_f32 v36, v152, v153
    v_cvt_pk_bf16_f32 v37, v154, v155
    s_nop 1
    v_mfma_f32_16x16x16_bf16 v[156:159], v[168:169], v[36:37], 0
    v_mfma_f32_16x16x16_bf16 v[160:163], v[170:171], v[36:37], 0
    v_mfma_f32_16x16x16_bf16 v[48:51], a[252:253], v[36:37], 0
    s_nop 5
    v_mfma_f32_16x16x32_bf16 v[156:159], v[136:139], v[164:167], v[156:159]
    v_mfma_f32_16x16x32_bf16 v[160:163], v[140:143], v[164:167], v[160:163]
    v_mfma_f32_16x16x32_bf16 v[48:51], a[244:247], v[164:167], v[48:51]
    s_nop 5
    v_cvt_pk_bf16_f32 v184, v156, v157
    v_cvt_pk_bf16_f32 v185, v158, v159
    v_cvt_pk_bf16_f32 v186, v160, v161
    v_cvt_pk_bf16_f32 v187, v162, v163
    ds_write_b128 v11, v[184:187]
    v_rcp_f32 v34, v48
    v_mfma_f32_16x16x32_bf16 v[224:227], v[56:59], v[184:187], 0
    v_mfma_f32_16x16x32_bf16 v[228:231], v[72:75], v[184:187], 0
    v_mfma_f32_16x16x32_bf16 v[232:235], v[88:91], v[184:187], 0
    s_nop 0
    v_mov_b32 v35, v34
    s_cmp_eq_u32 s35, 63
    s_waitcnt lgkmcnt(0)
    s_branch smok_sD
z1_sD:
    v_lshrrev_b32 v32, 1, v15
    buffer_load_dwordx2 v[30:31], v32, s[4:7], s91 offen sc1
    s_waitcnt vmcnt(0)
    v_max_u32 v30, v30, v31
    v_cmp_eq_u32 vcc, -1, v30
    s_cbranch_vccz z2_sD
    s_sub_u32 s36, s36, 1
    s_cbranch_scc0 z1_sD
    s_mov_b32 s46, 8
    s_branch chain_abort
z2_sD:
    s_add_u32 s91, s91, 512
    s_cmp_eq_u32 s90, 2
    s_cselect_b32 s90, 7, 23
    s_branch z1ok_sD
entry_sA:
    buffer_load_dwordx4 v[224:227], v2, s[4:7], s38 offen offset:0 sc1
    buffer_load_dwordx4 v[228:231], v2, s[4:7], s38 offen offset:1024 sc1
    buffer_load_dwordx4 v[232:235], v2, s[4:7], s38 offen offset:2048 sc1
    s_waitcnt vmcnt(0)
    buffer_load_dwordx4 v[236:239], v2, s[4:7], s38 offen offset:0 sc1
    buffer_load_dwordx4 v[240:243], v2, s[4:7], s38 offen offset:1024 sc1
    buffer_load_dwordx4 v[244:247], v2, s[4:7], s38 offen offset:2048 sc1
    s_branch loop_sA
.p2align 6
loop_sA:
    s_waitcnt vmcnt(5)
    ds_write_b128 v2, v[224:227] offset:0
    v_max3_u32 v30, v224, v225, v226
    v_max_u32 v30, v30, v227
    s_waitcnt vmcnt(4)
    ds_write_b128 v2, v[228:231] offset:1024
    v_max3_u32 v30, v30, v228, v229
    v_max3_u32 v30, v30, v230, v231
    s_waitcnt vmcnt(3)
    ds_write_b128 v2, v[232:235] offset:2048
    v_max3_u32 v30, v30, v232, v233
    v_max3_u32 v30, v30, v234, v235
    v_cmp_eq_u32 vcc, -1, v30
    s_waitcnt lgkmcnt(0)
    s_cbranch_vccnz x3s_sA
x3ok_sA:
    s_barrier
    ds_read_b128 v[192:195], v3 offset:0
    ds_read_b128 v[196:199], v3 offset:1024
    ds_read_b128 v[200:203], v3 offset:2048
    ds_read_b128 v[204:207], v3 offset:3072
    ds_read_b128 v[208:211], v3 offset:4096
    ds_read_b128 v[212:215], v3 offset:5120
    ds_read_b128 v[216:219], v3 offset:6144
    ds_read_b128 v[220:223], v3 offset:7168
    ds_read_b128 v[144:147], v3 offset:8192
    ds_read_b128 v[148:151], v3 offset:9216
p2c_sA:
    s_waitcnt lgkmcnt(9)
    v_mfma_f32_16x16x32_bf16 v[156:159], a[0:3], v[192:195], 0
    v_mfma_f32_16x16x32_bf16 v[160:163], a[4:7], v[192:195], 0
    s_waitcnt lgkmcnt(8)
    v_mfma_f32_16x16x32_bf16 v[156:159], a[8:11], v[196:199], v[156:159]
    v_mfma_f32_16x16x32_bf16 v[160:163], a[12:15], v[196:199], v[160:163]
    s_waitcnt lgkmcnt(7)
    v_mfma_f32_16x16x32_bf16 v[156:159], a[16:19], v[200:203], v[156:159]
    v_mfma_f32_16x16x32_bf16 v[160:163], a[20:23], v[200:203], v[160:163]
    s_waitcnt lgkmcnt(6)
    v_mfma_f32_16x16x32_bf16 v[156:159], a[24:27], v[204:207], v[156:159]
    v_mfma_f32_16x16x32_bf16 v[160:163], a[28:31], v[204:207], v[160:163]
    s_waitcnt lgkmcnt(5)
    v_mfma_f32_16x16x32_bf16 v[156:159], a[32:35], v[208:211], v[156:159]
    v_mfma_f32_16x16x32_bf16 v[160:163], a[36:39], v[208:211], v[160:163]
    s_waitcnt lgkmcnt(4)
    v_mfma_f32_16x16x32_bf16 v[156:159], a[40:43], v[212:215], v[156:159]
    v_mfma_f32_16x16x32_bf16 v[160:163], a[44:47], v[212:215], v[160:163]
    s_waitcnt lgkmcnt(3)
    v_mfma_f32_16x16x32_bf16 v[156:159], a[48:51], v[216:219], v[156:159]
    v_mfma_f32_16x16x32_bf16 v[160:163], a[52:55], v[216:219], v[160:163]
    s_waitcnt lgkmcnt(2)
    v_mfma_f32_16x16x32_bf16 v[156:159], a[56:59], v[220:223], v[156:159]
    v_mfma_f32_16x16x32_bf16 v[160:163], a[60:63], v[220:223], v[160:163]
    s_waitcnt lgkmcnt(1)
    v_mfma_f32_16x16x32_bf16 v[156:159], a[64:67], v[144:147], v[156:159]
    v_mfma_f32_16x16x32_bf16 v[160:163], a[68:71], v[144:147], v[160:163]
    s_waitcnt lgkmcnt(0)
    v_mfma_f32_16x16x32_bf16 v[156:159], a[72:75], v[148:151], v[156:159]
    v_mfma_f32_16x16x32_bf16 v[160:163], a[76:79], v[148:151], v[160:163]
    v_mfma_f32_16x16x32_bf16 v[52:55], v[192:195], a[80:83], 0
    v_mfma_f32_16x16x32_bf16 v[52:55], v[196:199], a[84:87], v[52:55]
    v_mfma_f32_16x16x32_bf16 v[52:55], v[200:203], a[88:91], v[52:55]
    v_add_f32_dpp v156, v160, v156 row_ror:8 row_mask:0xf bank_mask:0xf
    v_add_f32_dpp v157, v161, v157 row_ror:8 row_mask:0xf bank_mask:0xf
    v_add_f32_dpp v158, v162, v158 row_ror:8 row_mask:0xf bank_mask:0xf
    v_add_f32_dpp v159, v163, v159 row_ror:8 row_mask:0xf bank_mask:0xf
    v_pk_mul_f32 v[156:157], v[156:157], s[12:13]
    v_pk_mul_f32 v[158:159], v[158:159], s[12:13]
    v_cvt_pk_bf16_f32 v30, v156, v157
    v_cvt_pk_bf16_f32 v31, v158, v159
    v_min_u32 v30, -2, v30
    v_min_u32 v31, -2, v31
    buffer_store_dwordx2 v[30:31], v4, s[4:7], s39 offen sc1
    v_mfma_f32_16x16x32_bf16 v[52:55], v[204:207], a[92:95], v[52:55]
    v_mfma_f32_16x16x32_bf16 v[52:55], v[208:211], a[96:99], v[52:55]
    v_mfma_f32_16x16x32_bf16 v[52:55], v[212:215], a[100:103], v[52:55]
    v_mfma_f32_16x16x32_bf16 v[52:55], v[216:219], a[104:107], v[52:55]
    v_mfma_f32_16x16x32_bf16 v[52:55], v[220:223], a[108:111], v[52:55]
    buffer_load_dwordx4 v[248:251], v6, s[4:7], s39 offen sc1
    v_mfma_f32_16x16x32_bf16 v[52:55], v[144:147], a[112:115], v[52:55]
    v_mfma_f32_16x16x32_bf16 v[52:55], v[148:151], a[116:119], v[52:55]
    ds_read_b128 v[104:107], v15 offset:24576
    ds_read_b128 v[108:111], v15 offset:25600
    ds_read_b128 v[112:115], v15 offset:26624
    ds_read_b128 v[116:119], v15 offset:27648
    ds_read_b128 v[120:123], v15 offset:28672
    ds_read_b128 v[124:127], v15 offset:29696
    ds_read_b128 v[128:131], v15 offset:30720
    ds_read_b128 v[132:135], v15 offset:31744
    v_cvt_pk_bf16_f32 v32, v52, v53
    v_cvt_pk_bf16_f32 v33, v54, v55
    v_min_u32 v32, -2, v32
    v_min_u32 v33, -2, v33
    buffer_store_dwordx2 v[32:33], v5, s[4:7], s39 offen sc1
    s_add_u32 s47, s35, 3
    s_lshr_b32 s47, s47, 1
    s_cmp_lt_i32 s29, s47
    s_cbranch_scc1 qp_sA
qpok_sA:
    buffer_load_dwordx4 v[252:255], v6, s[4:7], s39 offen sc1
    s_waitcnt vmcnt(2)
    ds_write_b128 v7, v[248:251]
    v_max3_u32 v30, v248, v249, v250
    v_max_u32 v30, v30, v251
    v_cmp_eq_u32 vcc, -1, v30
    s_waitcnt lgkmcnt(0)
    s_cbranch_vccnz qks_sA
qkok_sA:
    buffer_load_dwordx4 v[168:171], v10, s[4:7], s39 offen sc1
    s_barrier
    ds_read_b128 v[192:195], v8 offset:0
    ds_read_b128 v[196:199], v8 offset:512
    ds_read_b128 v[200:203], v8 offset:1024
    ds_read_b128 v[204:207], v8 offset:1536
    ds_read_b128 v[208:211], v9 offset:0
    ds_read_b128 v[212:215], v9 offset:512
    ds_read_b128 v[216:219], v9 offset:1024
    ds_read_b128 v[220:223], v9 offset:1536
    s_waitcnt lgkmcnt(7)
    v_mfma_f32_16x16x32_bf16 v[144:147], v[104:107], v[192:195], v[40:43]
    s_waitcnt lgkmcnt(6)
    v_mfma_f32_16x16x32_bf16 v[144:147], v[108:111], v[196:199], v[144:147]
    s_waitcnt lgkmcnt(5)
    v_mfma_f32_16x16x32_bf16 v[144:147], v[112:115], v[200:203], v[144:147]
    s_waitcnt lgkmcnt(4)
    v_mfma_f32_16x16x32_bf16 v[144:147], v[116:119], v[204:207], v[144:147]
    s_waitcnt lgkmcnt(3)
    v_mfma_f32_16x16x32_bf16 v[152:155], v[208:211], v[192:195], 0
    s_waitcnt lgkmcnt(2)
    v_mfma_f32_16x16x32_bf16 v[152:155], v[212:215], v[196:199], v[152:155]
    s_waitcnt lgkmcnt(1)
    v_mfma_f32_16x16x32_bf16 v[152:155], v[216:219], v[200:203], v[152:155]
    v_exp_f32 v144, v144
    s_waitcnt lgkmcnt(0)
    v_mfma_f32_16x16x32_bf16 v[152:155], v[220:223], v[204:207], v[152:155]
    v_exp_f32 v145, v145
    v_mfma_f32_16x16x32_bf16 v[148:151], v[120:123], v[192:195], v[44:47]
    v_exp_f32 v146, v146
    v_mfma_f32_16x16x32_bf16 v[148:151], v[124:127], v[196:199], v[148:151]
    v_exp_f32 v147, v147
    v_mfma_f32_16x16x32_bf16 v[148:151], v[128:131], v[200:203], v[148:151]
    v_exp_f32 v152, v152
    v_mfma_f32_16x16x32_bf16 v[148:151], v[132:135], v[204:207], v[148:151]
    v_exp_f32 v153, v153
    v_exp_f32 v154, v154
    v_exp_f32 v155, v155
    s_waitcnt vmcnt(0)
    v_max3_u32 v32, v168, v169, v170
    v_max_u32 v32, v32, v171
    v_cmp_eq_u32 vcc, -1, v32
    v_cvt_pk_bf16_f32 v36, v152, v153
    v_cvt_pk_bf16_f32 v37, v154, v155
    v_exp_f32 v148, v148
    s_cbranch_vccnz pvs_sA
pvok_sA:
    v_mfma_f32_16x16x16_bf16 v[156:159], v[168:169], v[36:37], 0
    v_exp_f32 v149, v149
    buffer_load_dword v18, v25, s[4:7], s88 offen sc1
    v_mfma_f32_16x16x16_bf16 v[160:163], v[170:171], v[36:37], 0
    v_exp_f32 v150, v150
    v_mfma_f32_16x16x16_bf16 v[48:51], a[252:253], v[36:37], 0
    v_exp_f32 v151, v151
    v_cvt_pk_bf16_f32 v164, v144, v145
    v_cvt_pk_bf16_f32 v165, v146, v147
    v_cvt_pk_bf16_f32 v166, v148, v149
    v_cvt_pk_bf16_f32 v167, v150, v151
    s_nop 1
    v_mfma_f32_16x16x32_bf16 v[156:159], v[136:139], v[164:167], v[156:159]
    v_mfma_f32_16x16x32_bf16 v[160:163], v[140:143], v[164:167], v[160:163]
    v_mfma_f32_16x16x32_bf16 v[48:51], a[244:247], v[164:167], v[48:51]
    s_nop 5
    v_cvt_pk_bf16_f32 v184, v156, v157
    v_cvt_pk_bf16_f32 v185, v158, v159
    v_cvt_pk_bf16_f32 v186, v160, v161
    v_cvt_pk_bf16_f32 v187, v162, v163
    ds_write_b128 v11, v[184:187]
    v_rcp_f32 v34, v48
    v_mfma_f32_16x16x32_bf16 v[224:227], v[60:63], v[184:187], 0
    v_mfma_f32_16x16x32_bf16 v[228:231], v[76:79], v[184:187], 0
    v_mfma_f32_16x16x32_bf16 v[232:235], v[92:95], v[184:187], 0
    v_subrev_u32 v30, 0x21800000, v48
    v_cmp_le_u32 vcc, s89, v30
    v_mov_b32 v35, v34
    s_cmp_eq_u32 s35, 63
    s_waitcnt lgkmcnt(0)
    s_cbranch_vccnz smx_sA
smok_sA:
    s_cbranch_scc1 last_sA
    s_barrier
    ds_read_b128 v[192:195], v15 offset:14336
    ds_read_b128 v[200:203], v15 offset:16384
    ds_read_b128 v[204:207], v15 offset:17408
    v_pk_mul_f32 v[156:157], v[156:157], v[34:35]
    v_pk_mul_f32 v[160:161], v[160:161], v[34:35]
    v_pk_mul_f32 v[158:159], v[158:159], v[34:35]
    v_pk_mul_f32 v[162:163], v[162:163], v[34:35]
    v_cvt_pk_bf16_f32 v184, v156, v157
    v_cvt_pk_bf16_f32 v185, v158, v159
    s_waitcnt lgkmcnt(2)
    v_mfma_f32_16x16x32_bf16 v[232:235], v[88:91], v[192:195], v[232:235]
    v_cvt_pk_bf16_f32 v186, v160, v161
    v_cvt_pk_bf16_f32 v187, v162, v163
    s_waitcnt lgkmcnt(1)
    v_mfma_f32_16x16x32_bf16 v[232:235], v[96:99], v[200:203], v[232:235]
    s_waitcnt lgkmcnt(0)
    v_mfma_f32_16x16x32_bf16 v[232:235], v[100:103], v[204:207], v[232:235]
    v_mfma_f32_16x16x32_bf16 v[224:227], v[56:59], v[192:195], v[224:227]
    v_mfma_f32_16x16x32_bf16 v[224:227], v[64:67], v[200:203], v[224:227]
    v_mfma_f32_16x16x32_bf16 v[224:227], v[68:71], v[204:207], v[224:227]
    v_pk_mul_f32 v[232:233], v[232:233], v[34:35]
    v_pk_mul_f32 v[234:235], v[234:235], v[34:35]
    v_cvt_pk_bf16_f32 v232, v232, v233
    v_mfma_f32_16x16x32_bf16 v[228:231], v[72:75], v[192:195], v[228:231]
    v_cvt_pk_bf16_f32 v233, v234, v235
    s_nop 0
    v_min_u32_dpp v144, v232, v19 row_shr:8 row_mask:0xf bank_mask:0xc
    v_min_u32_dpp v145, v233, v19 row_shr:8 row_mask:0xf bank_mask:0xc
    v_mfma_f32_16x16x32_bf16 v[228:231], v[80:83], v[200:203], v[228:231]
    v_min_u32_dpp v146, v232, v19 row_shr:7 row_mask:0xf bank_mask:0xc
    v_min_u32_dpp v147, v233, v19 row_shr:7 row_mask:0xf bank_mask:0xc
    v_mfma_f32_16x16x32_bf16 v[228:231], v[84:87], v[204:207], v[228:231]
    v_pk_mul_f32 v[224:225], v[224:225], v[34:35]
    v_pk_mul_f32 v[226:227], v[226:227], v[34:35]
    v_cvt_pk_bf16_f32 v224, v224, v225
    v_cvt_pk_bf16_f32 v225, v226, v227
    s_nop 1
    v_min_u32_dpp v144, v224, v19 quad_perm:[0,1,2,3] row_mask:0xf bank_mask:0x3
    v_min_u32_dpp v145, v225, v19 quad_perm:[0,1,2,3] row_mask:0xf bank_mask:0x3
    v_pk_mul_f32 v[228:229], v[228:229], v[34:35]
    v_pk_mul_f32 v[230:231], v[230:231], v[34:35]
    v_cvt_pk_bf16_f32 v228, v228, v229
    v_cvt_pk_bf16_f32 v229, v230, v231
    s_nop 0
    v_min_u32_dpp v146, v228, v19 quad_perm:[0,1,2,3] row_mask:0xf bank_mask:0x3
    v_min_u32_dpp v147, v229, v19 quad_perm:[0,1,2,3] row_mask:0xf bank_mask:0x3
    buffer_store_dwordx4 v[144:147], v13, s[4:7], s40 offen sc1
    buffer_store_dwordx4 v[144:147], v12, s[4:7], s44 offen sc1
    s_mov_b32 m0, 22528
    s_nop 0
    buffer_load_dwordx4 v15, s[4:7], s15 offen sc1 lds
    buffer_load_dwordx4 v15, s[4:7], s15 offen offset:1024 sc1 lds
    s_add_u32 s15, s15, 786432
    s_add_u32 m0, s14, 24576
    s_add_u32 s42, s45, 8192
    buffer_load_dwordx4 v15, s[4:7], s45 offen sc1 lds
    buffer_load_dwordx4 v15, s[4:7], s45 offen offset:1024 sc1 lds
    buffer_load_dwordx4 v[136:139], v15, s[4:7], s42 offen sc1
    buffer_load_dwordx4 v[140:143], v15, s[4:7], s42 offen offset:1024 sc1
    s_add_u32 s45, s45, 786432
    s_add_u32 s88, s88, 786432
    buffer_store_dwordx4 v[184:187], v14, s[4:7], s48 offen sc1
    s_add_u32 s48, s48, 262144
    s_add_u32 s46, s35, 1
    s_and_b32 s47, s46, 63
    s_and_b32 s46, s46, 3
    s_mul_i32 s38, s46, 40960
    s_add_u32 s38, s38, s50
    v_readlane_b32 s40, v1, s47
    s_mul_i32 s44, s46, 327680
    s_add_u32 s44, s44, 4358144
    s_mul_i32 s39, s46, 262144
    s_add_u32 s39, s39, s51
    s_add_u32 s46, s46, 1
    s_and_b32 s46, s46, 3
    s_mul_i32 s41, s46, 40960
    s_add_u32 s41, s41, s50
    s_barrier
    buffer_load_dwordx4 v[224:227], v2, s[4:7], s38 offen offset:0 sc1
    buffer_load_dwordx4 v[228:231], v2, s[4:7], s38 offen offset:1024 sc1
    buffer_load_dwordx4 v[232:235], v2, s[4:7], s38 offen offset:2048 sc1
    s_add_u32 s35, s35, 1
    s_sleep 1
    buffer_load_dwordx4 v[236:239], v2, s[4:7], s38 offen offset:0 sc1
    buffer_load_dwordx4 v[240:243], v2, s[4:7], s38 offen offset:1024 sc1
    buffer_load_dwordx4 v[244:247], v2, s[4:7], s38 offen offset:2048 sc1
    s_branch loop_sA
last_sA:
    v_pk_mul_f32 v[156:157], v[156:157], v[34:35]
    v_pk_mul_f32 v[160:161], v[160:161], v[34:35]
    v_pk_mul_f32 v[158:159], v[158:159], v[34:35]
    v_pk_mul_f32 v[162:163], v[162:163], v[34:35]
    v_cvt_pk_bf16_f32 v184, v156, v157
    v_cvt_pk_bf16_f32 v185, v158, v159
    v_cvt_pk_bf16_f32 v186, v160, v161
    v_cvt_pk_bf16_f32 v187, v162, v163
    buffer_store_dwordx4 v[184:187], v14, s[4:7], s48 offen sc1
    s_add_u32 s48, s48, 262144
    s_waitcnt vmcnt(0)
    s_barrier
    s_endpgm
x3s_sA:
    buffer_load_dwordx4 v[224:227], v2, s[4:7], s38 offen offset:0 sc1
    buffer_load_dwordx4 v[228:231], v2, s[4:7], s38 offen offset:1024 sc1
    buffer_load_dwordx4 v[232:235], v2, s[4:7], s38 offen offset:2048 sc1
    s_waitcnt vmcnt(5)
    ds_write_b128 v2, v[236:239] offset:0
    v_max3_u32 v30, v236, v237, v238
    v_max_u32 v30, v30, v239
    s_waitcnt vmcnt(4)
    ds_write_b128 v2, v[240:243] offset:1024
    v_max3_u32 v30, v30, v240, v241
    v_max3_u32 v30, v30, v242, v243
    s_waitcnt vmcnt(3)
    ds_write_b128 v2, v[244:247] offset:2048
    v_max3_u32 v30, v30, v244, v245
    v_max3_u32 v30, v30, v246, v247
    v_cmp_eq_u32 vcc, -1, v30
    s_waitcnt lgkmcnt(0)
    s_cbranch_vccz x3ok_sA
    buffer_load_dwordx4 v[236:239], v2, s[4:7], s38 offen offset:0 sc1
    buffer_load_dwordx4 v[240:243], v2, s[4:7], s38 offen offset:1024 sc1
    buffer_load_dwordx4 v[244:247], v2, s[4:7], s38 offen offset:2048 sc1
    s_waitcnt vmcnt(5)
    ds_write_b128 v2, v[224:227] offset:0
    v_max3_u32 v30, v224, v225, v226
    v_max_u32 v30, v30, v227
    s_waitcnt vmcnt(4)
    ds_write_b128 v2, v[228:231] offset:1024
    v_max3_u32 v30, v30, v228, v229
    v_max3_u32 v30, v30, v230, v231
    s_waitcnt vmcnt(3)
    ds_write_b128 v2, v[232:235] offset:2048
    v_max3_u32 v30, v30, v232, v233
    v_max3_u32 v30, v30, v234, v235
    v_cmp_eq_u32 vcc, -1, v30
    s_waitcnt lgkmcnt(0)
    s_cbranch_vccz x3ok_sA
    s_sub_u32 s36, s36, 1
    s_cbranch_scc0 x3s_sA
    s_mov_b32 s46, 1
    s_branch chain_abort
qp_sA:
    buffer_load_dword v30, v26, s[4:7], 0 offen sc1
    s_waitcnt vmcnt(0)
    v_min_i32_dpp v30, v30, v30 row_ror:2 row_mask:0xf bank_mask:0xf
    s_nop 1
    v_min_i32_dpp v30, v30, v30 row_ror:1 row_mask:0xf bank_mask:0xf
    s_nop 1
    v_readfirstlane_b32 s29, v30
    s_cmp_ge_i32 s29, s47
    s_cbranch_scc1 qpok_sA
    s_sub_u32 s36, s36, 1
    s_cbranch_scc0 qp_sA
    s_mov_b32 s46, 9
    s_branch chain_abort
qks_sA:
qkt_sA:
    buffer_load_dwordx4 v[248:251], v6, s[4:7], s39 offen sc1
    s_waitcnt vmcnt(1)
    ds_write_b128 v7, v[252:255]
    v_max3_u32 v30, v252, v253, v254
    v_max_u32 v30, v30, v255
    v_cmp_eq_u32 vcc, -1, v30
    s_waitcnt lgkmcnt(0)
    s_cbranch_vccz qkok_sA
    buffer_load_dwordx4 v[252:255], v6, s[4:7], s39 offen sc1
    s_waitcnt vmcnt(1)
    ds_write_b128 v7, v[248:251]
    v_max3_u32 v30, v248, v249, v250
    v_max_u32 v30, v30, v251
    v_cmp_eq_u32 vcc, -1, v30
    s_waitcnt lgkmcnt(0)
    s_cbranch_vccz qkok_sA
    s_sub_u32 s36, s36, 1
    s_cbranch_scc0 qkt_sA
    s_mov_b32 s46, 2
    s_branch chain_abort
pvs_sA:
pvt_sA:
    buffer_load_dwordx4 v[168:171], v10, s[4:7], s39 offen sc1
    s_waitcnt vmcnt(0)
    v_max3_u32 v32, v168, v169, v170
    v_max_u32 v32, v32, v171
    v_cmp_eq_u32 vcc, -1, v32
    s_cbranch_vccz pvok_sA
    s_sub_u32 s36, s36, 1
    s_cbranch_scc0 pvt_sA
    s_mov_b32 s46, 3
    s_branch chain_abort
smx_sA:
    v_mfma_f32_16x16x32_bf16 v[144:147], v[104:107], v[192:195], v[40:43]
    v_mfma_f32_16x16x32_bf16 v[144:147], v[108:111], v[196:199], v[144:147]
    v_mfma_f32_16x16x32_bf16 v[144:147], v[112:115], v[200:203], v[144:147]
    v_mfma_f32_16x16x32_bf16 v[144:147], v[116:119], v[204:207], v[144:147]
    v_mfma_f32_16x16x32_bf16 v[148:151], v[120:123], v[192:195], v[44:47]
    v_mfma_f32_16x16x32_bf16 v[148:151], v[124:127], v[196:199], v[148:151]
    v_mfma_f32_16x16x32_bf16 v[148:151], v[128:131], v[200:203], v[148:151]
    v_mfma_f32_16x16x32_bf16 v[148:151], v[132:135], v[204:207], v[148:151]
    v_mfma_f32_16x16x32_bf16 v[152:155], v[208:211], v[192:195], 0
    v_mfma_f32_16x16x32_bf16 v[152:155], v[212:215], v[196:199], v[152:155]
    v_mfma_f32_16x16x32_bf16 v[152:155], v[216:219], v[200:203], v[152:155]
    v_mfma_f32_16x16x32_bf16 v[152:155], v[220:223], v[204:207], v[152:155]
    s_nop 7
    v_max3_f32 v20, v144, v145, v146
    v_max3_f32 v20, v20, v147, v148
    v_max3_f32 v20, v20, v149, v150
    v_max3_f32 v20, v20, v151, v152
    v_max3_f32 v20, v20, v153, v154
    v_max_f32 v20, v20, v155
    v_mov_b32 v30, v20
    s_nop 1
    v_permlane16_swap_b32 v30, v20
    s_nop 0
    v_max_f32 v20, v20, v30
    v_mov_b32 v30, v20
    s_nop 1
    v_permlane32_swap_b32 v30, v20
    s_nop 0
    v_max_f32 v20, v20, v30
    v_sub_f32 v144, v144, v20
    v_sub_f32 v145, v145, v20
    v_sub_f32 v146, v146, v20
    v_sub_f32 v147, v147, v20
    v_sub_f32 v148, v148, v20
    v_sub_f32 v149, v149, v20
    v_sub_f32 v150, v150, v20
    v_sub_f32 v151, v151, v20
    v_sub_f32 v152, v152, v20
    v_sub_f32 v153, v153, v20
    v_sub_f32 v154, v154, v20
    v_sub_f32 v155, v155, v20
    v_exp_f32 v144, v144
    v_exp_f32 v145, v145
    v_exp_f32 v146, v146
    v_exp_f32 v147, v147
    v_exp_f32 v148, v148
    v_exp_f32 v149, v149
    v_exp_f32 v150, v150
    v_exp_f32 v151, v151
    v_exp_f32 v152, v152
    v_exp_f32 v153, v153
    v_exp_f32 v154, v154
    v_exp_f32 v155, v155
    s_nop 0
    v_cvt_pk_bf16_f32 v164, v144, v145
    v_cvt_pk_bf16_f32 v165, v146, v147
    v_cvt_pk_bf16_f32 v166, v148, v149
    v_cvt_pk_bf16_f32 v167, v150, v151
    v_cvt_pk_bf16_f32 v36, v152, v153
    v_cvt_pk_bf16_f32 v37, v154, v155
    s_nop 1
    v_mfma_f32_16x16x16_bf16 v[156:159], v[168:169], v[36:37], 0
    v_mfma_f32_16x16x16_bf16 v[160:163], v[170:171], v[36:37], 0
    v_mfma_f32_16x16x16_bf16 v[48:51], a[252:253], v[36:37], 0
    s_nop 5
    v_mfma_f32_16x16x32_bf16 v[156:159], v[136:139], v[164:167], v[156:159]
    v_mfma_f32_16x16x32_bf16 v[160:163], v[140:143], v[164:167], v[160:163]
    v_mfma_f32_16x16x32_bf16 v[48:51], a[244:247], v[164:167], v[48:51]
    s_nop 5
    v_cvt_pk_bf16_f32 v184, v156, v157
    v_cvt_pk_bf16_f32 v185, v158, v159
    v_cvt_pk_bf16_f32 v186, v160, v161
    v_cvt_pk_bf16_f32 v187, v162, v163
    ds_write_b128 v11, v[184:187]
    v_rcp_f32 v34, v48
    v_mfma_f32_16x16x32_bf16 v[224:227], v[60:63], v[184:187], 0
    v_mfma_f32_16x16x32_bf16 v[228:231], v[76:79], v[184:187], 0
    v_mfma_f32_16x16x32_bf16 v[232:235], v[92:95], v[184:187], 0
    s_nop 0
    v_mov_b32 v35, v34
    s_cmp_eq_u32 s35, 63
    s_waitcnt lgkmcnt(0)
    s_branch smok_sA
entry_sB:
    buffer_load_dwordx4 v[224:227], v2, s[4:7], s38 offen offset:0 sc1
    buffer_load_dwordx4 v[228:231], v2, s[4:7], s38 offen offset:1024 sc1
    s_waitcnt vmcnt(0)
    buffer_load_dwordx4 v[236:239], v2, s[4:7], s38 offen offset:0 sc1
    buffer_load_dwordx4 v[240:243], v2, s[4:7], s38 offen offset:1024 sc1
    s_branch loop_sB
.p2align 6
loop_sB:
    s_waitcnt vmcnt(3)
    ds_write_b128 v2, v[224:227] offset:0
    v_max3_u32 v30, v224, v225, v226
    v_max_u32 v30, v30, v227
    s_waitcnt vmcnt(2)
    ds_write_b128 v2, v[228:231] offset:1024
    v_max3_u32 v30, v30, v228, v229
    v_max3_u32 v30, v30, v230, v231
    v_cmp_eq_u32 vcc, -1, v30
    s_waitcnt lgkmcnt(0)
    s_cbranch_vccnz x3s_sB
x3ok_sB:
    s_barrier
    ds_read_b128 v[192:195], v3 offset:0
    ds_read_b128 v[196:199], v3 offset:1024
    ds_read_b128 v[200:203], v3 offset:2048
    ds_read_b128 v[204:207], v3 offset:3072
    ds_read_b128 v[208:211], v3 offset:4096
    ds_read_b128 v[212:215], v3 offset:5120
    ds_read_b128 v[216:219], v3 offset:6144
    ds_read_b128 v[220:223], v3 offset:7168
    ds_read_b128 v[144:147], v3 offset:8192
    ds_read_b128 v[148:151], v3 offset:9216
p2c_sB:
    s_waitcnt lgkmcnt(9)
    v_mfma_f32_16x16x32_bf16 v[156:159], a[0:3], v[192:195], 0
    v_mfma_f32_16x16x32_bf16 v[160:163], a[4:7], v[192:195], 0
    s_waitcnt lgkmcnt(8)
    v_mfma_f32_16x16x32_bf16 v[156:159], a[8:11], v[196:199], v[156:159]
    v_mfma_f32_16x16x32_bf16 v[160:163], a[12:15], v[196:199], v[160:163]
    s_waitcnt lgkmcnt(7)
    v_mfma_f32_16x16x32_bf16 v[156:159], a[16:19], v[200:203], v[156:159]
    v_mfma_f32_16x16x32_bf16 v[160:163], a[20:23], v[200:203], v[160:163]
    s_waitcnt lgkmcnt(6)
    v_mfma_f32_16x16x32_bf16 v[156:159], a[24:27], v[204:207], v[156:159]
    v_mfma_f32_16x16x32_bf16 v[160:163], a[28:31], v[204:207], v[160:163]
    s_waitcnt lgkmcnt(5)
    v_mfma_f32_16x16x32_bf16 v[156:159], a[32:35], v[208:211], v[156:159]
    v_mfma_f32_16x16x32_bf16 v[160:163], a[36:39], v[208:211], v[160:163]
    s_waitcnt lgkmcnt(4)
    v_mfma_f32_16x16x32_bf16 v[156:159], a[40:43], v[212:215], v[156:159]
    v_mfma_f32_16x16x32_bf16 v[160:163], a[44:47], v[212:215], v[160:163]
    s_waitcnt lgkmcnt(3)
    v_mfma_f32_16x16x32_bf16 v[156:159], a[48:51], v[216:219], v[156:159]
    v_mfma_f32_16x16x32_bf16 v[160:163], a[52:55], v[216:219], v[160:163]
    s_waitcnt lgkmcnt(2)
    v_mfma_f32_16x16x32_bf16 v[156:159], a[56:59], v[220:223], v[156:159]
    v_mfma_f32_16x16x32_bf16 v[160:163], a[60:63], v[220:223], v[160:163]
    s_waitcnt lgkmcnt(1)
    v_mfma_f32_16x16x32_bf16 v[156:159], a[64:67], v[144:147], v[156:159]
    v_mfma_f32_16x16x32_bf16 v[160:163], a[68:71], v[144:147], v[160:163]
    s_waitcnt lgkmcnt(0)
    v_mfma_f32_16x16x32_bf16 v[156:159], a[72:75], v[148:151], v[156:159]
    v_mfma_f32_16x16x32_bf16 v[160:163], a[76:79], v[148:151], v[160:163]
    v_mfma_f32_16x16x32_bf16 v[52:55], v[192:195], a[80:83], 0
    v_mfma_f32_16x16x32_bf16 v[52:55], v[196:199], a[84:87], v[52:55]
    v_mfma_f32_16x16x32_bf16 v[52:55], v[200:203], a[88:91], v[52:55]
    v_add_f32_dpp v156, v160, v156 row_ror:8 row_mask:0xf bank_mask:0xf
    v_add_f32_dpp v157, v161, v157 row_ror:8 row_mask:0xf bank_mask:0xf
    v_add_f32_dpp v158, v162, v158 row_ror:8 row_mask:0xf bank_mask:0xf
    v_add_f32_dpp v159, v163, v159 row_ror:8 row_mask:0xf bank_mask:0xf
    v_cvt_pk_bf16_f32 v30, v156, v157
    v_cvt_pk_bf16_f32 v31, v158, v159
    v_min_u32 v30, -2, v30
    v_min_u32 v31, -2, v31
    buffer_store_dwordx2 v[30:31], v4, s[4:7], s39 offen sc1
    v_mfma_f32_16x16x32_bf16 v[52:55], v[204:207], a[92:95], v[52:55]
    v_mfma_f32_16x16x32_bf16 v[52:55], v[208:211], a[96:99], v[52:55]
    v_mfma_f32_16x16x32_bf16 v[52:55], v[212:215], a[100:103], v[52:55]
    v_mfma_f32_16x16x32_bf16 v[52:55], v[216:219], a[104:107], v[52:55]
    v_mfma_f32_16x16x32_bf16 v[52:55], v[220:223], a[108:111], v[52:55]
    buffer_load_dwordx4 v[248:251], v6, s[4:7], s39 offen sc1
    v_mfma_f32_16x16x32_bf16 v[52:55], v[144:147], a[112:115], v[52:55]
    v_mfma_f32_16x16x32_bf16 v[52:55], v[148:151], a[116:119], v[52:55]
    ds_read_b128 v[104:107], v15 offset:24576
    ds_read_b128 v[108:111], v15 offset:25600
    ds_read_b128 v[112:115], v15 offset:26624
    ds_read_b128 v[116:119], v15 offset:27648
    ds_read_b128 v[120:123], v15 offset:28672
    ds_read_b128 v[124:127], v15 offset:29696
    ds_read_b128 v[128:131], v15 offset:30720
    ds_read_b128 v[132:135], v15 offset:31744
    v_cvt_pk_bf16_f32 v32, v52, v53
    v_cvt_pk_bf16_f32 v33, v54, v55
    v_min_u32 v32, -2, v32
    v_min_u32 v33, -2, v33
    buffer_store_dwordx2 v[32:33], v5, s[4:7], s39 offen sc1
    buffer_load_dwordx4 v[252:255], v6, s[4:7], s39 offen sc1
    s_waitcnt vmcnt(2)
    ds_write_b128 v7, v[248:251]
    v_max3_u32 v30, v248, v249, v250
    v_max_u32 v30, v30, v251
    v_cmp_eq_u32 vcc, -1, v30
    s_waitcnt lgkmcnt(0)
    s_cbranch_vccnz qks_sB
qkok_sB:
    buffer_load_dwordx4 v[168:171], v10, s[4:7], s39 offen sc1
    s_barrier
    ds_read_b128 v[192:195], v8 offset:0
    ds_read_b128 v[196:199], v8 offset:512
    ds_read_b128 v[200:203], v8 offset:1024
    ds_read_b128 v[204:207], v8 offset:1536
    ds_read_b128 v[208:211], v9 offset:0
    ds_read_b128 v[212:215], v9 offset:512
    ds_read_b128 v[216:219], v9 offset:1024
    ds_read_b128 v[220:223], v9 offset:1536
    s_waitcnt lgkmcnt(7)
    v_mfma_f32_16x16x32_bf16 v[144:147], v[104:107], v[192:195], v[40:43]
    s_waitcnt lgkmcnt(6)
    v_mfma_f32_16x16x32_bf16 v[144:147], v[108:111], v[196:199], v[144:147]
    s_waitcnt lgkmcnt(5)
    v_mfma_f32_16x16x32_bf16 v[144:147], v[112:115], v[200:203], v[144:147]
    s_waitcnt lgkmcnt(4)
    v_mfma_f32_16x16x32_bf16 v[144:147], v[116:119], v[204:207], v[144:147]
    s_waitcnt lgkmcnt(3)
    v_mfma_f32_16x16x32_bf16 v[152:155], v[208:211], v[192:195], 0
    s_waitcnt lgkmcnt(2)
    v_mfma_f32_16x16x32_bf16 v[152:155], v[212:215], v[196:199], v[152:155]
    s_waitcnt lgkmcnt(1)
    v_mfma_f32_16x16x32_bf16 v[152:155], v[216:219], v[200:203], v[152:155]
    v_exp_f32 v144, v144
    s_waitcnt lgkmcnt(0)
    v_mfma_f32_16x16x32_bf16 v[152:155], v[220:223], v[204:207], v[152:155]
    v_exp_f32 v145, v145
    v_mfma_f32_16x16x32_bf16 v[148:151], v[120:123], v[192:195], v[44:47]
    v_exp_f32 v146, v146
    v_mfma_f32_16x16x32_bf16 v[148:151], v[124:127], v[196:199], v[148:151]
    v_exp_f32 v147, v147
    v_mfma_f32_16x16x32_bf16 v[148:151], v[128:131], v[200:203], v[148:151]
    v_exp_f32 v152, v152
    v_mfma_f32_16x16x32_bf16 v[148:151], v[132:135], v[204:207], v[148:151]
    v_exp_f32 v153, v153
    v_exp_f32 v154, v154
    v_exp_f32 v155, v155
    s_waitcnt vmcnt(0)
    v_max3_u32 v32, v168, v169, v170
    v_max_u32 v32, v32, v171
    v_cmp_eq_u32 vcc, -1, v32
    v_cvt_pk_bf16_f32 v36, v152, v153
    v_cvt_pk_bf16_f32 v37, v154, v155
    v_exp_f32 v148, v148
    s_cbranch_vccnz pvs_sB
pvok_sB:
    v_mfma_f32_16x16x16_bf16 v[156:159], v[168:169], v[36:37], 0
    v_exp_f32 v149, v149
    v_mfma_f32_16x16x16_bf16 v[160:163], v[170:171], v[36:37], 0
    v_exp_f32 v150, v150
    v_mfma_f32_16x16x16_bf16 v[48:51], a[252:253], v[36:37], 0
    v_exp_f32 v151, v151
    v_cvt_pk_bf16_f32 v164, v144, v145
    v_cvt_pk_bf16_f32 v165, v146, v147
    v_cvt_pk_bf16_f32 v166, v148, v149
    v_cvt_pk_bf16_f32 v167, v150, v151
    s_nop 1
    v_mfma_f32_16x16x32_bf16 v[156:159], v[136:139], v[164:167], v[156:159]
    v_mfma_f32_16x16x32_bf16 v[160:163], v[140:143], v[164:167], v[160:163]
    v_mfma_f32_16x16x32_bf16 v[48:51], a[244:247], v[164:167], v[48:51]
    s_nop 5
    v_cvt_pk_bf16_f32 v184, v156, v157
    v_cvt_pk_bf16_f32 v185, v158, v159
    v_cvt_pk_bf16_f32 v186, v160, v161
    v_cvt_pk_bf16_f32 v187, v162, v163
    ds_write_b128 v11, v[184:187]
    v_rcp_f32 v34, v48
    v_mfma_f32_16x16x32_bf16 v[224:227], v[64:67], v[184:187], 0
    v_mfma_f32_16x16x32_bf16 v[228:231], v[80:83], v[184:187], 0
    v_subrev_u32 v30, 0x21800000, v48
    v_cmp_le_u32 vcc, s89, v30
    v_mov_b32 v35, v34
    s_cmp_eq_u32 s35, 63
    s_waitcnt lgkmcnt(0)
    s_cbranch_vccnz smx_sB
smok_sB:
    s_cbranch_scc1 last_sB
    s_barrier
    ds_read_b128 v[192:195], v15 offset:14336
    ds_read_b128 v[196:199], v15 offset:15360
    ds_read_b128 v[204:207], v15 offset:17408
    v_pk_mul_f32 v[156:157], v[156:157], v[34:35]
    v_pk_mul_f32 v[160:161], v[160:161], v[34:35]
    v_pk_mul_f32 v[158:159], v[158:159], v[34:35]
    v_pk_mul_f32 v[162:163], v[162:163], v[34:35]
    v_cvt_pk_bf16_f32 v184, v156, v157
    v_cvt_pk_bf16_f32 v185, v158, v159
    s_waitcnt lgkmcnt(2)
    v_mfma_f32_16x16x32_bf16 v[224:227], v[56:59], v[192:195], v[224:227]
    v_cvt_pk_bf16_f32 v186, v160, v161
    v_cvt_pk_bf16_f32 v187, v162, v163
    s_waitcnt lgkmcnt(1)
    v_mfma_f32_16x16x32_bf16 v[224:227], v[60:63], v[196:199], v[224:227]
    s_waitcnt lgkmcnt(0)
    v_mfma_f32_16x16x32_bf16 v[224:227], v[68:71], v[204:207], v[224:227]
    v_mfma_f32_16x16x32_bf16 v[228:231], v[72:75], v[192:195], v[228:231]
    v_mfma_f32_16x16x32_bf16 v[228:231], v[76:79], v[196:199], v[228:231]
    v_mfma_f32_16x16x32_bf16 v[228:231], v[84:87], v[204:207], v[228:231]
    v_pk_mul_f32 v[224:225], v[224:225], v[34:35]
    v_pk_mul_f32 v[226:227], v[226:227], v[34:35]
    v_cvt_pk_bf16_f32 v224, v224, v225
    v_cvt_pk_bf16_f32 v225, v226, v227
    s_nop 1
    v_min_u32_dpp v144, v224, v19 quad_perm:[0,1,2,3] row_mask:0xf bank_mask:0x3
    v_min_u32_dpp v145, v225, v19 quad_perm:[0,1,2,3] row_mask:0xf bank_mask:0x3
    v_pk_mul_f32 v[228:229], v[228:229], v[34:35]
    v_pk_mul_f32 v[230:231], v[230:231], v[34:35]
    v_cvt_pk_bf16_f32 v228, v228, v229
    v_cvt_pk_bf16_f32 v229, v230, v231
    s_nop 0
    v_min_u32_dpp v146, v228, v19 quad_perm:[0,1,2,3] row_mask:0xf bank_mask:0x3
    v_min_u32_dpp v147, v229, v19 quad_perm:[0,1,2,3] row_mask:0xf bank_mask:0x3
    buffer_store_dwordx4 v[144:147], v13, s[4:7], s40 offen sc1
    buffer_store_dwordx4 v[144:147], v12, s[4:7], s44 offen sc1
    s_sleep 2
    s_add_u32 m0, s14, 24576
    s_add_u32 s42, s45, 8192
    buffer_load_dwordx4 v15, s[4:7], s45 offen sc1 lds
    buffer_load_dwordx4 v15, s[4:7], s45 offen offset:1024 sc1 lds
    buffer_load_dwordx4 v[136:139], v15, s[4:7], s42 offen sc1
    buffer_load_dwordx4 v[140:143], v15, s[4:7], s42 offen offset:1024 sc1
    s_add_u32 s45, s45, 786432
    s_sleep 3
    buffer_load_dwordx4 v[116:119], v24, s[4:7], s44 offen sc1
    buffer_load_dwordx4 v[104:107], v21, s[4:7], s40 offen sc1
    buffer_load_dwordx4 v[108:111], v22, s[4:7], s40 offen sc1
    buffer_load_dwordx4 v[112:115], v23, s[4:7], s40 offen sc1
    buffer_store_dwordx4 v[184:187], v14, s[4:7], s48 offen sc1
    s_add_u32 s48, s48, 262144
    s_waitcnt vmcnt(4)
    v_mfma_f32_16x16x32_bf16 v[156:159], a[240:243], v[116:119], 0
    v_max3_u32 v30, v116, v117, v118
    v_max_u32 v30, v30, v119
    s_waitcnt vmcnt(3)
    v_mfma_f32_16x16x32_bf16 v[156:159], a[240:243], v[104:107], v[156:159]
    v_max3_u32 v30, v30, v104, v105
    v_max3_u32 v30, v30, v106, v107
    s_waitcnt vmcnt(2)
    v_mfma_f32_16x16x32_bf16 v[156:159], a[240:243], v[108:111], v[156:159]
    v_max3_u32 v30, v30, v108, v109
    v_max3_u32 v30, v30, v110, v111
    s_waitcnt vmcnt(1)
    v_mfma_f32_16x16x32_bf16 v[156:159], a[240:243], v[112:115], v[156:159]
    v_max3_u32 v30, v30, v112, v113
    v_max3_u32 v30, v30, v114, v115
    v_cmp_eq_u32 vcc, -1, v30
    s_nop 3
    s_cbranch_vccnz x2s_sB
x2ok_sB:
    v_add_f32_dpp v160, v156, v156 row_ror:8 row_mask:0xf bank_mask:0xf
    v_add_f32_dpp v161, v157, v157 row_ror:8 row_mask:0xf bank_mask:0xf
    v_add_f32_dpp v162, v158, v158 row_ror:8 row_mask:0xf bank_mask:0xf
    v_add_f32_dpp v163, v159, v159 row_ror:8 row_mask:0xf bank_mask:0xf
    v_cvt_pk_bf16_f32 v30, v160, v161
    v_cvt_pk_bf16_f32 v31, v162, v163
    v_min_u32 v30, -2, v30
    v_min_u32 v31, -2, v31
    buffer_store_dwordx2 v[30:31], v29, s[4:7], s41 offen sc1
    s_barrier
    s_add_u32 s46, s35, 1
    s_and_b32 s47, s46, 63
    s_and_b32 s46, s46, 3
    s_mul_i32 s38, s46, 40960
    s_add_u32 s38, s38, s50
    buffer_load_dwordx4 v[224:227], v2, s[4:7], s38 offen offset:0 sc1
    buffer_load_dwordx4 v[228:231], v2, s[4:7], s38 offen offset:1024 sc1
    v_readlane_b32 s40, v1, s47
    s_mul_i32 s44, s46, 327680
    s_add_u32 s44, s44, 4358144
    s_mul_i32 s39, s46, 262144
    s_add_u32 s39, s39, s51
    s_add_u32 s46, s46, 1
    s_and_b32 s46, s46, 3
    s_mul_i32 s41, s46, 40960
    s_add_u32 s41, s41, s50
    s_add_u32 s35, s35, 1
    s_sleep 1
    buffer_load_dwordx4 v[236:239], v2, s[4:7], s38 offen offset:0 sc1
    buffer_load_dwordx4 v[240:243], v2, s[4:7], s38 offen offset:1024 sc1
    s_branch loop_sB
last_sB:
    v_pk_mul_f32 v[156:157], v[156:157], v[34:35]
    v_pk_mul_f32 v[160:161], v[160:161], v[34:35]
    v_pk_mul_f32 v[158:159], v[158:159], v[34:35]
    v_pk_mul_f32 v[162:163], v[162:163], v[34:35]
    v_cvt_pk_bf16_f32 v184, v156, v157
    v_cvt_pk_bf16_f32 v185, v158, v159
    v_cvt_pk_bf16_f32 v186, v160, v161
    v_cvt_pk_bf16_f32 v187, v162, v163
    buffer_store_dwordx4 v[184:187], v14, s[4:7], s48 offen sc1
    s_add_u32 s48, s48, 262144
    s_waitcnt vmcnt(0)
    s_barrier
    s_endpgm
x3s_sB:
    buffer_load_dwordx4 v[224:227], v2, s[4:7], s38 offen offset:0 sc1
    buffer_load_dwordx4 v[228:231], v2, s[4:7], s38 offen offset:1024 sc1
    s_waitcnt vmcnt(3)
    ds_write_b128 v2, v[236:239] offset:0
    v_max3_u32 v30, v236, v237, v238
    v_max_u32 v30, v30, v239
    s_waitcnt vmcnt(2)
    ds_write_b128 v2, v[240:243] offset:1024
    v_max3_u32 v30, v30, v240, v241
    v_max3_u32 v30, v30, v242, v243
    v_cmp_eq_u32 vcc, -1, v30
    s_waitcnt lgkmcnt(0)
    s_cbranch_vccz x3ok_sB
    buffer_load_dwordx4 v[236:239], v2, s[4:7], s38 offen offset:0 sc1
    buffer_load_dwordx4 v[240:243], v2, s[4:7], s38 offen offset:1024 sc1
    s_waitcnt vmcnt(3)
    ds_write_b128 v2, v[224:227] offset:0
    v_max3_u32 v30, v224, v225, v226
    v_max_u32 v30, v30, v227
    s_waitcnt vmcnt(2)
    ds_write_b128 v2, v[228:231] offset:1024
    v_max3_u32 v30, v30, v228, v229
    v_max3_u32 v30, v30, v230, v231
    v_cmp_eq_u32 vcc, -1, v30
    s_waitcnt lgkmcnt(0)
    s_cbranch_vccz x3ok_sB
    s_sub_u32 s36, s36, 1
    s_cbranch_scc0 x3s_sB
    s_mov_b32 s46, 1
    s_branch chain_abort
qks_sB:
qkt_sB:
    buffer_load_dwordx4 v[248:251], v6, s[4:7], s39 offen sc1
    s_waitcnt vmcnt(1)
    ds_write_b128 v7, v[252:255]
    v_max3_u32 v30, v252, v253, v254
    v_max_u32 v30, v30, v255
    v_cmp_eq_u32 vcc, -1, v30
    s_waitcnt lgkmcnt(0)
    s_cbranch_vccz qkok_sB
    buffer_load_dwordx4 v[252:255], v6, s[4:7], s39 offen sc1
    s_waitcnt vmcnt(1)
    ds_write_b128 v7, v[248:251]
    v_max3_u32 v30, v248, v249, v250
    v_max_u32 v30, v30, v251
    v_cmp_eq_u32 vcc, -1, v30
    s_waitcnt lgkmcnt(0)
    s_cbranch_vccz qkok_sB
    s_sub_u32 s36, s36, 1
    s_cbranch_scc0 qkt_sB
    s_mov_b32 s46, 2
    s_branch chain_abort
pvs_sB:
pvt_sB:
    buffer_load_dwordx4 v[168:171], v10, s[4:7], s39 offen sc1
    s_waitcnt vmcnt(0)
    v_max3_u32 v32, v168, v169, v170
    v_max_u32 v32, v32, v171
    v_cmp_eq_u32 vcc, -1, v32
    s_cbranch_vccz pvok_sB
    s_sub_u32 s36, s36, 1
    s_cbranch_scc0 pvt_sB
    s_mov_b32 s46, 3
    s_branch chain_abort
smx_sB:
    v_mfma_f32_16x16x32_bf16 v[144:147], v[104:107], v[192:195], v[40:43]
    v_mfma_f32_16x16x32_bf16 v[144:147], v[108:111], v[196:199], v[144:147]
    v_mfma_f32_16x16x32_bf16 v[144:147], v[112:115], v[200:203], v[144:147]
    v_mfma_f32_16x16x32_bf16 v[144:147], v[116:119], v[204:207], v[144:147]
    v_mfma_f32_16x16x32_bf16 v[148:151], v[120:123], v[192:195], v[44:47]
    v_mfma_f32_16x16x32_bf16 v[148:151], v[124:127], v[196:199], v[148:151]
    v_mfma_f32_16x16x32_bf16 v[148:151], v[128:131], v[200:203], v[148:151]
    v_mfma_f32_16x16x32_bf16 v[148:151], v[132:135], v[204:207], v[148:151]
    v_mfma_f32_16x16x32_bf16 v[152:155], v[208:211], v[192:195], 0
    v_mfma_f32_16x16x32_bf16 v[152:155], v[212:215], v[196:199], v[152:155]
    v_mfma_f32_16x16x32_bf16 v[152:155], v[216:219], v[200:203], v[152:155]
    v_mfma_f32_16x16x32_bf16 v[152:155], v[220:223], v[204:207], v[152:155]
    s_nop 7
    v_max3_f32 v20, v144, v145, v146
    v_max3_f32 v20, v20, v147, v148
    v_max3_f32 v20, v20, v149, v150
    v_max3_f32 v20, v20, v151, v152
    v_max3_f32 v20, v20, v153, v154
    v_max_f32 v20, v20, v155
    v_mov_b32 v30, v20
    s_nop 1
    v_permlane16_swap_b32 v30, v20
    s_nop 0
    v_max_f32 v20, v20, v30
    v_mov_b32 v30, v20
    s_nop 1
    v_permlane32_swap_b32 v30, v20
    s_nop 0
    v_max_f32 v20, v20, v30
    v_sub_f32 v144, v144, v20
    v_sub_f32 v145, v145, v20
    v_sub_f32 v146, v146, v20
    v_sub_f32 v147, v147, v20
    v_sub_f32 v148, v148, v20
    v_sub_f32 v149, v149, v20
    v_sub_f32 v150, v150, v20
    v_sub_f32 v151, v151, v20
    v_sub_f32 v152, v152, v20
    v_sub_f32 v153, v153, v20
    v_sub_f32 v154, v154, v20
    v_sub_f32 v155, v155, v20
    v_exp_f32 v144, v144
    v_exp_f32 v145, v145
    v_exp_f32 v146, v146
    v_exp_f32 v147, v147
    v_exp_f32 v148, v148
    v_exp_f32 v149, v149
    v_exp_f32 v150, v150
    v_exp_f32 v151, v151
    v_exp_f32 v152, v152
    v_exp_f32 v153, v153
    v_exp_f32 v154, v154
    v_exp_f32 v155, v155
    s_nop 0
    v_cvt_pk_bf16_f32 v164, v144, v145
    v_cvt_pk_bf16_f32 v165, v146, v147
    v_cvt_pk_bf16_f32 v166, v148, v149
    v_cvt_pk_bf16_f32 v167, v150, v151
    v_cvt_pk_bf16_f32 v36, v152, v153
    v_cvt_pk_bf16_f32 v37, v154, v155
    s_nop 1
    v_mfma_f32_16x16x16_bf16 v[156:159], v[168:169], v[36:37], 0
    v_mfma_f32_16x16x16_bf16 v[160:163], v[170:171], v[36:37], 0
    v_mfma_f32_16x16x16_bf16 v[48:51], a[252:253], v[36:37], 0
    s_nop 5
    v_mfma_f32_16x16x32_bf16 v[156:159], v[136:139], v[164:167], v[156:159]
    v_mfma_f32_16x16x32_bf16 v[160:163], v[140:143], v[164:167], v[160:163]
    v_mfma_f32_16x16x32_bf16 v[48:51], a[244:247], v[164:167], v[48:51]
    s_nop 5
    v_cvt_pk_bf16_f32 v184, v156, v157
    v_cvt_pk_bf16_f32 v185, v158, v159
    v_cvt_pk_bf16_f32 v186, v160, v161
    v_cvt_pk_bf16_f32 v187, v162, v163
    ds_write_b128 v11, v[184:187]
    v_rcp_f32 v34, v48
    v_mfma_f32_16x16x32_bf16 v[224:227], v[64:67], v[184:187], 0
    v_mfma_f32_16x16x32_bf16 v[228:231], v[80:83], v[184:187], 0
    s_nop 0
    v_mov_b32 v35, v34
    s_cmp_eq_u32 s35, 63
    s_waitcnt lgkmcnt(0)
    s_branch smok_sB
x2s_sB:
x2t_sB:
    buffer_load_dwordx4 v[116:119], v24, s[4:7], s44 offen sc1
    buffer_load_dwordx4 v[104:107], v21, s[4:7], s40 offen sc1
    buffer_load_dwordx4 v[108:111], v22, s[4:7], s40 offen sc1
    buffer_load_dwordx4 v[112:115], v23, s[4:7], s40 offen sc1
    s_waitcnt vmcnt(3)
    v_mfma_f32_16x16x32_bf16 v[156:159], a[240:243], v[116:119], 0
    v_max3_u32 v30, v116, v117, v118
    v_max_u32 v30, v30, v119
    s_waitcnt vmcnt(2)
    v_mfma_f32_16x16x32_bf16 v[156:159], a[240:243], v[104:107], v[156:159]
    v_max3_u32 v30, v30, v104, v105
    v_max3_u32 v30, v30, v106, v107
    s_waitcnt vmcnt(1)
    v_mfma_f32_16x16x32_bf16 v[156:159], a[240:243], v[108:111], v[156:159]
    v_max3_u32 v30, v30, v108, v109
    v_max3_u32 v30, v30, v110, v111
    s_waitcnt vmcnt(0)
    v_mfma_f32_16x16x32_bf16 v[156:159], a[240:243], v[112:115], v[156:159]
    v_max3_u32 v30, v30, v112, v113
    v_max3_u32 v30, v30, v114, v115
    v_cmp_eq_u32 vcc, -1, v30
    s_nop 3
    s_cbranch_vccz x2ok_sB
    s_sub_u32 s36, s36, 1
    s_cbranch_scc0 x2t_sB
    s_mov_b32 s46, 4
    s_branch chain_abort
entry_sE:
    buffer_load_dwordx4 v[224:227], v2, s[4:7], s38 offen offset:0 sc1
    buffer_load_dwordx4 v[228:231], v2, s[4:7], s38 offen offset:1024 sc1
    buffer_load_dwordx4 v[232:235], v2, s[4:7], s38 offen offset:2048 sc1
    s_waitcnt vmcnt(0)
    buffer_load_dwordx4 v[236:239], v2, s[4:7], s38 offen offset:0 sc1
    buffer_load_dwordx4 v[240:243], v2, s[4:7], s38 offen offset:1024 sc1
    buffer_load_dwordx4 v[244:247], v2, s[4:7], s38 offen offset:2048 sc1
    s_branch loop_sE
.p2align 6
loop_sE:
    s_waitcnt vmcnt(5)
    ds_write_b128 v2, v[224:227] offset:0
    v_max3_u32 v30, v224, v225, v226
    v_max_u32 v30, v30, v227
    s_waitcnt vmcnt(4)
    ds_write_b128 v2, v[228:231] offset:1024
    v_max3_u32 v30, v30, v228, v229
    v_max3_u32 v30, v30, v230, v231
    s_waitcnt vmcnt(3)
    ds_write_b128 v2, v[232:235] offset:2048
    v_max3_u32 v30, v30, v232, v233
    v_max3_u32 v30, v30, v234, v235
    v_cmp_eq_u32 vcc, -1, v30
    s_waitcnt lgkmcnt(0)
    s_cbranch_vccnz x3s_sE
x3ok_sE:
    s_barrier
    ds_read_b128 v[192:195], v3 offset:0
    ds_read_b128 v[196:199], v3 offset:1024
    ds_read_b128 v[200:203], v3 offset:2048
    ds_read_b128 v[204:207], v3 offset:3072
    ds_read_b128 v[208:211], v3 offset:4096
    ds_read_b128 v[212:215], v3 offset:5120
    ds_read_b128 v[216:219], v3 offset:6144
    ds_read_b128 v[220:223], v3 offset:7168
    ds_read_b128 v[144:147], v3 offset:8192
    ds_read_b128 v[148:151], v3 offset:9216
p2c_sE:
    s_waitcnt lgkmcnt(9)
    v_mfma_f32_16x16x32_bf16 v[156:159], a[0:3], v[192:195], 0
    v_mfma_f32_16x16x32_bf16 v[160:163], a[4:7], v[192:195], 0
    s_waitcnt lgkmcnt(8)
    v_mfma_f32_16x16x32_bf16 v[156:159], a[8:11], v[196:199], v[156:159]
    v_mfma_f32_16x16x32_bf16 v[160:163], a[12:15], v[196:199], v[160:163]
    s_waitcnt lgkmcnt(7)
    v_mfma_f32_16x16x32_bf16 v[156:159], a[16:19], v[200:203], v[156:159]
    v_mfma_f32_16x16x32_bf16 v[160:163], a[20:23], v[200:203], v[160:163]
    s_waitcnt lgkmcnt(6)
    v_mfma_f32_16x16x32_bf16 v[156:159], a[24:27], v[204:207], v[156:159]
    v_mfma_f32_16x16x32_bf16 v[160:163], a[28:31], v[204:207], v[160:163]
    s_waitcnt lgkmcnt(5)
    v_mfma_f32_16x16x32_bf16 v[156:159], a[32:35], v[208:211], v[156:159]
    v_mfma_f32_16x16x32_bf16 v[160:163], a[36:39], v[208:211], v[160:163]
    s_waitcnt lgkmcnt(4)
    v_mfma_f32_16x16x32_bf16 v[156:159], a[40:43], v[212:215], v[156:159]
    v_mfma_f32_16x16x32_bf16 v[160:163], a[44:47], v[212:215], v[160:163]
    s_waitcnt lgkmcnt(3)
    v_mfma_f32_16x16x32_bf16 v[156:159], a[48:51], v[216:219], v[156:159]
    v_mfma_f32_16x16x32_bf16 v[160:163], a[52:55], v[216:219], v[160:163]
    s_waitcnt lgkmcnt(2)
    v_mfma_f32_16x16x32_bf16 v[156:159], a[56:59], v[220:223], v[156:159]
    v_mfma_f32_16x16x32_bf16 v[160:163], a[60:63], v[220:223], v[160:163]
    s_waitcnt lgkmcnt(1)
    v_mfma_f32_16x16x32_bf16 v[156:159], a[64:67], v[144:147], v[156:159]
    v_mfma_f32_16x16x32_bf16 v[160:163], a[68:71], v[144:147], v[160:163]
    s_waitcnt lgkmcnt(0)
    v_mfma_f32_16x16x32_bf16 v[156:159], a[72:75], v[148:151], v[156:159]
    v_mfma_f32_16x16x32_bf16 v[160:163], a[76:79], v[148:151], v[160:163]
    v_mfma_f32_16x16x32_bf16 v[52:55], v[192:195], a[80:83], 0
    v_mfma_f32_16x16x32_bf16 v[52:55], v[196:199], a[84:87], v[52:55]
    v_mfma_f32_16x16x32_bf16 v[52:55], v[200:203], a[88:91], v[52:55]
    v_add_f32_dpp v156, v160, v156 row_ror:8 row_mask:0xf bank_mask:0xf
    v_add_f32_dpp v157, v161, v157 row_ror:8 row_mask:0xf bank_mask:0xf
    v_add_f32_dpp v158, v162, v158 row_ror:8 row_mask:0xf bank_mask:0xf
    v_add_f32_dpp v159, v163, v159 row_ror:8 row_mask:0xf bank_mask:0xf
    v_pk_mul_f32 v[156:157], v[156:157], s[12:13]
    v_pk_mul_f32 v[158:159], v[158:159], s[12:13]
    v_cvt_pk_bf16_f32 v30, v156, v157
    v_cvt_pk_bf16_f32 v31, v158, v159
    v_min_u32 v30, -2, v30
    v_min_u32 v31, -2, v31
    buffer_store_dwordx2 v[30:31], v4, s[4:7], s39 offen sc1
    v_mfma_f32_16x16x32_bf16 v[52:55], v[204:207], a[92:95], v[52:55]
    v_mfma_f32_16x16x32_bf16 v[52:55], v[208:211], a[96:99], v[52:55]
    v_mfma_f32_16x16x32_bf16 v[52:55], v[212:215], a[100:103], v[52:55]
    v_mfma_f32_16x16x32_bf16 v[52:55], v[216:219], a[104:107], v[52:55]
    v_mfma_f32_16x16x32_bf16 v[52:55], v[220:223], a[108:111], v[52:55]
    buffer_load_dwordx4 v[248:251], v6, s[4:7], s39 offen sc1
    v_mfma_f32_16x16x32_bf16 v[52:55], v[144:147], a[112:115], v[52:55]
    v_mfma_f32_16x16x32_bf16 v[52:55], v[148:151], a[116:119], v[52:55]
    ds_read_b128 v[104:107], v15 offset:24576
    ds_read_b128 v[108:111], v15 offset:25600
    ds_read_b128 v[112:115], v15 offset:26624
    ds_read_b128 v[116:119], v15 offset:27648
    ds_read_b128 v[120:123], v15 offset:28672
    ds_read_b128 v[124:127], v15 offset:29696
    ds_read_b128 v[128:131], v15 offset:30720
    ds_read_b128 v[132:135], v15 offset:31744
    v_cvt_pk_bf16_f32 v32, v52, v53
    v_cvt_pk_bf16_f32 v33, v54, v55
    v_min_u32 v32, -2, v32
    v_min_u32 v33, -2, v33
    buffer_store_dwordx2 v[32:33], v5, s[4:7], s39 offen sc1
    s_add_u32 s47, s35, 3
    s_lshr_b32 s47, s47, 1
    s_cmp_lt_i32 s29, s47
    s_cbranch_scc1 qp_sE
qpok_sE:
    buffer_load_dwordx4 v[252:255], v6, s[4:7], s39 offen sc1
    s_waitcnt vmcnt(2)
    ds_write_b128 v7, v[248:251]
    v_max3_u32 v30, v248, v249, v250
    v_max_u32 v30, v30, v251
    v_cmp_eq_u32 vcc, -1, v30
    s_waitcnt lgkmcnt(0)
    s_cbranch_vccnz qks_sE
qkok_sE:
    buffer_load_dwordx4 v[168:171], v10, s[4:7], s39 offen sc1
    s_barrier
    ds_read_b128 v[192:195], v8 offset:0
    ds_read_b128 v[196:199], v8 offset:512
    ds_read_b128 v[200:203], v8 offset:1024
    ds_read_b128 v[204:207], v8 offset:1536
    ds_read_b128 v[208:211], v9 offset:0
    ds_read_b128 v[212:215], v9 offset:512
    ds_read_b128 v[216:219], v9 offset:1024
    ds_read_b128 v[220:223], v9 offset:1536
    s_waitcnt lgkmcnt(7)
    v_mfma_f32_16x16x32_bf16 v[144:147], v[104:107], v[192:195], v[40:43]
    s_waitcnt lgkmcnt(6)
    v_mfma_f32_16x16x32_bf16 v[144:147], v[108:111], v[196:199], v[144:147]
    s_waitcnt lgkmcnt(5)
    v_mfma_f32_16x16x32_bf16 v[144:147], v[112:115], v[200:203], v[144:147]
    s_waitcnt lgkmcnt(4)
    v_mfma_f32_16x16x32_bf16 v[144:147], v[116:119], v[204:207], v[144:147]
    s_waitcnt lgkmcnt(3)
    v_mfma_f32_16x16x32_bf16 v[152:155], v[208:211], v[192:195], 0
    s_waitcnt lgkmcnt(2)
    v_mfma_f32_16x16x32_bf16 v[152:155], v[212:215], v[196:199], v[152:155]
    s_waitcnt lgkmcnt(1)
    v_mfma_f32_16x16x32_bf16 v[152:155], v[216:219], v[200:203], v[152:155]
    v_exp_f32 v144, v144
    s_waitcnt lgkmcnt(0)
    v_mfma_f32_16x16x32_bf16 v[152:155], v[220:223], v[204:207], v[152:155]
    v_exp_f32 v145, v145
    v_mfma_f32_16x16x32_bf16 v[148:151], v[120:123], v[192:195], v[44:47]
    v_exp_f32 v146, v146
    v_mfma_f32_16x16x32_bf16 v[148:151], v[124:127], v[196:199], v[148:151]
    v_exp_f32 v147, v147
    v_mfma_f32_16x16x32_bf16 v[148:151], v[128:131], v[200:203], v[148:151]
    v_exp_f32 v152, v152
    v_mfma_f32_16x16x32_bf16 v[148:151], v[132:135], v[204:207], v[148:151]
    v_exp_f32 v153, v153
    v_exp_f32 v154, v154
    v_exp_f32 v155, v155
    s_waitcnt vmcnt(0)
    v_max3_u32 v32, v168, v169, v170
    v_max_u32 v32, v32, v171
    v_cmp_eq_u32 vcc, -1, v32
    v_cvt_pk_bf16_f32 v36, v152, v153
    v_cvt_pk_bf16_f32 v37, v154, v155
    v_exp_f32 v148, v148
    s_cbranch_vccnz pvs_sE
pvok_sE:
    v_mfma_f32_16x16x16_bf16 v[156:159], v[168:169], v[36:37], 0
    v_exp_f32 v149, v149
    buffer_load_dword v18, v25, s[4:7], s88 offen sc1
    v_mfma_f32_16x16x16_bf16 v[160:163], v[170:171], v[36:37], 0
    v_exp_f32 v150, v150
    v_mfma_f32_16x16x16_bf16 v[48:51], a[252:253], v[36:37], 0
    v_exp_f32 v151, v151
    v_cvt_pk_bf16_f32 v164, v144, v145
    v_cvt_pk_bf16_f32 v165, v146, v147
    v_cvt_pk_bf16_f32 v166, v148, v149
    v_cvt_pk_bf16_f32 v167, v150, v151
    s_nop 1
    v_mfma_f32_16x16x32_bf16 v[156:159], v[136:139], v[164:167], v[156:159]
    v_mfma_f32_16x16x32_bf16 v[160:163], v[140:143], v[164:167], v[160:163]
    v_mfma_f32_16x16x32_bf16 v[48:51], a[244:247], v[164:167], v[48:51]
    s_nop 5
    v_cvt_pk_bf16_f32 v184, v156, v157
    v_cvt_pk_bf16_f32 v185, v158, v159
    v_cvt_pk_bf16_f32 v186, v160, v161
    v_cvt_pk_bf16_f32 v187, v162, v163
    ds_write_b128 v11, v[184:187]
    v_rcp_f32 v34, v48
    v_mfma_f32_16x16x32_bf16 v[224:227], v[60:63], v[184:187], 0
    v_mfma_f32_16x16x32_bf16 v[228:231], v[76:79], v[184:187], 0
    v_mfma_f32_16x16x32_bf16 v[232:235], v[92:95], v[184:187], 0
    v_subrev_u32 v30, 0x21800000, v48
    v_cmp_le_u32 vcc, s89, v30
    v_mov_b32 v35, v34
    s_cmp_eq_u32 s35, 63
    s_waitcnt lgkmcnt(0)
    s_cbranch_vccnz smx_sE
smok_sE:
    s_cbranch_scc1 last_sE
    s_barrier
    ds_read_b128 v[192:195], v15 offset:14336
    ds_read_b128 v[200:203], v15 offset:16384
    ds_read_b128 v[204:207], v15 offset:17408
    v_pk_mul_f32 v[156:157], v[156:157], v[34:35]
    v_pk_mul_f32 v[160:161], v[160:161], v[34:35]
    v_pk_mul_f32 v[158:159], v[158:159], v[34:35]
    v_pk_mul_f32 v[162:163], v[162:163], v[34:35]
    v_cvt_pk_bf16_f32 v184, v156, v157
    v_cvt_pk_bf16_f32 v185, v158, v159
    s_waitcnt lgkmcnt(2)
    v_mfma_f32_16x16x32_bf16 v[232:235], v[88:91], v[192:195], v[232:235]
    v_cvt_pk_bf16_f32 v186, v160, v161
    v_cvt_pk_bf16_f32 v187, v162, v163
    s_waitcnt lgkmcnt(1)
    v_mfma_f32_16x16x32_bf16 v[232:235], v[96:99], v[200:203], v[232:235]
    s_waitcnt lgkmcnt(0)
    v_mfma_f32_16x16x32_bf16 v[232:235], v[100:103], v[204:207], v[232:235]
    v_mfma_f32_16x16x32_bf16 v[224:227], v[56:59], v[192:195], v[224:227]
    v_mfma_f32_16x16x32_bf16 v[224:227], v[64:67], v[200:203], v[224:227]
    v_mfma_f32_16x16x32_bf16 v[224:227], v[68:71], v[204:207], v[224:227]
    v_pk_mul_f32 v[232:233], v[232:233], v[34:35]
    v_pk_mul_f32 v[234:235], v[234:235], v[34:35]
    v_cvt_pk_bf16_f32 v232, v232, v233
    v_mfma_f32_16x16x32_bf16 v[228:231], v[72:75], v[192:195], v[228:231]
    v_cvt_pk_bf16_f32 v233, v234, v235
    s_nop 0
    v_min_u32_dpp v144, v232, v19 row_shr:8 row_mask:0xf bank_mask:0xc
    v_min_u32_dpp v145, v233, v19 row_shr:8 row_mask:0xf bank_mask:0xc
    v_mfma_f32_16x16x32_bf16 v[228:231], v[80:83], v[200:203], v[228:231]
    v_min_u32_dpp v146, v232, v19 row_shr:7 row_mask:0xf bank_mask:0xc
    v_min_u32_dpp v147, v233, v19 row_shr:7 row_mask:0xf bank_mask:0xc
    v_mfma_f32_16x16x32_bf16 v[228:231], v[84:87], v[204:207], v[228:231]
    v_pk_mul_f32 v[224:225], v[224:225], v[34:35]
    v_pk_mul_f32 v[226:227], v[226:227], v[34:35]
    v_cvt_pk_bf16_f32 v224, v224, v225
    v_cvt_pk_bf16_f32 v225, v226, v227
    s_nop 1
    v_min_u32_dpp v144, v224, v19 quad_perm:[0,1,2,3] row_mask:0xf bank_mask:0x3
    v_min_u32_dpp v145, v225, v19 quad_perm:[0,1,2,3] row_mask:0xf bank_mask:0x3
    v_pk_mul_f32 v[228:229], v[228:229], v[34:35]
    v_pk_mul_f32 v[230:231], v[230:231], v[34:35]
    v_cvt_pk_bf16_f32 v228, v228, v229
    v_cvt_pk_bf16_f32 v229, v230, v231
    s_nop 0
    v_min_u32_dpp v146, v228, v19 quad_perm:[0,1,2,3] row_mask:0xf bank_mask:0x3
    v_min_u32_dpp v147, v229, v19 quad_perm:[0,1,2,3] row_mask:0xf bank_mask:0x3
    buffer_store_dwordx4 v[144:147], v13, s[4:7], s40 offen sc1
    buffer_store_dwordx4 v[144:147], v12, s[4:7], s44 offen sc1
    s_mov_b32 m0, 22528
    s_nop 0
    buffer_load_dwordx4 v15, s[4:7], s15 offen sc1 lds
    buffer_load_dwordx4 v15, s[4:7], s15 offen offset:1024 sc1 lds
    s_add_u32 s15, s15, 786432
    s_add_u32 m0, s14, 24576
    s_add_u32 s42, s45, 8192
    buffer_load_dwordx4 v15, s[4:7], s45 offen sc1 lds
    buffer_load_dwordx4 v15, s[4:7], s45 offen offset:1024 sc1 lds
    buffer_load_dwordx4 v[136:139], v15, s[4:7], s42 offen sc1
    buffer_load_dwordx4 v[140:143], v15, s[4:7], s42 offen offset:1024 sc1
    s_add_u32 s45, s45, 786432
    s_add_u32 s88, s88, 786432
    s_sleep 3
    buffer_load_dwordx4 v[116:119], v24, s[4:7], s44 offen sc1
    buffer_load_dwordx4 v[104:107], v21, s[4:7], s40 offen sc1
    buffer_load_dwordx4 v[108:111], v22, s[4:7], s40 offen sc1
    buffer_load_dwordx4 v[112:115], v23, s[4:7], s40 offen sc1
    buffer_store_dwordx4 v[184:187], v14, s[4:7], s48 offen sc1
    s_add_u32 s48, s48, 262144
    s_waitcnt vmcnt(4)
    v_mfma_f32_16x16x32_bf16 v[156:159], a[240:243], v[116:119], 0
    v_max3_u32 v30, v116, v117, v118
    v_max_u32 v30, v30, v119
    s_waitcnt vmcnt(3)
    v_mfma_f32_16x16x32_bf16 v[156:159], a[240:243], v[104:107], v[156:159]
    v_max3_u32 v30, v30, v104, v105
    v_max3_u32 v30, v30, v106, v107
    s_waitcnt vmcnt(2)
    v_mfma_f32_16x16x32_bf16 v[156:159], a[240:243], v[108:111], v[156:159]
    v_max3_u32 v30, v30, v108, v109
    v_max3_u32 v30, v30, v110, v111
    s_waitcnt vmcnt(1)
    v_mfma_f32_16x16x32_bf16 v[156:159], a[240:243], v[112:115], v[156:159]
    v_max3_u32 v30, v30, v112, v113
    v_max3_u32 v30, v30, v114, v115
    v_cmp_eq_u32 vcc, -1, v30
    s_nop 3
    s_cbranch_vccnz x2s_sE
x2ok_sE:
    v_add_f32_dpp v160, v156, v156 row_ror:8 row_mask:0xf bank_mask:0xf
    v_add_f32_dpp v161, v157, v157 row_ror:8 row_mask:0xf bank_mask:0xf
    v_add_f32_dpp v162, v158, v158 row_ror:8 row_mask:0xf bank_mask:0xf
    v_add_f32_dpp v163, v159, v159 row_ror:8 row_mask:0xf bank_mask:0xf
    v_cvt_pk_bf16_f32 v30, v160, v161
    v_cvt_pk_bf16_f32 v31, v162, v163
    v_min_u32 v30, -2, v30
    v_min_u32 v31, -2, v31
    buffer_store_dwordx2 v[30:31], v29, s[4:7], s41 offen sc1
    s_barrier
    s_add_u32 s46, s35, 1
    s_and_b32 s47, s46, 63
    s_and_b32 s46, s46, 3
    s_mul_i32 s38, s46, 40960
    s_add_u32 s38, s38, s50
    buffer_load_dwordx4 v[224:227], v2, s[4:7], s38 offen offset:0 sc1
    buffer_load_dwordx4 v[228:231], v2, s[4:7], s38 offen offset:1024 sc1
    buffer_load_dwordx4 v[232:235], v2, s[4:7], s38 offen offset:2048 sc1
    v_readlane_b32 s40, v1, s47
    s_mul_i32 s44, s46, 327680
    s_add_u32 s44, s44, 4358144
    s_mul_i32 s39, s46, 262144
    s_add_u32 s39, s39, s51
    s_add_u32 s46, s46, 1
    s_and_b32 s46, s46, 3
    s_mul_i32 s41, s46, 40960
    s_add_u32 s41, s41, s50
    s_add_u32 s35, s35, 1
    s_sleep 1
    buffer_load_dwordx4 v[236:239], v2, s[4:7], s38 offen offset:0 sc1
    buffer_load_dwordx4 v[240:243], v2, s[4:7], s38 offen offset:1024 sc1
    buffer_load_dwordx4 v[244:247], v2, s[4:7], s38 offen offset:2048 sc1
    s_branch loop_sE
last_sE:
    v_pk_mul_f32 v[156:157], v[156:157], v[34:35]
    v_pk_mul_f32 v[160:161], v[160:161], v[34:35]
    v_pk_mul_f32 v[158:159], v[158:159], v[34:35]
    v_pk_mul_f32 v[162:163], v[162:163], v[34:35]
    v_cvt_pk_bf16_f32 v184, v156, v157
    v_cvt_pk_bf16_f32 v185, v158, v159
    v_cvt_pk_bf16_f32 v186, v160, v161
    v_cvt_pk_bf16_f32 v187, v162, v163
    buffer_store_dwordx4 v[184:187], v14, s[4:7], s48 offen sc1
    s_add_u32 s48, s48, 262144
    s_waitcnt vmcnt(0)
    s_barrier
    s_endpgm
x3s_sE:
    buffer_load_dwordx4 v[224:227], v2, s[4:7], s38 offen offset:0 sc1
    buffer_load_dwordx4 v[228:231], v2, s[4:7], s38 offen offset:1024 sc1
    buffer_load_dwordx4 v[232:235], v2, s[4:7], s38 offen offset:2048 sc1
    s_waitcnt vmcnt(5)
    ds_write_b128 v2, v[236:239] offset:0
    v_max3_u32 v30, v236, v237, v238
    v_max_u32 v30, v30, v239
    s_waitcnt vmcnt(4)
    ds_write_b128 v2, v[240:243] offset:1024
    v_max3_u32 v30, v30, v240, v241
    v_max3_u32 v30, v30, v242, v243
    s_waitcnt vmcnt(3)
    ds_write_b128 v2, v[244:247] offset:2048
    v_max3_u32 v30, v30, v244, v245
    v_max3_u32 v30, v30, v246, v247
    v_cmp_eq_u32 vcc, -1, v30
    s_waitcnt lgkmcnt(0)
    s_cbranch_vccz x3ok_sE
    buffer_load_dwordx4 v[236:239], v2, s[4:7], s38 offen offset:0 sc1
    buffer_load_dwordx4 v[240:243], v2, s[4:7], s38 offen offset:1024 sc1
    buffer_load_dwordx4 v[244:247], v2, s[4:7], s38 offen offset:2048 sc1
    s_waitcnt vmcnt(5)
    ds_write_b128 v2, v[224:227] offset:0
    v_max3_u32 v30, v224, v225, v226
    v_max_u32 v30, v30, v227
    s_waitcnt vmcnt(4)
    ds_write_b128 v2, v[228:231] offset:1024
    v_max3_u32 v30, v30, v228, v229
    v_max3_u32 v30, v30, v230, v231
    s_waitcnt vmcnt(3)
    ds_write_b128 v2, v[232:235] offset:2048
    v_max3_u32 v30, v30, v232, v233
    v_max3_u32 v30, v30, v234, v235
    v_cmp_eq_u32 vcc, -1, v30
    s_waitcnt lgkmcnt(0)
    s_cbranch_vccz x3ok_sE
    s_sub_u32 s36, s36, 1
    s_cbranch_scc0 x3s_sE
    s_mov_b32 s46, 1
    s_branch chain_abort
qp_sE:
    buffer_load_dword v30, v26, s[4:7], 0 offen sc1
    s_waitcnt vmcnt(0)
    v_min_i32_dpp v30, v30, v30 row_ror:2 row_mask:0xf bank_mask:0xf
    s_nop 1
    v_min_i32_dpp v30, v30, v30 row_ror:1 row_mask:0xf bank_mask:0xf
    s_nop 1
    v_readfirstlane_b32 s29, v30
    s_cmp_ge_i32 s29, s47
    s_cbranch_scc1 qpok_sE
    s_sub_u32 s36, s36, 1
    s_cbranch_scc0 qp_sE
    s_mov_b32 s46, 9
    s_branch chain_abort
qks_sE:
qkt_sE:
    buffer_load_dwordx4 v[248:251], v6, s[4:7], s39 offen sc1
    s_waitcnt vmcnt(1)
    ds_write_b128 v7, v[252:255]
    v_max3_u32 v30, v252, v253, v254
    v_max_u32 v30, v30, v255
    v_cmp_eq_u32 vcc, -1, v30
    s_waitcnt lgkmcnt(0)
    s_cbranch_vccz qkok_sE
    buffer_load_dwordx4 v[252:255], v6, s[4:7], s39 offen sc1
    s_waitcnt vmcnt(1)
    ds_write_b128 v7, v[248:251]
    v_max3_u32 v30, v248, v249, v250
    v_max_u32 v30, v30, v251
    v_cmp_eq_u32 vcc, -1, v30
    s_waitcnt lgkmcnt(0)
    s_cbranch_vccz qkok_sE
    s_sub_u32 s36, s36, 1
    s_cbranch_scc0 qkt_sE
    s_mov_b32 s46, 2
    s_branch chain_abort
pvs_sE:
pvt_sE:
    buffer_load_dwordx4 v[168:171], v10, s[4:7], s39 offen sc1
    s_waitcnt vmcnt(0)
    v_max3_u32 v32, v168, v169, v170
    v_max_u32 v32, v32, v171
    v_cmp_eq_u32 vcc, -1, v32
    s_cbranch_vccz pvok_sE
    s_sub_u32 s36, s36, 1
    s_cbranch_scc0 pvt_sE
    s_mov_b32 s46, 3
    s_branch chain_abort
smx_sE:
    v_mfma_f32_16x16x32_bf16 v[144:147], v[104:107], v[192:195], v[40:43]
    v_mfma_f32_16x16x32_bf16 v[144:147], v[108:111], v[196:199], v[144:147]
    v_mfma_f32_16x16x32_bf16 v[144:147], v[112:115], v[200:203], v[144:147]
    v_mfma_f32_16x16x32_bf16 v[144:147], v[116:119], v[204:207], v[144:147]
    v_mfma_f32_16x16x32_bf16 v[148:151], v[120:123], v[192:195], v[44:47]
    v_mfma_f32_16x16x32_bf16 v[148:151], v[124:127], v[196:199], v[148:151]
    v_mfma_f32_16x16x32_bf16 v[148:151], v[128:131], v[200:203], v[148:151]
    v_mfma_f32_16x16x32_bf16 v[148:151], v[132:135], v[204:207], v[148:151]
    v_mfma_f32_16x16x32_bf16 v[152:155], v[208:211], v[192:195], 0
    v_mfma_f32_16x16x32_bf16 v[152:155], v[212:215], v[196:199], v[152:155]
    v_mfma_f32_16x16x32_bf16 v[152:155], v[216:219], v[200:203], v[152:155]
    v_mfma_f32_16x16x32_bf16 v[152:155], v[220:223], v[204:207], v[152:155]
    s_nop 7
    v_max3_f32 v20, v144, v145, v146
    v_max3_f32 v20, v20, v147, v148
    v_max3_f32 v20, v20, v149, v150
    v_max3_f32 v20, v20, v151, v152
    v_max3_f32 v20, v20, v153, v154
    v_max_f32 v20, v20, v155
    v_mov_b32 v30, v20
    s_nop 1
    v_permlane16_swap_b32 v30, v20
    s_nop 0
    v_max_f32 v20, v20, v30
    v_mov_b32 v30, v20
    s_nop 1
    v_permlane32_swap_b32 v30, v20
    s_nop 0
    v_max_f32 v20, v20, v30
    v_sub_f32 v144, v144, v20
    v_sub_f32 v145, v145, v20
    v_sub_f32 v146, v146, v20
    v_sub_f32 v147, v147, v20
    v_sub_f32 v148, v148, v20
    v_sub_f32 v149, v149, v20
    v_sub_f32 v150, v150, v20
    v_sub_f32 v151, v151, v20
    v_sub_f32 v152, v152, v20
    v_sub_f32 v153, v153, v20
    v_sub_f32 v154, v154, v20
    v_sub_f32 v155, v155, v20
    v_exp_f32 v144, v144
    v_exp_f32 v145, v145
    v_exp_f32 v146, v146
    v_exp_f32 v147, v147
    v_exp_f32 v148, v148
    v_exp_f32 v149, v149
    v_exp_f32 v150, v150
    v_exp_f32 v151, v151
    v_exp_f32 v152, v152
    v_exp_f32 v153, v153
    v_exp_f32 v154, v154
    v_exp_f32 v155, v155
    s_nop 0
    v_cvt_pk_bf16_f32 v164, v144, v145
    v_cvt_pk_bf16_f32 v165, v146, v147
    v_cvt_pk_bf16_f32 v166, v148, v149
    v_cvt_pk_bf16_f32 v167, v150, v151
    v_cvt_pk_bf16_f32 v36, v152, v153
    v_cvt_pk_bf16_f32 v37, v154, v155
    s_nop 1
    v_mfma_f32_16x16x16_bf16 v[156:159], v[168:169], v[36:37], 0
    v_mfma_f32_16x16x16_bf16 v[160:163], v[170:171], v[36:37], 0
    v_mfma_f32_16x16x16_bf16 v[48:51], a[252:253], v[36:37], 0
    s_nop 5
    v_mfma_f32_16x16x32_bf16 v[156:159], v[136:139], v[164:167], v[156:159]
    v_mfma_f32_16x16x32_bf16 v[160:163], v[140:143], v[164:167], v[160:163]
    v_mfma_f32_16x16x32_bf16 v[48:51], a[244:247], v[164:167], v[48:51]
    s_nop 5
    v_cvt_pk_bf16_f32 v184, v156, v157
    v_cvt_pk_bf16_f32 v185, v158, v159
    v_cvt_pk_bf16_f32 v186, v160, v161
    v_cvt_pk_bf16_f32 v187, v162, v163
    ds_write_b128 v11, v[184:187]
    v_rcp_f32 v34, v48
    v_mfma_f32_16x16x32_bf16 v[224:227], v[60:63], v[184:187], 0
    v_mfma_f32_16x16x32_bf16 v[228:231], v[76:79], v[184:187], 0
    v_mfma_f32_16x16x32_bf16 v[232:235], v[92:95], v[184:187], 0
    s_nop 0
    v_mov_b32 v35, v34
    s_cmp_eq_u32 s35, 63
    s_waitcnt lgkmcnt(0)
    s_branch smok_sE
x2s_sE:
x2t_sE:
    buffer_load_dwordx4 v[116:119], v24, s[4:7], s44 offen sc1
    buffer_load_dwordx4 v[104:107], v21, s[4:7], s40 offen sc1
    buffer_load_dwordx4 v[108:111], v22, s[4:7], s40 offen sc1
    buffer_load_dwordx4 v[112:115], v23, s[4:7], s40 offen sc1
    s_waitcnt vmcnt(3)
    v_mfma_f32_16x16x32_bf16 v[156:159], a[240:243], v[116:119], 0
    v_max3_u32 v30, v116, v117, v118
    v_max_u32 v30, v30, v119
    s_waitcnt vmcnt(2)
    v_mfma_f32_16x16x32_bf16 v[156:159], a[240:243], v[104:107], v[156:159]
    v_max3_u32 v30, v30, v104, v105
    v_max3_u32 v30, v30, v106, v107
    s_waitcnt vmcnt(1)
    v_mfma_f32_16x16x32_bf16 v[156:159], a[240:243], v[108:111], v[156:159]
    v_max3_u32 v30, v30, v108, v109
    v_max3_u32 v30, v30, v110, v111
    s_waitcnt vmcnt(0)
    v_mfma_f32_16x16x32_bf16 v[156:159], a[240:243], v[112:115], v[156:159]
    v_max3_u32 v30, v30, v112, v113
    v_max3_u32 v30, v30, v114, v115
    v_cmp_eq_u32 vcc, -1, v30
    s_nop 3
    s_cbranch_vccz x2ok_sE
    s_sub_u32 s36, s36, 1
    s_cbranch_scc0 x2t_sE
    s_mov_b32 s46, 4
    s_branch chain_abort
entry_sC:
    buffer_load_dwordx4 v[224:227], v2, s[4:7], s38 offen offset:0 sc1
    buffer_load_dwordx4 v[228:231], v2, s[4:7], s38 offen offset:1024 sc1
    s_waitcnt vmcnt(0)
    buffer_load_dwordx4 v[236:239], v2, s[4:7], s38 offen offset:0 sc1
    buffer_load_dwordx4 v[240:243], v2, s[4:7], s38 offen offset:1024 sc1
    s_branch loop_sC
.p2align 6
loop_sC:
    s_waitcnt vmcnt(3)
    ds_write_b128 v2, v[224:227] offset:0
    v_max3_u32 v30, v224, v225, v226
    v_max_u32 v30, v30, v227
    s_waitcnt vmcnt(2)
    ds_write_b128 v2, v[228:231] offset:1024
    v_max3_u32 v30, v30, v228, v229
    v_max3_u32 v30, v30, v230, v231
    v_cmp_eq_u32 vcc, -1, v30
    s_waitcnt lgkmcnt(0)
    s_cbranch_vccnz x3s_sC
x3ok_sC:
    s_barrier
    ds_read_b128 v[192:195], v3 offset:0
    ds_read_b128 v[196:199], v3 offset:1024
    ds_read_b128 v[200:203], v3 offset:2048
    ds_read_b128 v[204:207], v3 offset:3072
    ds_read_b128 v[208:211], v3 offset:4096
    ds_read_b128 v[212:215], v3 offset:5120
    ds_read_b128 v[216:219], v3 offset:6144
    ds_read_b128 v[220:223], v3 offset:7168
    ds_read_b128 v[144:147], v3 offset:8192
    ds_read_b128 v[148:151], v3 offset:9216
p2c_sC:
    s_waitcnt lgkmcnt(9)
    v_mfma_f32_16x16x32_bf16 v[156:159], a[0:3], v[192:195], 0
    v_mfma_f32_16x16x32_bf16 v[160:163], a[4:7], v[192:195], 0
    s_waitcnt lgkmcnt(8)
    v_mfma_f32_16x16x32_bf16 v[156:159], a[8:11], v[196:199], v[156:159]
    v_mfma_f32_16x16x32_bf16 v[160:163], a[12:15], v[196:199], v[160:163]
    s_waitcnt lgkmcnt(7)
    v_mfma_f32_16x16x32_bf16 v[156:159], a[16:19], v[200:203], v[156:159]
    v_mfma_f32_16x16x32_bf16 v[160:163], a[20:23], v[200:203], v[160:163]
    s_waitcnt lgkmcnt(6)
    v_mfma_f32_16x16x32_bf16 v[156:159], a[24:27], v[204:207], v[156:159]
    v_mfma_f32_16x16x32_bf16 v[160:163], a[28:31], v[204:207], v[160:163]
    s_waitcnt lgkmcnt(5)
    v_mfma_f32_16x16x32_bf16 v[156:159], a[32:35], v[208:211], v[156:159]
    v_mfma_f32_16x16x32_bf16 v[160:163], a[36:39], v[208:211], v[160:163]
    s_waitcnt lgkmcnt(4)
    v_mfma_f32_16x16x32_bf16 v[156:159], a[40:43], v[212:215], v[156:159]
    v_mfma_f32_16x16x32_bf16 v[160:163], a[44:47], v[212:215], v[160:163]
    s_waitcnt lgkmcnt(3)
    v_mfma_f32_16x16x32_bf16 v[156:159], a[48:51], v[216:219], v[156:159]
    v_mfma_f32_16x16x32_bf16 v[160:163], a[52:55], v[216:219], v[160:163]
    s_waitcnt lgkmcnt(2)
    v_mfma_f32_16x16x32_bf16 v[156:159], a[56:59], v[220:223], v[156:159]
    v_mfma_f32_16x16x32_bf16 v[160:163], a[60:63], v[220:223], v[160:163]
    s_waitcnt lgkmcnt(1)
    v_mfma_f32_16x16x32_bf16 v[156:159], a[64:67], v[144:147], v[156:159]
    v_mfma_f32_16x16x32_bf16 v[160:163], a[68:71], v[144:147], v[160:163]
    s_waitcnt lgkmcnt(0)
    v_mfma_f32_16x16x32_bf16 v[156:159], a[72:75], v[148:151], v[156:159]
    v_mfma_f32_16x16x32_bf16 v[160:163], a[76:79], v[148:151], v[160:163]
    v_mfma_f32_16x16x32_bf16 v[52:55], v[192:195], a[80:83], 0
    v_mfma_f32_16x16x32_bf16 v[52:55], v[196:199], a[84:87], v[52:55]
    v_mfma_f32_16x16x32_bf16 v[52:55], v[200:203], a[88:91], v[52:55]
    v_add_f32_dpp v156, v160, v156 row_ror:8 row_mask:0xf bank_mask:0xf
    v_add_f32_dpp v157, v161, v157 row_ror:8 row_mask:0xf bank_mask:0xf
    v_add_f32_dpp v158, v162, v158 row_ror:8 row_mask:0xf bank_mask:0xf
    v_add_f32_dpp v159, v163, v159 row_ror:8 row_mask:0xf bank_mask:0xf
    v_cvt_pk_bf16_f32 v30, v156, v157
    v_cvt_pk_bf16_f32 v31, v158, v159
    v_min_u32 v30, -2, v30
    v_min_u32 v31, -2, v31
    buffer_store_dwordx2 v[30:31], v4, s[4:7], s39 offen sc1
    v_mfma_f32_16x16x32_bf16 v[52:55], v[204:207], a[92:95], v[52:55]
    v_mfma_f32_16x16x32_bf16 v[52:55], v[208:211], a[96:99], v[52:55]
    v_mfma_f32_16x16x32_bf16 v[52:55], v[212:215], a[100:103], v[52:55]
    v_mfma_f32_16x16x32_bf16 v[52:55], v[216:219], a[104:107], v[52:55]
    v_mfma_f32_16x16x32_bf16 v[52:55], v[220:223], a[108:111], v[52:55]
    buffer_load_dwordx4 v[248:251], v6, s[4:7], s39 offen sc1
    v_mfma_f32_16x16x32_bf16 v[52:55], v[144:147], a[112:115], v[52:55]
    v_mfma_f32_16x16x32_bf16 v[52:55], v[148:151], a[116:119], v[52:55]
    ds_read_b128 v[104:107], v15 offset:24576
    ds_read_b128 v[108:111], v15 offset:25600
    ds_read_b128 v[112:115], v15 offset:26624
    ds_read_b128 v[116:119], v15 offset:27648
    ds_read_b128 v[120:123], v15 offset:28672
    ds_read_b128 v[124:127], v15 offset:29696
    ds_read_b128 v[128:131], v15 offset:30720
    ds_read_b128 v[132:135], v15 offset:31744
    v_cvt_pk_bf16_f32 v32, v52, v53
    v_cvt_pk_bf16_f32 v33, v54, v55
    v_min_u32 v32, -2, v32
    v_min_u32 v33, -2, v33
    buffer_store_dwordx2 v[32:33], v5, s[4:7], s39 offen sc1
    buffer_load_dwordx4 v[252:255], v6, s[4:7], s39 offen sc1
    s_waitcnt vmcnt(2)
    ds_write_b128 v7, v[248:251]
    v_max3_u32 v30, v248, v249, v250
    v_max_u32 v30, v30, v251
    v_cmp_eq_u32 vcc, -1, v30
    s_waitcnt lgkmcnt(0)
    s_cbranch_vccnz qks_sC
qkok_sC:
    buffer_load_dwordx4 v[168:171], v10, s[4:7], s39 offen sc1
    s_barrier
    ds_read_b128 v[192:195], v8 offset:0
    ds_read_b128 v[196:199], v8 offset:512
    ds_read_b128 v[200:203], v8 offset:1024
    ds_read_b128 v[204:207], v8 offset:1536
    ds_read_b128 v[208:211], v9 offset:0
    ds_read_b128 v[212:215], v9 offset:512
    ds_read_b128 v[216:219], v9 offset:1024
    ds_read_b128 v[220:223], v9 offset:1536
    s_waitcnt lgkmcnt(7)
    v_mfma_f32_16x16x32_bf16 v[144:147], v[104:107], v[192:195], v[40:43]
    s_waitcnt lgkmcnt(6)
    v_mfma_f32_16x16x32_bf16 v[144:147], v[108:111], v[196:199], v[144:147]
    s_waitcnt lgkmcnt(5)
    v_mfma_f32_16x16x32_bf16 v[144:147], v[112:115], v[200:203], v[144:147]
    s_waitcnt lgkmcnt(4)
    v_mfma_f32_16x16x32_bf16 v[144:147], v[116:119], v[204:207], v[144:147]
    s_waitcnt lgkmcnt(3)
    v_mfma_f32_16x16x32_bf16 v[152:155], v[208:211], v[192:195], 0
    s_waitcnt lgkmcnt(2)
    v_mfma_f32_16x16x32_bf16 v[152:155], v[212:215], v[196:199], v[152:155]
    s_waitcnt lgkmcnt(1)
    v_mfma_f32_16x16x32_bf16 v[152:155], v[216:219], v[200:203], v[152:155]
    v_exp_f32 v144, v144
    s_waitcnt lgkmcnt(0)
    v_mfma_f32_16x16x32_bf16 v[152:155], v[220:223], v[204:207], v[152:155]
    v_exp_f32 v145, v145
    v_mfma_f32_16x16x32_bf16 v[148:151], v[120:123], v[192:195], v[44:47]
    v_exp_f32 v146, v146
    v_mfma_f32_16x16x32_bf16 v[148:151], v[124:127], v[196:199], v[148:151]
    v_exp_f32 v147, v147
    v_mfma_f32_16x16x32_bf16 v[148:151], v[128:131], v[200:203], v[148:151]
    v_exp_f32 v152, v152
    v_mfma_f32_16x16x32_bf16 v[148:151], v[132:135], v[204:207], v[148:151]
    v_exp_f32 v153, v153
    v_exp_f32 v154, v154
    v_exp_f32 v155, v155
    s_waitcnt vmcnt(0)
    v_max3_u32 v32, v168, v169, v170
    v_max_u32 v32, v32, v171
    v_cmp_eq_u32 vcc, -1, v32
    v_cvt_pk_bf16_f32 v36, v152, v153
    v_cvt_pk_bf16_f32 v37, v154, v155
    v_exp_f32 v148, v148
    s_cbranch_vccnz pvs_sC
pvok_sC:
    v_mfma_f32_16x16x16_bf16 v[156:159], v[168:169], v[36:37], 0
    v_exp_f32 v149, v149
    v_mfma_f32_16x16x16_bf16 v[160:163], v[170:171], v[36:37], 0
    v_exp_f32 v150, v150
    v_mfma_f32_16x16x16_bf16 v[48:51], a[252:253], v[36:37], 0
    v_exp_f32 v151, v151
    v_cvt_pk_bf16_f32 v164, v144, v145
    v_cvt_pk_bf16_f32 v165, v146, v147
    v_cvt_pk_bf16_f32 v166, v148, v149
    v_cvt_pk_bf16_f32 v167, v150, v151
    s_nop 1
    v_mfma_f32_16x16x32_bf16 v[156:159], v[136:139], v[164:167], v[156:159]
    v_mfma_f32_16x16x32_bf16 v[160:163], v[140:143], v[164:167], v[160:163]
    v_mfma_f32_16x16x32_bf16 v[48:51], a[244:247], v[164:167], v[48:51]
    s_nop 5
    v_cvt_pk_bf16_f32 v184, v156, v157
    v_cvt_pk_bf16_f32 v185, v158, v159
    v_cvt_pk_bf16_f32 v186, v160, v161
    v_cvt_pk_bf16_f32 v187, v162, v163
    ds_write_b128 v11, v[184:187]
    v_rcp_f32 v34, v48
    v_mfma_f32_16x16x32_bf16 v[224:227], v[68:71], v[184:187], 0
    v_mfma_f32_16x16x32_bf16 v[228:231], v[84:87], v[184:187], 0
    v_subrev_u32 v30, 0x21800000, v48
    v_cmp_le_u32 vcc, s89, v30
    v_mov_b32 v35, v34
    s_cmp_eq_u32 s35, 63
    s_waitcnt lgkmcnt(0)
    s_cbranch_vccnz smx_sC
smok_sC:
    s_cbranch_scc1 last_sC
    s_barrier
    ds_read_b128 v[192:195], v15 offset:14336
    ds_read_b128 v[196:199], v15 offset:15360
    ds_read_b128 v[200:203], v15 offset:16384
    v_pk_mul_f32 v[156:157], v[156:157], v[34:35]
    v_pk_mul_f32 v[160:161], v[160:161], v[34:35]
    v_pk_mul_f32 v[158:159], v[158:159], v[34:35]
    v_pk_mul_f32 v[162:163], v[162:163], v[34:35]
    v_cvt_pk_bf16_f32 v184, v156, v157
    v_cvt_pk_bf16_f32 v185, v158, v159
    s_waitcnt lgkmcnt(2)
    v_mfma_f32_16x16x32_bf16 v[224:227], v[56:59], v[192:195], v[224:227]
    v_cvt_pk_bf16_f32 v186, v160, v161
    v_cvt_pk_bf16_f32 v187, v162, v163
    s_waitcnt lgkmcnt(1)
    v_mfma_f32_16x16x32_bf16 v[224:227], v[60:63], v[196:199], v[224:227]
    s_waitcnt lgkmcnt(0)
    v_mfma_f32_16x16x32_bf16 v[224:227], v[64:67], v[200:203], v[224:227]
    v_mfma_f32_16x16x32_bf16 v[228:231], v[72:75], v[192:195], v[228:231]
    v_mfma_f32_16x16x32_bf16 v[228:231], v[76:79], v[196:199], v[228:231]
    v_mfma_f32_16x16x32_bf16 v[228:231], v[80:83], v[200:203], v[228:231]
    v_pk_mul_f32 v[224:225], v[224:225], v[34:35]
    v_pk_mul_f32 v[226:227], v[226:227], v[34:35]
    v_cvt_pk_bf16_f32 v224, v224, v225
    v_cvt_pk_bf16_f32 v225, v226, v227
    s_nop 1
    v_min_u32_dpp v144, v224, v19 quad_perm:[0,1,2,3] row_mask:0xf bank_mask:0x3
    v_min_u32_dpp v145, v225, v19 quad_perm:[0,1,2,3] row_mask:0xf bank_mask:0x3
    v_pk_mul_f32 v[228:229], v[228:229], v[34:35]
    v_pk_mul_f32 v[230:231], v[230:231], v[34:35]
    v_cvt_pk_bf16_f32 v228, v228, v229
    v_cvt_pk_bf16_f32 v229, v230, v231
    s_nop 0
    v_min_u32_dpp v146, v228, v19 quad_perm:[0,1,2,3] row_mask:0xf bank_mask:0x3
    v_min_u32_dpp v147, v229, v19 quad_perm:[0,1,2,3] row_mask:0xf bank_mask:0x3
    buffer_store_dwordx4 v[144:147], v13, s[4:7], s40 offen sc1
    buffer_store_dwordx4 v[144:147], v12, s[4:7], s44 offen sc1
    s_sleep 2
    s_add_u32 m0, s14, 24576
    s_add_u32 s42, s45, 8192
    buffer_load_dwordx4 v15, s[4:7], s45 offen sc1 lds
    buffer_load_dwordx4 v15, s[4:7], s45 offen offset:1024 sc1 lds
    buffer_load_dwordx4 v[136:139], v15, s[4:7], s42 offen sc1
    buffer_load_dwordx4 v[140:143], v15, s[4:7], s42 offen offset:1024 sc1
    s_add_u32 s45, s45, 786432
    s_sleep 3
    buffer_load_dwordx4 v[116:119], v24, s[4:7], s44 offen sc1
    buffer_load_dwordx4 v[104:107], v21, s[4:7], s40 offen sc1
    buffer_load_dwordx4 v[108:111], v22, s[4:7], s40 offen sc1
    buffer_load_dwordx4 v[112:115], v23, s[4:7], s40 offen sc1
    buffer_store_dwordx4 v[184:187], v14, s[4:7], s48 offen sc1
    s_add_u32 s48, s48, 262144
    s_waitcnt vmcnt(4)
    v_mfma_f32_16x16x32_bf16 v[156:159], a[240:243], v[116:119], 0
    v_max3_u32 v30, v116, v117, v118
    v_max_u32 v30, v30, v119
    s_waitcnt vmcnt(3)
    v_mfma_f32_16x16x32_bf16 v[156:159], a[240:243], v[104:107], v[156:159]
    v_max3_u32 v30, v30, v104, v105
    v_max3_u32 v30, v30, v106, v107
    s_waitcnt vmcnt(2)
    v_mfma_f32_16x16x32_bf16 v[156:159], a[240:243], v[108:111], v[156:159]
    v_max3_u32 v30, v30, v108, v109
    v_max3_u32 v30, v30, v110, v111
    s_waitcnt vmcnt(1)
    v_mfma_f32_16x16x32_bf16 v[156:159], a[240:243], v[112:115], v[156:159]
    v_max3_u32 v30, v30, v112, v113
    v_max3_u32 v30, v30, v114, v115
    v_cmp_eq_u32 vcc, -1, v30
    s_nop 3
    s_cbranch_vccnz x2s_sC
x2ok_sC:
    v_add_f32_dpp v160, v156, v156 row_ror:8 row_mask:0xf bank_mask:0xf
    v_add_f32_dpp v161, v157, v157 row_ror:8 row_mask:0xf bank_mask:0xf
    v_add_f32_dpp v162, v158, v158 row_ror:8 row_mask:0xf bank_mask:0xf
    v_add_f32_dpp v163, v159, v159 row_ror:8 row_mask:0xf bank_mask:0xf
    v_cvt_pk_bf16_f32 v30, v160, v161
    v_cvt_pk_bf16_f32 v31, v162, v163
    v_min_u32 v30, -2, v30
    v_min_u32 v31, -2, v31
    buffer_store_dwordx2 v[30:31], v29, s[4:7], s41 offen sc1
    s_barrier
    s_add_u32 s46, s35, 1
    s_and_b32 s47, s46, 63
    s_and_b32 s46, s46, 3
    s_mul_i32 s38, s46, 40960
    s_add_u32 s38, s38, s50
    buffer_load_dwordx4 v[224:227], v2, s[4:7], s38 offen offset:0 sc1
    buffer_load_dwordx4 v[228:231], v2, s[4:7], s38 offen offset:1024 sc1
    v_readlane_b32 s40, v1, s47
    s_mul_i32 s44, s46, 327680
    s_add_u32 s44, s44, 4358144
    s_mul_i32 s39, s46, 262144
    s_add_u32 s39, s39, s51
    s_add_u32 s46, s46, 1
    s_and_b32 s46, s46, 3
    s_mul_i32 s41, s46, 40960
    s_add_u32 s41, s41, s50
    s_add_u32 s35, s35, 1
    s_sleep 1
    buffer_load_dwordx4 v[236:239], v2, s[4:7], s38 offen offset:0 sc1
    buffer_load_dwordx4 v[240:243], v2, s[4:7], s38 offen offset:1024 sc1
    s_branch loop_sC
last_sC:
    v_pk_mul_f32 v[156:157], v[156:157], v[34:35]
    v_pk_mul_f32 v[160:161], v[160:161], v[34:35]
    v_pk_mul_f32 v[158:159], v[158:159], v[34:35]
    v_pk_mul_f32 v[162:163], v[162:163], v[34:35]
    v_cvt_pk_bf16_f32 v184, v156, v157
    v_cvt_pk_bf16_f32 v185, v158, v159
    v_cvt_pk_bf16_f32 v186, v160, v161
    v_cvt_pk_bf16_f32 v187, v162, v163
    buffer_store_dwordx4 v[184:187], v14, s[4:7], s48 offen sc1
    s_add_u32 s48, s48, 262144
    s_waitcnt vmcnt(0)
    s_barrier
    s_endpgm
x3s_sC:
    buffer_load_dwordx4 v[224:227], v2, s[4:7], s38 offen offset:0 sc1
    buffer_load_dwordx4 v[228:231], v2, s[4:7], s38 offen offset:1024 sc1
    s_waitcnt vmcnt(3)
    ds_write_b128 v2, v[236:239] offset:0
    v_max3_u32 v30, v236, v237, v238
    v_max_u32 v30, v30, v239
    s_waitcnt vmcnt(2)
    ds_write_b128 v2, v[240:243] offset:1024
    v_max3_u32 v30, v30, v240, v241
    v_max3_u32 v30, v30, v242, v243
    v_cmp_eq_u32 vcc, -1, v30
    s_waitcnt lgkmcnt(0)
    s_cbranch_vccz x3ok_sC
    buffer_load_dwordx4 v[236:239], v2, s[4:7], s38 offen offset:0 sc1
    buffer_load_dwordx4 v[240:243], v2, s[4:7], s38 offen offset:1024 sc1
    s_waitcnt vmcnt(3)
    ds_write_b128 v2, v[224:227] offset:0
    v_max3_u32 v30, v224, v225, v226
    v_max_u32 v30, v30, v227
    s_waitcnt vmcnt(2)
    ds_write_b128 v2, v[228:231] offset:1024
    v_max3_u32 v30, v30, v228, v229
    v_max3_u32 v30, v30, v230, v231
    v_cmp_eq_u32 vcc, -1, v30
    s_waitcnt lgkmcnt(0)
    s_cbranch_vccz x3ok_sC
    s_sub_u32 s36, s36, 1
    s_cbranch_scc0 x3s_sC
    s_mov_b32 s46, 1
    s_branch chain_abort
qks_sC:
qkt_sC:
    buffer_load_dwordx4 v[248:251], v6, s[4:7], s39 offen sc1
    s_waitcnt vmcnt(1)
    ds_write_b128 v7, v[252:255]
    v_max3_u32 v30, v252, v253, v254
    v_max_u32 v30, v30, v255
    v_cmp_eq_u32 vcc, -1, v30
    s_waitcnt lgkmcnt(0)
    s_cbranch_vccz qkok_sC
    buffer_load_dwordx4 v[252:255], v6, s[4:7], s39 offen sc1
    s_waitcnt vmcnt(1)
    ds_write_b128 v7, v[248:251]
    v_max3_u32 v30, v248, v249, v250
    v_max_u32 v30, v30, v251
    v_cmp_eq_u32 vcc, -1, v30
    s_waitcnt lgkmcnt(0)
    s_cbranch_vccz qkok_sC
    s_sub_u32 s36, s36, 1
    s_cbranch_scc0 qkt_sC
    s_mov_b32 s46, 2
    s_branch chain_abort
pvs_sC:
pvt_sC:
    buffer_load_dwordx4 v[168:171], v10, s[4:7], s39 offen sc1
    s_waitcnt vmcnt(0)
    v_max3_u32 v32, v168, v169, v170
    v_max_u32 v32, v32, v171
    v_cmp_eq_u32 vcc, -1, v32
    s_cbranch_vccz pvok_sC
    s_sub_u32 s36, s36, 1
    s_cbranch_scc0 pvt_sC
    s_mov_b32 s46, 3
    s_branch chain_abort
smx_sC:
    v_mfma_f32_16x16x32_bf16 v[144:147], v[104:107], v[192:195], v[40:43]
    v_mfma_f32_16x16x32_bf16 v[144:147], v[108:111], v[196:199], v[144:147]
    v_mfma_f32_16x16x32_bf16 v[144:147], v[112:115], v[200:203], v[144:147]
    v_mfma_f32_16x16x32_bf16 v[144:147], v[116:119], v[204:207], v[144:147]
    v_mfma_f32_16x16x32_bf16 v[148:151], v[120:123], v[192:195], v[44:47]
    v_mfma_f32_16x16x32_bf16 v[148:151], v[124:127], v[196:199], v[148:151]
    v_mfma_f32_16x16x32_bf16 v[148:151], v[128:131], v[200:203], v[148:151]
    v_mfma_f32_16x16x32_bf16 v[148:151], v[132:135], v[204:207], v[148:151]
    v_mfma_f32_16x16x32_bf16 v[152:155], v[208:211], v[192:195], 0
    v_mfma_f32_16x16x32_bf16 v[152:155], v[212:215], v[196:199], v[152:155]
    v_mfma_f32_16x16x32_bf16 v[152:155], v[216:219], v[200:203], v[152:155]
    v_mfma_f32_16x16x32_bf16 v[152:155], v[220:223], v[204:207], v[152:155]
    s_nop 7
    v_max3_f32 v20, v144, v145, v146
    v_max3_f32 v20, v20, v147, v148
    v_max3_f32 v20, v20, v149, v150
    v_max3_f32 v20, v20, v151, v152
    v_max3_f32 v20, v20, v153, v154
    v_max_f32 v20, v20, v155
    v_mov_b32 v30, v20
    s_nop 1
    v_permlane16_swap_b32 v30, v20
    s_nop 0
    v_max_f32 v20, v20, v30
    v_mov_b32 v30, v20
    s_nop 1
    v_permlane32_swap_b32 v30, v20
    s_nop 0
    v_max_f32 v20, v20, v30
    v_sub_f32 v144, v144, v20
    v_sub_f32 v145, v145, v20
    v_sub_f32 v146, v146, v20
    v_sub_f32 v147, v147, v20
    v_sub_f32 v148, v148, v20
    v_sub_f32 v149, v149, v20
    v_sub_f32 v150, v150, v20
    v_sub_f32 v151, v151, v20
    v_sub_f32 v152, v152, v20
    v_sub_f32 v153, v153, v20
    v_sub_f32 v154, v154, v20
    v_sub_f32 v155, v155, v20
    v_exp_f32 v144, v144
    v_exp_f32 v145, v145
    v_exp_f32 v146, v146
    v_exp_f32 v147, v147
    v_exp_f32 v148, v148
    v_exp_f32 v149, v149
    v_exp_f32 v150, v150
    v_exp_f32 v151, v151
    v_exp_f32 v152, v152
    v_exp_f32 v153, v153
    v_exp_f32 v154, v154
    v_exp_f32 v155, v155
    s_nop 0
    v_cvt_pk_bf16_f32 v164, v144, v145
    v_cvt_pk_bf16_f32 v165, v146, v147
    v_cvt_pk_bf16_f32 v166, v148, v149
    v_cvt_pk_bf16_f32 v167, v150, v151
    v_cvt_pk_bf16_f32 v36, v152, v153
    v_cvt_pk_bf16_f32 v37, v154, v155
    s_nop 1
    v_mfma_f32_16x16x16_bf16 v[156:159], v[168:169], v[36:37], 0
    v_mfma_f32_16x16x16_bf16 v[160:163], v[170:171], v[36:37], 0
    v_mfma_f32_16x16x16_bf16 v[48:51], a[252:253], v[36:37], 0
    s_nop 5
    v_mfma_f32_16x16x32_bf16 v[156:159], v[136:139], v[164:167], v[156:159]
    v_mfma_f32_16x16x32_bf16 v[160:163], v[140:143], v[164:167], v[160:163]
    v_mfma_f32_16x16x32_bf16 v[48:51], a[244:247], v[164:167], v[48:51]
    s_nop 5
    v_cvt_pk_bf16_f32 v184, v156, v157
    v_cvt_pk_bf16_f32 v185, v158, v159
    v_cvt_pk_bf16_f32 v186, v160, v161
    v_cvt_pk_bf16_f32 v187, v162, v163
    ds_write_b128 v11, v[184:187]
    v_rcp_f32 v34, v48
    v_mfma_f32_16x16x32_bf16 v[224:227], v[68:71], v[184:187], 0
    v_mfma_f32_16x16x32_bf16 v[228:231], v[84:87], v[184:187], 0
    s_nop 0
    v_mov_b32 v35, v34
    s_cmp_eq_u32 s35, 63
    s_waitcnt lgkmcnt(0)
    s_branch smok_sC
x2s_sC:
x2t_sC:
    buffer_load_dwordx4 v[116:119], v24, s[4:7], s44 offen sc1
    buffer_load_dwordx4 v[104:107], v21, s[4:7], s40 offen sc1
    buffer_load_dwordx4 v[108:111], v22, s[4:7], s40 offen sc1
    buffer_load_dwordx4 v[112:115], v23, s[4:7], s40 offen sc1
    s_waitcnt vmcnt(3)
    v_mfma_f32_16x16x32_bf16 v[156:159], a[240:243], v[116:119], 0
    v_max3_u32 v30, v116, v117, v118
    v_max_u32 v30, v30, v119
    s_waitcnt vmcnt(2)
    v_mfma_f32_16x16x32_bf16 v[156:159], a[240:243], v[104:107], v[156:159]
    v_max3_u32 v30, v30, v104, v105
    v_max3_u32 v30, v30, v106, v107
    s_waitcnt vmcnt(1)
    v_mfma_f32_16x16x32_bf16 v[156:159], a[240:243], v[108:111], v[156:159]
    v_max3_u32 v30, v30, v108, v109
    v_max3_u32 v30, v30, v110, v111
    s_waitcnt vmcnt(0)
    v_mfma_f32_16x16x32_bf16 v[156:159], a[240:243], v[112:115], v[156:159]
    v_max3_u32 v30, v30, v112, v113
    v_max3_u32 v30, v30, v114, v115
    v_cmp_eq_u32 vcc, -1, v30
    s_nop 3
    s_cbranch_vccz x2ok_sC
    s_sub_u32 s36, s36, 1
    s_cbranch_scc0 x2t_sC
    s_mov_b32 s46, 4
    s_branch chain_abort
chain_abort10:
    s_mov_b32 s46, 10
chain_abort:
    s_mov_b32 s8, s24
    s_and_b32 s9, s25, 0xffff
    s_mov_b32 s10, 0x100
    s_mov_b32 s11, 0x00020000
    v_mov_b32 v30, s46
    v_mov_b32 v31, 0
    buffer_store_dword v30, v31, s[8:11], 0 offen
    s_endpgm
bulk_entry:
    s_getpc_b64 s[64:65]
    s_lshr_b32 s3, s2, 3
    s_mul_i32 s3, s3, 768
    v_lshlrev_b32 v252, 7, v0
    v_add_u32 v252, s3, v252
    v_cmp_gt_u32 vcc, 6, v0
    s_and_saveexec_b64 s[66:67], vcc
    s_cbranch_execz cpf_8
    global_load_dword v253, v252, s[64:65]
cpf_8:
    s_mov_b64 exec, s[66:67]
    s_load_dwordx4 s[44:47], s[0:1], 64
    s_load_dwordx4 s[48:51], s[0:1], 80
    s_load_dwordx4 s[52:55], s[0:1], 96
    s_load_dwordx2 s[56:57], s[0:1], 40
    s_load_dwordx4 s[60:63], s[0:1], 0
    s_load_dwordx4 s[88:91], s[0:1], 16
    s_load_dwordx2 s[58:59], s[0:1], 32
    v_lshrrev_b32 v247, 6, v0
    v_and_b32 v244, 63, v0
    v_readfirstlane_b32 s30, v247
    v_bfe_u32 v245, v0, 4, 2
    v_and_b32 v246, 15, v0
    s_lshr_b32 s31, s2, 3
    s_lshl_b32 s31, s31, 2
    s_and_b32 s43, s2, 3
    s_add_u32 s31, s31, s43
    v_mov_b32 v248, s31
    s_lshl_b32 s92, s43, 5
    s_lshr_b32 s3, s31, 2
    s_add_u32 s92, s92, s3
    v_mov_b32 v249, s92
    s_mov_b32 s38, 0x400000
    v_lshlrev_b32 v200, 0x4, v244
    v_mov_b32 v1, v200
    v_lshrrev_b32 v200, 0x1, v249
    v_lshlrev_b32 v201, 0x5, v200
    v_add_u32 v202, v246, v201
    v_mul_u32_u24 v203, 0x500, v202
    v_mul_u32_u24 v204, 0x140, v247
    v_add_u32 v205, v204, v203
    v_lshlrev_b32 v206, 0x4, v245
    v_add_u32 v207, v206, v205
    v_mov_b32 v6, v207
    v_lshrrev_b32 v200, 0x3, v244
    v_lshlrev_b32 v201, 0xd, v200
    v_lshrrev_b32 v202, 0x1, v244
    v_and_b32 v203, 0x3, v202
    v_lshrrev_b32 v204, 0x4, v244
    v_and_b32 v205, 0x1, v204
    v_and_b32 v206, 0x1, v247
    v_lshlrev_b32 v207, 0x1, v206
    v_or_b32 v208, v207, v205
    v_xor_b32 v209, v208, v203
    v_lshlrev_b32 v210, 0x1, v209
    v_and_b32 v211, 0x1, v244
    v_add_u32 v212, v211, v210
    v_lshlrev_b32 v213, 0x4, v212
    v_add_u32 v214, v213, v201
    v_lshrrev_b32 v215, 0x2, v249
    v_lshlrev_b32 v216, 0x8, v215
    v_add_u32 v217, v216, v214
    v_and_b32 v218, 0x2, v249
    v_lshlrev_b32 v219, 0x6, v218
    v_add_u32 v220, v219, v217
    v_mov_b32 v2, v220
    s_waitcnt lgkmcnt(0)
    s_mov_b32 s4, s54
    s_and_b32 s5, s55, 0xffff
    s_mov_b32 s6, 0x10000000
    s_mov_b32 s7, 0x00020000
    s_mov_b32 s8, s60
    s_and_b32 s9, s61, 0xffff
    s_mov_b32 s10, 0x280000
    s_mov_b32 s11, 0x00020000
    s_mov_b32 s20, s52
    s_and_b32 s21, s53, 0xffff
    s_mov_b32 s22, 0x100
    s_mov_b32 s23, 0x00020000
    v_cmp_eq_u32 vcc, 0, v0
    v_mov_b32 v200, 0x0
    v_mov_b32 v201, 0x40000000
    s_nop 1
    v_cndmask_b32 v202, v201, v200, vcc
    v_mov_b32 v16, v202
    v_lshlrev_b32 v200, 0x3, v244
    v_mov_b32 v14, v200
    s_and_b32 s3, s92, 1
    s_cbranch_scc0 b_even
    s_movk_i32 s26, 0x5000
    buffer_load_dwordx4 v[32:35], v6, s[8:11], 0 offen offset:0
    buffer_load_dwordx4 v[36:39], v6, s[8:11], 0 offen offset:64
    buffer_load_dwordx4 v[40:43], v6, s[8:11], 0 offen offset:128
    buffer_load_dwordx4 v[44:47], v6, s[8:11], 0 offen offset:192
    buffer_load_dwordx4 v[48:51], v6, s[8:11], 0 offen offset:256
    buffer_load_dwordx4 v[112:115], v6, s[8:11], s26 offen offset:0
    buffer_load_dwordx4 v[116:119], v6, s[8:11], s26 offen offset:64
    buffer_load_dwordx4 v[120:123], v6, s[8:11], s26 offen offset:128
    buffer_load_dwordx4 v[124:127], v6, s[8:11], s26 offen offset:192
    buffer_load_dwordx4 v[128:131], v6, s[8:11], s26 offen offset:256
    v_lshrrev_b32 v200, 0x1, v249
    v_mul_u32_u24 v201, 0xa000, v200
    v_mul_u32_u24 v202, 0x1400, v247
    v_add_u32 v203, v202, v201
    v_add_u32 v204, v1, v203
    v_mov_b32 v7, v204
    v_lshlrev_b32 v200, 0x6, v247
    v_lshlrev_b32 v201, 0x2, v246
    v_add_u32 v202, v201, v200
    v_mov_b32 v12, v202
    v_lshlrev_b32 v200, 0x2, v246
    v_mov_b32 v13, v200
    s_mov_b32 s32, 0
    s_waitcnt vmcnt(0)
ln_loop:
    v_lshlrev_b32 v64, 16, v32
    v_and_b32 v65, 0xffff0000, v32
    v_lshlrev_b32 v66, 16, v33
    v_and_b32 v67, 0xffff0000, v33
    v_lshlrev_b32 v68, 16, v34
    v_and_b32 v69, 0xffff0000, v34
    v_lshlrev_b32 v70, 16, v35
    v_and_b32 v71, 0xffff0000, v35
    v_lshlrev_b32 v72, 16, v36
    v_and_b32 v73, 0xffff0000, v36
    v_lshlrev_b32 v74, 16, v37
    v_and_b32 v75, 0xffff0000, v37
    v_lshlrev_b32 v76, 16, v38
    v_and_b32 v77, 0xffff0000, v38
    v_lshlrev_b32 v78, 16, v39
    v_and_b32 v79, 0xffff0000, v39
    v_lshlrev_b32 v80, 16, v40
    v_and_b32 v81, 0xffff0000, v40
    v_lshlrev_b32 v82, 16, v41
    v_and_b32 v83, 0xffff0000, v41
    v_lshlrev_b32 v84, 16, v42
    v_and_b32 v85, 0xffff0000, v42
    v_lshlrev_b32 v86, 16, v43
    v_and_b32 v87, 0xffff0000, v43
    v_lshlrev_b32 v88, 16, v44
    v_and_b32 v89, 0xffff0000, v44
    v_lshlrev_b32 v90, 16, v45
    v_and_b32 v91, 0xffff0000, v45
    v_lshlrev_b32 v92, 16, v46
    v_and_b32 v93, 0xffff0000, v46
    v_lshlrev_b32 v94, 16, v47
    v_and_b32 v95, 0xffff0000, v47
    v_lshlrev_b32 v96, 16, v48
    v_and_b32 v97, 0xffff0000, v48
    v_lshlrev_b32 v98, 16, v49
    v_and_b32 v99, 0xffff0000, v49
    v_lshlrev_b32 v100, 16, v50
    v_and_b32 v101, 0xffff0000, v50
    v_lshlrev_b32 v102, 16, v51
    v_and_b32 v103, 0xffff0000, v51
    v_add_f32 v8, v64, v65
    v_add_f32 v8, v8, v66
    v_add_f32 v8, v8, v67
    v_add_f32 v8, v8, v68
    v_add_f32 v8, v8, v69
    v_add_f32 v8, v8, v70
    v_add_f32 v8, v8, v71
    v_add_f32 v8, v8, v72
    v_add_f32 v8, v8, v73
    v_add_f32 v8, v8, v74
    v_add_f32 v8, v8, v75
    v_add_f32 v8, v8, v76
    v_add_f32 v8, v8, v77
    v_add_f32 v8, v8, v78
    v_add_f32 v8, v8, v79
    v_add_f32 v8, v8, v80
    v_add_f32 v8, v8, v81
    v_add_f32 v8, v8, v82
    v_add_f32 v8, v8, v83
    v_add_f32 v8, v8, v84
    v_add_f32 v8, v8, v85
    v_add_f32 v8, v8, v86
    v_add_f32 v8, v8, v87
    v_add_f32 v8, v8, v88
    v_add_f32 v8, v8, v89
    v_add_f32 v8, v8, v90
    v_add_f32 v8, v8, v91
    v_add_f32 v8, v8, v92
    v_add_f32 v8, v8, v93
    v_add_f32 v8, v8, v94
    v_add_f32 v8, v8, v95
    v_add_f32 v8, v8, v96
    v_add_f32 v8, v8, v97
    v_add_f32 v8, v8, v98
    v_add_f32 v8, v8, v99
    v_add_f32 v8, v8, v100
    v_add_f32 v8, v8, v101
    v_add_f32 v8, v8, v102
    v_add_f32 v8, v8, v103
    v_mov_b32 v9, v8
    s_nop 1
    v_permlane16_swap_b32 v9, v8
    s_nop 0
    v_add_f32 v8, v8, v9
    v_mov_b32 v9, v8
    s_nop 1
    v_permlane32_swap_b32 v9, v8
    s_nop 0
    v_add_f32 v8, v8, v9
    ds_write_b32 v12, v8 offset:0
    s_waitcnt lgkmcnt(0)
    s_barrier
    ds_read_b32 v104, v13 offset:0
    ds_read_b32 v105, v13 offset:64
    ds_read_b32 v106, v13 offset:128
    ds_read_b32 v107, v13 offset:192
    s_waitcnt lgkmcnt(0)
    v_add_f32 v104, v104, v105
    v_add_f32 v106, v106, v107
    v_add_f32 v104, v104, v106
    v_mul_f32 v104, 0x3acccccd, v104
    v_sub_f32 v9, v64, v104
    v_mul_f32 v8, v9, v9
    v_sub_f32 v9, v65, v104
    v_fmac_f32 v8, v9, v9
    v_sub_f32 v9, v66, v104
    v_fmac_f32 v8, v9, v9
    v_sub_f32 v9, v67, v104
    v_fmac_f32 v8, v9, v9
    v_sub_f32 v9, v68, v104
    v_fmac_f32 v8, v9, v9
    v_sub_f32 v9, v69, v104
    v_fmac_f32 v8, v9, v9
    v_sub_f32 v9, v70, v104
    v_fmac_f32 v8, v9, v9
    v_sub_f32 v9, v71, v104
    v_fmac_f32 v8, v9, v9
    v_sub_f32 v9, v72, v104
    v_fmac_f32 v8, v9, v9
    v_sub_f32 v9, v73, v104
    v_fmac_f32 v8, v9, v9
    v_sub_f32 v9, v74, v104
    v_fmac_f32 v8, v9, v9
    v_sub_f32 v9, v75, v104
    v_fmac_f32 v8, v9, v9
    v_sub_f32 v9, v76, v104
    v_fmac_f32 v8, v9, v9
    v_sub_f32 v9, v77, v104
    v_fmac_f32 v8, v9, v9
    v_sub_f32 v9, v78, v104
    v_fmac_f32 v8, v9, v9
    v_sub_f32 v9, v79, v104
    v_fmac_f32 v8, v9, v9
    v_sub_f32 v9, v80, v104
    v_fmac_f32 v8, v9, v9
    v_sub_f32 v9, v81, v104
    v_fmac_f32 v8, v9, v9
    v_sub_f32 v9, v82, v104
    v_fmac_f32 v8, v9, v9
    v_sub_f32 v9, v83, v104
    v_fmac_f32 v8, v9, v9
    v_sub_f32 v9, v84, v104
    v_fmac_f32 v8, v9, v9
    v_sub_f32 v9, v85, v104
    v_fmac_f32 v8, v9, v9
    v_sub_f32 v9, v86, v104
    v_fmac_f32 v8, v9, v9
    v_sub_f32 v9, v87, v104
    v_fmac_f32 v8, v9, v9
    v_sub_f32 v9, v88, v104
    v_fmac_f32 v8, v9, v9
    v_sub_f32 v9, v89, v104
    v_fmac_f32 v8, v9, v9
    v_sub_f32 v9, v90, v104
    v_fmac_f32 v8, v9, v9
    v_sub_f32 v9, v91, v104
    v_fmac_f32 v8, v9, v9
    v_sub_f32 v9, v92, v104
    v_fmac_f32 v8, v9, v9
    v_sub_f32 v9, v93, v104
    v_fmac_f32 v8, v9, v9
    v_sub_f32 v9, v94, v104
    v_fmac_f32 v8, v9, v9
    v_sub_f32 v9, v95, v104
    v_fmac_f32 v8, v9, v9
    v_sub_f32 v9, v96, v104
    v_fmac_f32 v8, v9, v9
    v_sub_f32 v9, v97, v104
    v_fmac_f32 v8, v9, v9
    v_sub_f32 v9, v98, v104
    v_fmac_f32 v8, v9, v9
    v_sub_f32 v9, v99, v104
    v_fmac_f32 v8, v9, v9
    v_sub_f32 v9, v100, v104
    v_fmac_f32 v8, v9, v9
    v_sub_f32 v9, v101, v104
    v_fmac_f32 v8, v9, v9
    v_sub_f32 v9, v102, v104
    v_fmac_f32 v8, v9, v9
    v_sub_f32 v9, v103, v104
    v_fmac_f32 v8, v9, v9
    v_mov_b32 v9, v8
    s_nop 1
    v_permlane16_swap_b32 v9, v8
    s_nop 0
    v_add_f32 v8, v8, v9
    v_mov_b32 v9, v8
    s_nop 1
    v_permlane32_swap_b32 v9, v8
    s_nop 0
    v_add_f32 v8, v8, v9
    ds_write_b32 v12, v8 offset:256
    s_waitcnt lgkmcnt(0)
    s_barrier
    ds_read_b32 v108, v13 offset:256
    ds_read_b32 v109, v13 offset:320
    ds_read_b32 v110, v13 offset:384
    ds_read_b32 v111, v13 offset:448
    s_waitcnt lgkmcnt(0)
    v_add_f32 v108, v108, v109
    v_add_f32 v110, v110, v111
    v_add_f32 v108, v108, v110
    v_mul_f32 v108, 0x3acccccd, v108
    v_cvt_pk_bf16_f32 v108, v108, v108
    v_and_b32 v108, 0xffff0000, v108
    v_add_f32 v108, 0x3727c5ac, v108
    v_cvt_pk_bf16_f32 v108, v108, v108
    v_and_b32 v108, 0xffff0000, v108
    v_sqrt_f32 v108, v108
    s_nop 0
    v_cvt_pk_bf16_f32 v108, v108, v108
    v_and_b32 v108, 0xffff0000, v108
    v_rcp_f32 v108, v108
    v_cvt_pk_bf16_f32 v104, v104, v104
    v_and_b32 v104, 0xffff0000, v104
    v_mov_b32 v105, v104
    v_mov_b32 v109, v108
    v_pk_add_f32 v[64:65], v[64:65], v[104:105] neg_lo:[0,1] neg_hi:[0,1]
    v_cvt_pk_bf16_f32 v9, v64, v65
    v_lshlrev_b32 v64, 16, v9
    v_and_b32 v65, 0xffff0000, v9
    v_pk_mul_f32 v[64:65], v[64:65], v[108:109]
    v_cvt_pk_bf16_f32 v136, v64, v65
    v_pk_add_f32 v[66:67], v[66:67], v[104:105] neg_lo:[0,1] neg_hi:[0,1]
    v_cvt_pk_bf16_f32 v9, v66, v67
    v_lshlrev_b32 v66, 16, v9
    v_and_b32 v67, 0xffff0000, v9
    v_pk_mul_f32 v[66:67], v[66:67], v[108:109]
    v_cvt_pk_bf16_f32 v137, v66, v67
    v_pk_add_f32 v[68:69], v[68:69], v[104:105] neg_lo:[0,1] neg_hi:[0,1]
    v_cvt_pk_bf16_f32 v9, v68, v69
    v_lshlrev_b32 v68, 16, v9
    v_and_b32 v69, 0xffff0000, v9
    v_pk_mul_f32 v[68:69], v[68:69], v[108:109]
    v_cvt_pk_bf16_f32 v138, v68, v69
    v_pk_add_f32 v[70:71], v[70:71], v[104:105] neg_lo:[0,1] neg_hi:[0,1]
    v_cvt_pk_bf16_f32 v9, v70, v71
    v_lshlrev_b32 v70, 16, v9
    v_and_b32 v71, 0xffff0000, v9
    v_pk_mul_f32 v[70:71], v[70:71], v[108:109]
    v_cvt_pk_bf16_f32 v139, v70, v71
    v_pk_add_f32 v[72:73], v[72:73], v[104:105] neg_lo:[0,1] neg_hi:[0,1]
    v_cvt_pk_bf16_f32 v9, v72, v73
    v_lshlrev_b32 v72, 16, v9
    v_and_b32 v73, 0xffff0000, v9
    v_pk_mul_f32 v[72:73], v[72:73], v[108:109]
    v_cvt_pk_bf16_f32 v140, v72, v73
    v_pk_add_f32 v[74:75], v[74:75], v[104:105] neg_lo:[0,1] neg_hi:[0,1]
    v_cvt_pk_bf16_f32 v9, v74, v75
    v_lshlrev_b32 v74, 16, v9
    v_and_b32 v75, 0xffff0000, v9
    v_pk_mul_f32 v[74:75], v[74:75], v[108:109]
    v_cvt_pk_bf16_f32 v141, v74, v75
    v_pk_add_f32 v[76:77], v[76:77], v[104:105] neg_lo:[0,1] neg_hi:[0,1]
    v_cvt_pk_bf16_f32 v9, v76, v77
    v_lshlrev_b32 v76, 16, v9
    v_and_b32 v77, 0xffff0000, v9
    v_pk_mul_f32 v[76:77], v[76:77], v[108:109]
    v_cvt_pk_bf16_f32 v142, v76, v77
    v_pk_add_f32 v[78:79], v[78:79], v[104:105] neg_lo:[0,1] neg_hi:[0,1]
    v_cvt_pk_bf16_f32 v9, v78, v79
    v_lshlrev_b32 v78, 16, v9
    v_and_b32 v79, 0xffff0000, v9
    v_pk_mul_f32 v[78:79], v[78:79], v[108:109]
    v_cvt_pk_bf16_f32 v143, v78, v79
    v_pk_add_f32 v[80:81], v[80:81], v[104:105] neg_lo:[0,1] neg_hi:[0,1]
    v_cvt_pk_bf16_f32 v9, v80, v81
    v_lshlrev_b32 v80, 16, v9
    v_and_b32 v81, 0xffff0000, v9
    v_pk_mul_f32 v[80:81], v[80:81], v[108:109]
    v_cvt_pk_bf16_f32 v144, v80, v81
    v_pk_add_f32 v[82:83], v[82:83], v[104:105] neg_lo:[0,1] neg_hi:[0,1]
    v_cvt_pk_bf16_f32 v9, v82, v83
    v_lshlrev_b32 v82, 16, v9
    v_and_b32 v83, 0xffff0000, v9
    v_pk_mul_f32 v[82:83], v[82:83], v[108:109]
    v_cvt_pk_bf16_f32 v145, v82, v83
    v_pk_add_f32 v[84:85], v[84:85], v[104:105] neg_lo:[0,1] neg_hi:[0,1]
    v_cvt_pk_bf16_f32 v9, v84, v85
    v_lshlrev_b32 v84, 16, v9
    v_and_b32 v85, 0xffff0000, v9
    v_pk_mul_f32 v[84:85], v[84:85], v[108:109]
    v_cvt_pk_bf16_f32 v146, v84, v85
    v_pk_add_f32 v[86:87], v[86:87], v[104:105] neg_lo:[0,1] neg_hi:[0,1]
    v_cvt_pk_bf16_f32 v9, v86, v87
    v_lshlrev_b32 v86, 16, v9
    v_and_b32 v87, 0xffff0000, v9
    v_pk_mul_f32 v[86:87], v[86:87], v[108:109]
    v_cvt_pk_bf16_f32 v147, v86, v87
    v_pk_add_f32 v[88:89], v[88:89], v[104:105] neg_lo:[0,1] neg_hi:[0,1]
    v_cvt_pk_bf16_f32 v9, v88, v89
    v_lshlrev_b32 v88, 16, v9
    v_and_b32 v89, 0xffff0000, v9
    v_pk_mul_f32 v[88:89], v[88:89], v[108:109]
    v_cvt_pk_bf16_f32 v148, v88, v89
    v_pk_add_f32 v[90:91], v[90:91], v[104:105] neg_lo:[0,1] neg_hi:[0,1]
    v_cvt_pk_bf16_f32 v9, v90, v91
    v_lshlrev_b32 v90, 16, v9
    v_and_b32 v91, 0xffff0000, v9
    v_pk_mul_f32 v[90:91], v[90:91], v[108:109]
    v_cvt_pk_bf16_f32 v149, v90, v91
    v_pk_add_f32 v[92:93], v[92:93], v[104:105] neg_lo:[0,1] neg_hi:[0,1]
    v_cvt_pk_bf16_f32 v9, v92, v93
    v_lshlrev_b32 v92, 16, v9
    v_and_b32 v93, 0xffff0000, v9
    v_pk_mul_f32 v[92:93], v[92:93], v[108:109]
    v_cvt_pk_bf16_f32 v150, v92, v93
    v_pk_add_f32 v[94:95], v[94:95], v[104:105] neg_lo:[0,1] neg_hi:[0,1]
    v_cvt_pk_bf16_f32 v9, v94, v95
    v_lshlrev_b32 v94, 16, v9
    v_and_b32 v95, 0xffff0000, v9
    v_pk_mul_f32 v[94:95], v[94:95], v[108:109]
    v_cvt_pk_bf16_f32 v151, v94, v95
    v_pk_add_f32 v[96:97], v[96:97], v[104:105] neg_lo:[0,1] neg_hi:[0,1]
    v_cvt_pk_bf16_f32 v9, v96, v97
    v_lshlrev_b32 v96, 16, v9
    v_and_b32 v97, 0xffff0000, v9
    v_pk_mul_f32 v[96:97], v[96:97], v[108:109]
    v_cvt_pk_bf16_f32 v152, v96, v97
    v_pk_add_f32 v[98:99], v[98:99], v[104:105] neg_lo:[0,1] neg_hi:[0,1]
    v_cvt_pk_bf16_f32 v9, v98, v99
    v_lshlrev_b32 v98, 16, v9
    v_and_b32 v99, 0xffff0000, v9
    v_pk_mul_f32 v[98:99], v[98:99], v[108:109]
    v_cvt_pk_bf16_f32 v153, v98, v99
    v_pk_add_f32 v[100:101], v[100:101], v[104:105] neg_lo:[0,1] neg_hi:[0,1]
    v_cvt_pk_bf16_f32 v9, v100, v101
    v_lshlrev_b32 v100, 16, v9
    v_and_b32 v101, 0xffff0000, v9
    v_pk_mul_f32 v[100:101], v[100:101], v[108:109]
    v_cvt_pk_bf16_f32 v154, v100, v101
    v_pk_add_f32 v[102:103], v[102:103], v[104:105] neg_lo:[0,1] neg_hi:[0,1]
    v_cvt_pk_bf16_f32 v9, v102, v103
    v_lshlrev_b32 v102, 16, v9
    v_and_b32 v103, 0xffff0000, v9
    v_pk_mul_f32 v[102:103], v[102:103], v[108:109]
    v_cvt_pk_bf16_f32 v155, v102, v103
    v_add_u32 v8, 4096, v7
    buffer_store_dwordx4 v[136:139], v7, s[4:7], 0 offen offset:0 sc1
    buffer_store_dwordx4 v[140:143], v7, s[4:7], 0 offen offset:1024 sc1
    buffer_store_dwordx4 v[144:147], v7, s[4:7], 0 offen offset:2048 sc1
    buffer_store_dwordx4 v[148:151], v7, s[4:7], 0 offen offset:3072 sc1
    buffer_store_dwordx4 v[152:155], v8, s[4:7], 0 offen offset:0 sc1
    v_mov_b32 v32, v112
    v_mov_b32 v33, v113
    v_mov_b32 v34, v114
    v_mov_b32 v35, v115
    v_mov_b32 v36, v116
    v_mov_b32 v37, v117
    v_mov_b32 v38, v118
    v_mov_b32 v39, v119
    v_mov_b32 v40, v120
    v_mov_b32 v41, v121
    v_mov_b32 v42, v122
    v_mov_b32 v43, v123
    v_mov_b32 v44, v124
    v_mov_b32 v45, v125
    v_mov_b32 v46, v126
    v_mov_b32 v47, v127
    v_mov_b32 v48, v128
    v_mov_b32 v49, v129
    v_mov_b32 v50, v130
    v_mov_b32 v51, v131
    v_add_u32 v7, 20480, v7
    s_add_u32 s32, s32, 1
    s_cmp_lt_u32 s32, 2
    s_cbranch_scc1 ln_loop
    s_load_dword s26, s[52:53], 200
    s_waitcnt lgkmcnt(0)
    s_cmp_lg_u32 s26, 0
    s_cbranch_scc1 ro_10
rp_9:
    s_load_dword s26, s[52:53], 200 glc
    s_waitcnt lgkmcnt(0)
    s_cmp_lg_u32 s26, 0
    s_cbranch_scc1 ro_10
    s_sleep 16
    s_sub_u32 s38, s38, 1
    s_cbranch_scc0 rp_9
    s_branch bulk_abort
ro_10:
    s_cmp_eq_u32 s26, s99
    s_cbranch_scc1 rv_11
    s_mov_b32 s99, s26
    s_waitcnt vmcnt(0)
    s_barrier
    s_branch k_role
rv_11:
    v_mov_b32 v24, -1
    v_mov_b32 v25, -1
    v_mov_b32 v26, -1
    v_mov_b32 v27, -1
    v_lshrrev_b32 v200, 0x1, v249
    v_lshlrev_b32 v201, 0x8, v200
    v_lshlrev_b32 v202, 0x4, v0
    v_add_u32 v203, v202, v201
    v_add_u32 v204, 0x568000, v203
    v_cmp_gt_u32 vcc, 16, v0
    v_mov_b32 v205, 0x40000000
    s_nop 1
    v_cndmask_b32 v206, v205, v204, vcc
    v_mov_b32 v7, v206
    buffer_store_dwordx4 v[24:27], v7, s[4:7], 0 offen sc1
    s_waitcnt vmcnt(0)
    s_barrier
    s_cmp_lg_u32 s30, 0
    s_cbranch_scc1 b_arrived
    s_mov_b32 s26, 1
    s_atomic_add s26, s[52:53], 64 glc
    s_waitcnt lgkmcnt(0)
    s_cmp_lg_u32 s26, 85
    s_cbranch_scc1 b_arrived
    s_mov_b32 s26, 0
    s_atomic_or s26, s[52:53], 72 glc
    s_waitcnt lgkmcnt(0)
    s_or_b32 s26, s26, 0x80000000
    s_atomic_or s26, s[52:53], 192
    s_waitcnt lgkmcnt(0)
    s_branch b_arrived
b_even:
b_arrived:
    v_xor_b32 v200, 0x0, v2
    v_mov_b32 v3, v200
    s_mov_b32 s12, s88
    s_and_b32 s13, s89, 0xffff
    s_mov_b32 s14, 0x500000
    s_mov_b32 s15, 0x00020000
    s_mov_b32 s16, s90
    s_and_b32 s17, s91, 0xffff
    s_mov_b32 s18, 0x500000
    s_mov_b32 s19, 0x00020000
    s_lshl_b32 s36, s30, 10
    s_mul_i32 s37, s30, 65536
    s_add_u32 m0, s36, 0
    s_add_u32 s3, s37, 0
    buffer_load_dwordx4 v2, s[12:15], s3 offen lds
    s_add_u32 m0, s36, 4096
    s_add_u32 s3, s37, 262144
    buffer_load_dwordx4 v2, s[12:15], s3 offen lds
    s_add_u32 m0, s36, 8192
    s_add_u32 s3, s37, 524288
    buffer_load_dwordx4 v2, s[12:15], s3 offen lds
    s_add_u32 m0, s36, 12288
    s_add_u32 s3, s37, 786432
    buffer_load_dwordx4 v2, s[12:15], s3 offen lds
    s_add_u32 m0, s36, 16384
    s_add_u32 s3, s37, 1048576
    buffer_load_dwordx4 v2, s[12:15], s3 offen lds
    s_add_u32 m0, s36, 20480
    s_add_u32 s3, s37, 1310720
    buffer_load_dwordx4 v2, s[12:15], s3 offen lds
    s_add_u32 m0, s36, 24576
    s_add_u32 s3, s37, 1572864
    buffer_load_dwordx4 v2, s[12:15], s3 offen lds
    s_add_u32 m0, s36, 28672
    s_add_u32 s3, s37, 1835008
    buffer_load_dwordx4 v2, s[12:15], s3 offen lds
    s_add_u32 m0, s36, 32768
    s_add_u32 s3, s37, 2097152
    buffer_load_dwordx4 v2, s[12:15], s3 offen lds
    s_add_u32 m0, s36, 36864
    s_add_u32 s3, s37, 2359296
    buffer_load_dwordx4 v2, s[12:15], s3 offen lds
    s_add_u32 m0, s36, 40960
    s_add_u32 s3, s37, 2621440
    buffer_load_dwordx4 v2, s[12:15], s3 offen lds
    s_add_u32 m0, s36, 45056
    s_add_u32 s3, s37, 2883584
    buffer_load_dwordx4 v2, s[12:15], s3 offen lds
    s_add_u32 m0, s36, 49152
    s_add_u32 s3, s37, 3145728
    buffer_load_dwordx4 v2, s[12:15], s3 offen lds
    s_add_u32 m0, s36, 53248
    s_add_u32 s3, s37, 3407872
    buffer_load_dwordx4 v2, s[12:15], s3 offen lds
    s_add_u32 m0, s36, 57344
    s_add_u32 s3, s37, 3670016
    buffer_load_dwordx4 v2, s[12:15], s3 offen lds
    s_add_u32 m0, s36, 61440
    s_add_u32 s3, s37, 3932160
    buffer_load_dwordx4 v2, s[12:15], s3 offen lds
    s_add_u32 m0, s36, 65536
    s_add_u32 s3, s37, 4194304
    buffer_load_dwordx4 v2, s[12:15], s3 offen lds
    s_add_u32 m0, s36, 69632
    s_add_u32 s3, s37, 4456448
    buffer_load_dwordx4 v2, s[12:15], s3 offen lds
    s_add_u32 m0, s36, 73728
    s_add_u32 s3, s37, 4718592
    buffer_load_dwordx4 v2, s[12:15], s3 offen lds
    s_add_u32 m0, s36, 77824
    s_add_u32 s3, s37, 4980736
    buffer_load_dwordx4 v2, s[12:15], s3 offen lds
    s_add_u32 m0, s36, 81920
    s_add_u32 s3, s37, 0
    buffer_load_dwordx4 v3, s[16:19], s3 offen lds
    s_add_u32 m0, s36, 86016
    s_add_u32 s3, s37, 262144
    buffer_load_dwordx4 v3, s[16:19], s3 offen lds
    s_add_u32 m0, s36, 90112
    s_add_u32 s3, s37, 524288
    buffer_load_dwordx4 v3, s[16:19], s3 offen lds
    s_add_u32 m0, s36, 94208
    s_add_u32 s3, s37, 786432
    buffer_load_dwordx4 v3, s[16:19], s3 offen lds
    s_add_u32 m0, s36, 98304
    s_add_u32 s3, s37, 1048576
    buffer_load_dwordx4 v3, s[16:19], s3 offen lds
    s_add_u32 m0, s36, 102400
    s_add_u32 s3, s37, 1310720
    buffer_load_dwordx4 v3, s[16:19], s3 offen lds
    s_add_u32 m0, s36, 106496
    s_add_u32 s3, s37, 1572864
    buffer_load_dwordx4 v3, s[16:19], s3 offen lds
    s_add_u32 m0, s36, 110592
    s_add_u32 s3, s37, 1835008
    buffer_load_dwordx4 v3, s[16:19], s3 offen lds
    s_add_u32 m0, s36, 114688
    s_add_u32 s3, s37, 2097152
    buffer_load_dwordx4 v3, s[16:19], s3 offen lds
    s_add_u32 m0, s36, 118784
    s_add_u32 s3, s37, 2359296
    buffer_load_dwordx4 v3, s[16:19], s3 offen lds
    s_add_u32 m0, s36, 122880
    s_add_u32 s3, s37, 2621440
    buffer_load_dwordx4 v3, s[16:19], s3 offen lds
    s_add_u32 m0, s36, 126976
    s_add_u32 s3, s37, 2883584
    buffer_load_dwordx4 v3, s[16:19], s3 offen lds
    s_add_u32 m0, s36, 131072
    s_add_u32 s3, s37, 3145728
    buffer_load_dwordx4 v3, s[16:19], s3 offen lds
    s_add_u32 m0, s36, 135168
    s_add_u32 s3, s37, 3407872
    buffer_load_dwordx4 v3, s[16:19], s3 offen lds
    s_add_u32 m0, s36, 139264
    s_add_u32 s3, s37, 3670016
    buffer_load_dwordx4 v3, s[16:19], s3 offen lds
    s_add_u32 m0, s36, 143360
    s_add_u32 s3, s37, 3932160
    buffer_load_dwordx4 v3, s[16:19], s3 offen lds
    s_add_u32 m0, s36, 147456
    s_add_u32 s3, s37, 4194304
    buffer_load_dwordx4 v3, s[16:19], s3 offen lds
    s_add_u32 m0, s36, 151552
    s_add_u32 s3, s37, 4456448
    buffer_load_dwordx4 v3, s[16:19], s3 offen lds
    s_add_u32 m0, s36, 155648
    s_add_u32 s3, s37, 4718592
    buffer_load_dwordx4 v3, s[16:19], s3 offen lds
    s_add_u32 m0, s36, 159744
    s_add_u32 s3, s37, 4980736
    buffer_load_dwordx4 v3, s[16:19], s3 offen lds
    s_mov_b32 s12, s58
    s_and_b32 s13, s59, 0xffff
    s_mov_b32 s14, 0x500000
    s_mov_b32 s15, 0x00020000
    v_lshlrev_b32 v200, 0xd, v0
    v_lshrrev_b32 v201, 0x2, v249
    v_lshlrev_b32 v202, 0x8, v201
    v_add_u32 v203, v202, v200
    v_and_b32 v204, 0x2, v249
    v_lshlrev_b32 v205, 0x6, v204
    v_add_u32 v206, v205, v203
    v_cmp_gt_u32 vcc, 640, v0
    v_mov_b32 v207, 0x40000000
    s_nop 1
    v_cndmask_b32 v208, v207, v206, vcc
    v_mov_b32 v7, v208
    buffer_load_dword v112, v7, s[12:15], 0 offen
    v_add_u32 v200, 0x100, v0
    v_add_u32 v201, 0x100, v0
    v_lshlrev_b32 v202, 0xd, v201
    v_lshrrev_b32 v203, 0x2, v249
    v_lshlrev_b32 v204, 0x8, v203
    v_add_u32 v205, v204, v202
    v_and_b32 v206, 0x2, v249
    v_lshlrev_b32 v207, 0x6, v206
    v_add_u32 v208, v207, v205
    v_cmp_gt_u32 vcc, 640, v200
    v_mov_b32 v209, 0x40000000
    s_nop 1
    v_cndmask_b32 v210, v209, v208, vcc
    v_mov_b32 v7, v210
    buffer_load_dword v113, v7, s[12:15], 0 offen
    v_add_u32 v200, 0x200, v0
    v_add_u32 v201, 0x200, v0
    v_lshlrev_b32 v202, 0xd, v201
    v_lshrrev_b32 v203, 0x2, v249
    v_lshlrev_b32 v204, 0x8, v203
    v_add_u32 v205, v204, v202
    v_and_b32 v206, 0x2, v249
    v_lshlrev_b32 v207, 0x6, v206
    v_add_u32 v208, v207, v205
    v_cmp_gt_u32 vcc, 640, v200
    v_mov_b32 v209, 0x40000000
    s_nop 1
    v_cndmask_b32 v210, v209, v208, vcc
    v_mov_b32 v7, v210
    buffer_load_dword v114, v7, s[12:15], 0 offen
    s_load_dword s26, s[52:53], 200
    s_waitcnt lgkmcnt(0)
    s_cmp_lg_u32 s26, 0
    s_cbranch_scc1 ro_13
rp_12:
    s_load_dword s26, s[52:53], 200 glc
    s_waitcnt lgkmcnt(0)
    s_cmp_lg_u32 s26, 0
    s_cbranch_scc1 ro_13
    s_sleep 16
    s_sub_u32 s38, s38, 1
    s_cbranch_scc0 rp_12
    s_branch bulk_abort
ro_13:
    s_cmp_eq_u32 s26, s99
    s_cbranch_scc1 rv_14
    s_mov_b32 s99, s26
    s_waitcnt vmcnt(0)
    s_barrier
    s_branch k_role
rv_14:
    v_and_b32 v200, 0x1, v247
    v_lshlrev_b32 v201, 0xa, v245
    v_lshrrev_b32 v202, 0x2, v244
    v_and_b32 v203, 0x3, v202
    v_lshlrev_b32 v204, 0x7, v203
    v_add_u32 v205, v204, v201
    v_lshrrev_b32 v206, 0x3, v244
    v_and_b32 v207, 0x1, v206
    v_and_b32 v208, 0x1, v245
    v_lshlrev_b32 v209, 0x1, v208
    v_or_b32 v210, v209, v207
    v_xor_b32 v211, v210, v200
    v_lshlrev_b32 v212, 0x5, v211
    v_add_u32 v213, v212, v205
    v_and_b32 v214, 0x3, v244
    v_lshlrev_b32 v215, 0x3, v214
    v_add_u32 v216, v215, v213
    v_lshrrev_b32 v217, 0x1, v247
    v_mul_u32_u24 v218, 0x14000, v217
    v_add_u32 v219, v218, v216
    v_mov_b32 v5, v219
    v_and_b32 v200, 0x1, v247
    v_add_u32 v201, 0x2, v200
    v_lshlrev_b32 v202, 0xa, v245
    v_lshrrev_b32 v203, 0x2, v244
    v_and_b32 v204, 0x3, v203
    v_lshlrev_b32 v205, 0x7, v204
    v_add_u32 v206, v205, v202
    v_lshrrev_b32 v207, 0x3, v244
    v_and_b32 v208, 0x1, v207
    v_and_b32 v209, 0x1, v245
    v_lshlrev_b32 v210, 0x1, v209
    v_or_b32 v211, v210, v208
    v_xor_b32 v212, v211, v201
    v_lshlrev_b32 v213, 0x5, v212
    v_add_u32 v214, v213, v206
    v_and_b32 v215, 0x3, v244
    v_lshlrev_b32 v216, 0x3, v215
    v_add_u32 v217, v216, v214
    v_lshrrev_b32 v218, 0x1, v247
    v_mul_u32_u24 v219, 0x14000, v218
    v_add_u32 v220, v219, v217
    v_mov_b32 v4, v220
    s_waitcnt vmcnt(3)
    s_barrier
    v_add_u32 v9, 0x10000, v5
    ds_read_b64_tr_b16 a[0:1], v5 offset:0
    ds_read_b64_tr_b16 a[2:3], v5 offset:512
    ds_read_b64_tr_b16 a[4:5], v5 offset:4096
    ds_read_b64_tr_b16 a[6:7], v5 offset:4608
    ds_read_b64_tr_b16 a[8:9], v5 offset:8192
    ds_read_b64_tr_b16 a[10:11], v5 offset:8704
    ds_read_b64_tr_b16 a[12:13], v5 offset:12288
    ds_read_b64_tr_b16 a[14:15], v5 offset:12800
    s_waitcnt lgkmcnt(4)
    ds_read_b64_tr_b16 a[16:17], v5 offset:16384
    ds_read_b64_tr_b16 a[18:19], v5 offset:16896
    ds_read_b64_tr_b16 a[20:21], v5 offset:20480
    ds_read_b64_tr_b16 a[22:23], v5 offset:20992
    ds_read_b64_tr_b16 a[24:25], v5 offset:24576
    ds_read_b64_tr_b16 a[26:27], v5 offset:25088
    ds_read_b64_tr_b16 a[28:29], v5 offset:28672
    ds_read_b64_tr_b16 a[30:31], v5 offset:29184
    s_waitcnt lgkmcnt(4)
    ds_read_b64_tr_b16 a[32:33], v5 offset:32768
    ds_read_b64_tr_b16 a[34:35], v5 offset:33280
    ds_read_b64_tr_b16 a[36:37], v5 offset:36864
    ds_read_b64_tr_b16 a[38:39], v5 offset:37376
    ds_read_b64_tr_b16 a[40:41], v5 offset:40960
    ds_read_b64_tr_b16 a[42:43], v5 offset:41472
    ds_read_b64_tr_b16 a[44:45], v5 offset:45056
    ds_read_b64_tr_b16 a[46:47], v5 offset:45568
    s_waitcnt lgkmcnt(4)
    ds_read_b64_tr_b16 a[48:49], v5 offset:49152
    ds_read_b64_tr_b16 a[50:51], v5 offset:49664
    ds_read_b64_tr_b16 a[52:53], v5 offset:53248
    ds_read_b64_tr_b16 a[54:55], v5 offset:53760
    ds_read_b64_tr_b16 a[56:57], v5 offset:57344
    ds_read_b64_tr_b16 a[58:59], v5 offset:57856
    ds_read_b64_tr_b16 a[60:61], v5 offset:61440
    ds_read_b64_tr_b16 a[62:63], v5 offset:61952
    s_waitcnt lgkmcnt(4)
    ds_read_b64_tr_b16 a[64:65], v9 offset:0
    ds_read_b64_tr_b16 a[66:67], v9 offset:512
    ds_read_b64_tr_b16 a[68:69], v9 offset:4096
    ds_read_b64_tr_b16 a[70:71], v9 offset:4608
    ds_read_b64_tr_b16 a[72:73], v9 offset:8192
    ds_read_b64_tr_b16 a[74:75], v9 offset:8704
    ds_read_b64_tr_b16 a[76:77], v9 offset:12288
    ds_read_b64_tr_b16 a[78:79], v9 offset:12800
    s_waitcnt lgkmcnt(4)
    v_add_u32 v9, 0x10000, v4
    ds_read_b64_tr_b16 a[160:161], v4 offset:0
    ds_read_b64_tr_b16 a[162:163], v4 offset:512
    ds_read_b64_tr_b16 a[164:165], v4 offset:4096
    ds_read_b64_tr_b16 a[166:167], v4 offset:4608
    ds_read_b64_tr_b16 a[168:169], v4 offset:8192
    ds_read_b64_tr_b16 a[170:171], v4 offset:8704
    ds_read_b64_tr_b16 a[172:173], v4 offset:12288
    ds_read_b64_tr_b16 a[174:175], v4 offset:12800
    s_waitcnt lgkmcnt(4)
    ds_read_b64_tr_b16 a[176:177], v4 offset:16384
    ds_read_b64_tr_b16 a[178:179], v4 offset:16896
    ds_read_b64_tr_b16 a[180:181], v4 offset:20480
    ds_read_b64_tr_b16 a[182:183], v4 offset:20992
    ds_read_b64_tr_b16 a[184:185], v4 offset:24576
    ds_read_b64_tr_b16 a[186:187], v4 offset:25088
    ds_read_b64_tr_b16 a[188:189], v4 offset:28672
    ds_read_b64_tr_b16 a[190:191], v4 offset:29184
    s_waitcnt lgkmcnt(4)
    ds_read_b64_tr_b16 a[192:193], v4 offset:32768
    ds_read_b64_tr_b16 a[194:195], v4 offset:33280
    ds_read_b64_tr_b16 a[196:197], v4 offset:36864
    ds_read_b64_tr_b16 a[198:199], v4 offset:37376
    ds_read_b64_tr_b16 a[200:201], v4 offset:40960
    ds_read_b64_tr_b16 a[202:203], v4 offset:41472
    ds_read_b64_tr_b16 a[204:205], v4 offset:45056
    ds_read_b64_tr_b16 a[206:207], v4 offset:45568
    s_waitcnt lgkmcnt(4)
    ds_read_b64_tr_b16 a[208:209], v4 offset:49152
    ds_read_b64_tr_b16 a[210:211], v4 offset:49664
    ds_read_b64_tr_b16 a[212:213], v4 offset:53248
    ds_read_b64_tr_b16 a[214:215], v4 offset:53760
    ds_read_b64_tr_b16 a[216:217], v4 offset:57344
    ds_read_b64_tr_b16 a[218:219], v4 offset:57856
    ds_read_b64_tr_b16 a[220:221], v4 offset:61440
    ds_read_b64_tr_b16 a[222:223], v4 offset:61952
    s_waitcnt lgkmcnt(4)
    ds_read_b64_tr_b16 a[224:225], v9 offset:0
    ds_read_b64_tr_b16 a[226:227], v9 offset:512
    ds_read_b64_tr_b16 a[228:229], v9 offset:4096
    ds_read_b64_tr_b16 a[230:231], v9 offset:4608
    ds_read_b64_tr_b16 a[232:233], v9 offset:8192
    ds_read_b64_tr_b16 a[234:235], v9 offset:8704
    ds_read_b64_tr_b16 a[236:237], v9 offset:12288
    ds_read_b64_tr_b16 a[238:239], v9 offset:12800
    s_waitcnt lgkmcnt(4)
    s_waitcnt lgkmcnt(0)
    s_barrier
    s_mov_b32 s12, s58
    s_and_b32 s13, s59, 0xffff
    s_mov_b32 s14, 0x500000
    s_mov_b32 s15, 0x00020000
    s_lshl_b32 s36, s30, 10
    s_mul_i32 s37, s30, 65536
    s_add_u32 m0, s36, 81920
    s_add_u32 s3, s37, 0
    buffer_load_dwordx4 v2, s[12:15], s3 offen lds
    s_add_u32 m0, s36, 86016
    s_add_u32 s3, s37, 262144
    buffer_load_dwordx4 v2, s[12:15], s3 offen lds
    s_add_u32 m0, s36, 90112
    s_add_u32 s3, s37, 524288
    buffer_load_dwordx4 v2, s[12:15], s3 offen lds
    s_add_u32 m0, s36, 94208
    s_add_u32 s3, s37, 786432
    buffer_load_dwordx4 v2, s[12:15], s3 offen lds
    s_add_u32 m0, s36, 98304
    s_add_u32 s3, s37, 1048576
    buffer_load_dwordx4 v2, s[12:15], s3 offen lds
    s_add_u32 m0, s36, 102400
    s_add_u32 s3, s37, 1310720
    buffer_load_dwordx4 v2, s[12:15], s3 offen lds
    s_add_u32 m0, s36, 106496
    s_add_u32 s3, s37, 1572864
    buffer_load_dwordx4 v2, s[12:15], s3 offen lds
    s_add_u32 m0, s36, 110592
    s_add_u32 s3, s37, 1835008
    buffer_load_dwordx4 v2, s[12:15], s3 offen lds
    s_add_u32 m0, s36, 114688
    s_add_u32 s3, s37, 2097152
    buffer_load_dwordx4 v2, s[12:15], s3 offen lds
    s_add_u32 m0, s36, 118784
    s_add_u32 s3, s37, 2359296
    buffer_load_dwordx4 v2, s[12:15], s3 offen lds
    s_add_u32 m0, s36, 122880
    s_add_u32 s3, s37, 2621440
    buffer_load_dwordx4 v2, s[12:15], s3 offen lds
    s_add_u32 m0, s36, 126976
    s_add_u32 s3, s37, 2883584
    buffer_load_dwordx4 v2, s[12:15], s3 offen lds
    s_add_u32 m0, s36, 131072
    s_add_u32 s3, s37, 3145728
    buffer_load_dwordx4 v2, s[12:15], s3 offen lds
    s_add_u32 m0, s36, 135168
    s_add_u32 s3, s37, 3407872
    buffer_load_dwordx4 v2, s[12:15], s3 offen lds
    s_add_u32 m0, s36, 139264
    s_add_u32 s3, s37, 3670016
    buffer_load_dwordx4 v2, s[12:15], s3 offen lds
    s_add_u32 m0, s36, 143360
    s_add_u32 s3, s37, 3932160
    buffer_load_dwordx4 v2, s[12:15], s3 offen lds
    s_add_u32 m0, s36, 147456
    s_add_u32 s3, s37, 4194304
    buffer_load_dwordx4 v2, s[12:15], s3 offen lds
    s_add_u32 m0, s36, 151552
    s_add_u32 s3, s37, 4456448
    buffer_load_dwordx4 v2, s[12:15], s3 offen lds
    s_add_u32 m0, s36, 155648
    s_add_u32 s3, s37, 4718592
    buffer_load_dwordx4 v2, s[12:15], s3 offen lds
    s_add_u32 m0, s36, 159744
    s_add_u32 s3, s37, 4980736
    buffer_load_dwordx4 v2, s[12:15], s3 offen lds
    v_lshlrev_b32 v200, 0xa, v245
    v_lshrrev_b32 v201, 0x2, v244
    v_and_b32 v202, 0x3, v201
    v_lshlrev_b32 v203, 0x7, v202
    v_add_u32 v204, v203, v200
    v_lshrrev_b32 v205, 0x3, v244
    v_and_b32 v206, 0x1, v205
    v_and_b32 v207, 0x1, v245
    v_lshlrev_b32 v208, 0x1, v207
    v_or_b32 v209, v208, v206
    v_xor_b32 v210, v209, v247
    v_lshlrev_b32 v211, 0x5, v210
    v_add_u32 v212, v211, v204
    v_and_b32 v213, 0x3, v244
    v_lshlrev_b32 v214, 0x3, v213
    v_add_u32 v215, v214, v212
    v_add_u32 v216, 0x14000, v215
    v_mov_b32 v5, v216
    s_and_b32 s36, s31, 15
    s_mul_i32 s36, s36, 5
    v_mov_b32 v6, s36
    v_lshrrev_b32 v200, 0x1, v6
    v_lshlrev_b32 v201, 0xe, v200
    v_and_b32 v202, 0x1, v6
    v_lshlrev_b32 v203, 0xc, v202
    v_add_u32 v204, v203, v201
    v_lshlrev_b32 v205, 0x4, v0
    v_add_u32 v206, v205, v204
    v_mov_b32 v17, v206
    v_add_u32 v200, 0x1, v6
    v_lshrrev_b32 v201, 0x1, v200
    v_lshlrev_b32 v202, 0xe, v201
    v_and_b32 v203, 0x1, v200
    v_lshlrev_b32 v204, 0xc, v203
    v_add_u32 v205, v204, v202
    v_lshlrev_b32 v206, 0x4, v0
    v_add_u32 v207, v206, v205
    v_mov_b32 v18, v207
    v_add_u32 v200, 0x2, v6
    v_lshrrev_b32 v201, 0x1, v200
    v_lshlrev_b32 v202, 0xe, v201
    v_and_b32 v203, 0x1, v200
    v_lshlrev_b32 v204, 0xc, v203
    v_add_u32 v205, v204, v202
    v_lshlrev_b32 v206, 0x4, v0
    v_add_u32 v207, v206, v205
    v_mov_b32 v19, v207
    v_add_u32 v200, 0x3, v6
    v_lshrrev_b32 v201, 0x1, v200
    v_lshlrev_b32 v202, 0xe, v201
    v_and_b32 v203, 0x1, v200
    v_lshlrev_b32 v204, 0xc, v203
    v_add_u32 v205, v204, v202
    v_lshlrev_b32 v206, 0x4, v0
    v_add_u32 v207, v206, v205
    v_mov_b32 v20, v207
    v_add_u32 v200, 0x4, v6
    v_lshrrev_b32 v201, 0x1, v200
    v_lshlrev_b32 v202, 0xe, v201
    v_and_b32 v203, 0x1, v200
    v_lshlrev_b32 v204, 0xc, v203
    v_add_u32 v205, v204, v202
    v_lshlrev_b32 v206, 0x4, v0
    v_add_u32 v207, v206, v205
    v_mov_b32 v21, v207
    s_waitcnt vmcnt(0)
    s_barrier
    v_add_u32 v9, 0x10000, v5
    ds_read_b64_tr_b16 a[80:81], v5 offset:0
    ds_read_b64_tr_b16 a[82:83], v5 offset:512
    ds_read_b64_tr_b16 a[84:85], v5 offset:4096
    ds_read_b64_tr_b16 a[86:87], v5 offset:4608
    ds_read_b64_tr_b16 a[88:89], v5 offset:8192
    ds_read_b64_tr_b16 a[90:91], v5 offset:8704
    ds_read_b64_tr_b16 a[92:93], v5 offset:12288
    ds_read_b64_tr_b16 a[94:95], v5 offset:12800
    s_waitcnt lgkmcnt(4)
    ds_read_b64_tr_b16 a[96:97], v5 offset:16384
    ds_read_b64_tr_b16 a[98:99], v5 offset:16896
    ds_read_b64_tr_b16 a[100:101], v5 offset:20480
    ds_read_b64_tr_b16 a[102:103], v5 offset:20992
    ds_read_b64_tr_b16 a[104:105], v5 offset:24576
    ds_read_b64_tr_b16 a[106:107], v5 offset:25088
    ds_read_b64_tr_b16 a[108:109], v5 offset:28672
    ds_read_b64_tr_b16 a[110:111], v5 offset:29184
    s_waitcnt lgkmcnt(4)
    ds_read_b64_tr_b16 a[112:113], v5 offset:32768
    ds_read_b64_tr_b16 a[114:115], v5 offset:33280
    ds_read_b64_tr_b16 a[116:117], v5 offset:36864
    ds_read_b64_tr_b16 a[118:119], v5 offset:37376
    ds_read_b64_tr_b16 a[120:121], v5 offset:40960
    ds_read_b64_tr_b16 a[122:123], v5 offset:41472
    ds_read_b64_tr_b16 a[124:125], v5 offset:45056
    ds_read_b64_tr_b16 a[126:127], v5 offset:45568
    s_waitcnt lgkmcnt(4)
    ds_read_b64_tr_b16 a[128:129], v5 offset:49152
    ds_read_b64_tr_b16 a[130:131], v5 offset:49664
    ds_read_b64_tr_b16 a[132:133], v5 offset:53248
    ds_read_b64_tr_b16 a[134:135], v5 offset:53760
    ds_read_b64_tr_b16 a[136:137], v5 offset:57344
    ds_read_b64_tr_b16 a[138:139], v5 offset:57856
    ds_read_b64_tr_b16 a[140:141], v5 offset:61440
    ds_read_b64_tr_b16 a[142:143], v5 offset:61952
    s_waitcnt lgkmcnt(4)
    ds_read_b64_tr_b16 a[144:145], v9 offset:0
    ds_read_b64_tr_b16 a[146:147], v9 offset:512
    ds_read_b64_tr_b16 a[148:149], v9 offset:4096
    ds_read_b64_tr_b16 a[150:151], v9 offset:4608
    ds_read_b64_tr_b16 a[152:153], v9 offset:8192
    ds_read_b64_tr_b16 a[154:155], v9 offset:8704
    ds_read_b64_tr_b16 a[156:157], v9 offset:12288
    ds_read_b64_tr_b16 a[158:159], v9 offset:12800
    s_waitcnt lgkmcnt(4)
    s_lshr_b32 s42, s31, 4
    s_cmp_lt_u32 s30, 2
    s_cselect_b32 s24, 0x3e0293ee, 1.0
    s_mov_b32 s25, s24
    v_lshrrev_b32 v200, 0x3, v246
    v_lshlrev_b32 v201, 0xb, v200
    v_and_b32 v202, 0x2, v249
    v_and_b32 v203, 0x1, v247
    v_add_u32 v204, v203, v202
    v_lshlrev_b32 v205, 0x9, v204
    v_add_u32 v206, v205, v201
    v_lshlrev_b32 v207, 0x3, v245
    v_and_b32 v208, 0x7, v246
    v_add_u32 v209, v208, v207
    v_lshlrev_b32 v210, 0x4, v209
    v_add_u32 v211, v210, v206
    v_add_u32 v212, 0x4000, v211
    v_and_b32 v213, 0x2, v249
    v_and_b32 v214, 0x1, v247
    v_add_u32 v215, v214, v213
    v_lshlrev_b32 v216, 0xa, v215
    v_add_u32 v217, v1, v216
    v_cmp_gt_u32 vcc, 2, v247
    s_nop 1
    v_cndmask_b32 v218, v217, v212, vcc
    v_mov_b32 v10, v218
    v_and_b32 v200, 0x2, v249
    v_lshlrev_b32 v201, 0x1, v200
    v_add_u32 v202, v247, v201
    v_lshlrev_b32 v203, 0xa, v202
    v_add_u32 v204, v1, v203
    v_add_u32 v205, 0x2000, v204
    v_mov_b32 v11, v205
    v_lshlrev_b32 v200, 0x2, v249
    v_add_u32 v201, 0x569400, v200
    v_cmp_eq_u32 vcc, 0, v0
    v_mov_b32 v202, 0x40000000
    s_nop 1
    v_cndmask_b32 v203, v202, v201, vcc
    v_mov_b32 v13, v203
    s_and_b32 s3, s92, 1
    s_mul_i32 s33, s3, 40960
    s_mul_i32 s35, s30, 5120
    s_add_u32 s33, s33, 0
    s_add_u32 s33, s33, s35
    s_mul_i32 s34, s3, 786432
    s_lshr_b32 s3, s92, 2
    s_mul_i32 s3, s3, 24576
    s_add_u32 s34, s34, s3
    s_add_u32 s34, s34, 58720256
    s_mov_b32 s32, 0
ws_15:
    v_mov_b32 v6, 0
    buffer_load_dword v6, v6, s[20:23], 0 offen offset:192 sc1
    s_waitcnt vmcnt(0)
    v_readfirstlane_b32 s26, v6
    s_cmp_lt_i32 s26, 0
    s_cbranch_scc1 b_start
    s_sleep 2
    s_sub_u32 s38, s38, 1
    s_cbranch_scc0 ws_15
    s_branch bulk_abort
b_start:
    s_add_u32 m0, s35, 0
    s_add_u32 s36, s33, 4096
    buffer_load_dwordx4 v1, s[4:7], s33 offen offset:0 sc1 lds
    buffer_load_dwordx4 v1, s[4:7], s33 offen offset:1024 sc1 lds
    buffer_load_dwordx4 v1, s[4:7], s33 offen offset:2048 sc1 lds
    buffer_load_dwordx4 v1, s[4:7], s33 offen offset:3072 sc1 lds
    s_add_u32 m0, s35, 4096
    s_add_u32 s33, s33, 20480
    buffer_load_dwordx4 v1, s[4:7], s36 offen sc1 lds
    v_mul_u32_u24 v200, 0x5556, v244
    v_lshrrev_b32 v201, 0x10, v200
    v_mov_b32 v7, v201
    v_mov_b32 v15, s26
    v_lshrrev_b32 v15, v7, v15
    v_lshlrev_b32 v200, 0x15, v7
    v_mul_u32_u24 v201, 0x3, v7
    v_subrev_u32 v202, v201, v244
    v_mul_u32_u24 v203, 0xa0000, v202
    v_add_u32 v204, v203, v200
    v_and_b32 v205, 0x1, v15
    v_lshlrev_b32 v206, 0xd, v205
    v_add_u32 v207, v206, v204
    v_mov_b32 v15, v207
    s_sub_u32 s3, 0, s54
    s_and_b32 s3, s3, 0x1fffff
    s_add_u32 s3, s3, 8388608
    v_add_u32 v15, s3, v15
    s_waitcnt vmcnt(0) lgkmcnt(0)
q_loop:
    s_waitcnt vmcnt(2)
    s_barrier
    ds_read_b128 v[40:43], v1 offset:0
    ds_read_b128 v[44:47], v1 offset:1024
    ds_read_b128 v[48:51], v1 offset:2048
    ds_read_b128 v[52:55], v1 offset:3072
    ds_read_b128 v[56:59], v1 offset:4096
    ds_read_b128 v[60:63], v1 offset:5120
    s_waitcnt lgkmcnt(5)
    v_mfma_f32_16x16x32_bf16 v[72:75], a[0:3], v[40:43], 0
    s_add_u32 m0, s35, 20480
    s_add_u32 s36, s33, 4096
    v_mfma_f32_16x16x32_bf16 v[76:79], a[160:163], v[40:43], 0
    buffer_load_dwordx4 v1, s[4:7], s33 offen offset:0 sc1 lds
    v_mfma_f32_16x16x32_bf16 v[80:83], v[40:43], a[80:83], 0
    buffer_load_dwordx4 v1, s[4:7], s33 offen offset:1024 sc1 lds
    ds_read_b128 v[64:67], v1 offset:6144
    s_waitcnt lgkmcnt(5)
    v_mfma_f32_16x16x32_bf16 v[72:75], a[4:7], v[44:47], v[72:75]
    buffer_load_dwordx4 v1, s[4:7], s33 offen offset:2048 sc1 lds
    v_mfma_f32_16x16x32_bf16 v[76:79], a[164:167], v[44:47], v[76:79]
    buffer_load_dwordx4 v1, s[4:7], s33 offen offset:3072 sc1 lds
    v_mfma_f32_16x16x32_bf16 v[80:83], v[44:47], a[84:87], v[80:83]
    s_add_u32 m0, s35, 24576
    s_add_u32 s33, s33, 61440
    ds_read_b128 v[68:71], v1 offset:7168
    s_waitcnt lgkmcnt(5)
    v_mfma_f32_16x16x32_bf16 v[72:75], a[8:11], v[48:51], v[72:75]
    buffer_load_dwordx4 v1, s[4:7], s36 offen sc1 lds
    v_mfma_f32_16x16x32_bf16 v[76:79], a[168:171], v[48:51], v[76:79]
    v_mfma_f32_16x16x32_bf16 v[80:83], v[48:51], a[88:91], v[80:83]
    ds_read_b128 v[40:43], v1 offset:8192
    s_waitcnt lgkmcnt(5)
    v_mfma_f32_16x16x32_bf16 v[72:75], a[12:15], v[52:55], v[72:75]
    v_mfma_f32_16x16x32_bf16 v[76:79], a[172:175], v[52:55], v[76:79]
    v_mfma_f32_16x16x32_bf16 v[80:83], v[52:55], a[92:95], v[80:83]
    ds_read_b128 v[44:47], v1 offset:9216
    s_waitcnt lgkmcnt(5)
    v_mfma_f32_16x16x32_bf16 v[72:75], a[16:19], v[56:59], v[72:75]
    v_mfma_f32_16x16x32_bf16 v[76:79], a[176:179], v[56:59], v[76:79]
    v_mfma_f32_16x16x32_bf16 v[80:83], v[56:59], a[96:99], v[80:83]
    ds_read_b128 v[48:51], v1 offset:10240
    s_waitcnt lgkmcnt(5)
    v_mfma_f32_16x16x32_bf16 v[72:75], a[20:23], v[60:63], v[72:75]
    v_mfma_f32_16x16x32_bf16 v[76:79], a[180:183], v[60:63], v[76:79]
    v_mfma_f32_16x16x32_bf16 v[80:83], v[60:63], a[100:103], v[80:83]
    ds_read_b128 v[52:55], v1 offset:11264
    s_waitcnt lgkmcnt(5)
    v_mfma_f32_16x16x32_bf16 v[72:75], a[24:27], v[64:67], v[72:75]
    v_mfma_f32_16x16x32_bf16 v[76:79], a[184:187], v[64:67], v[76:79]
    v_mfma_f32_16x16x32_bf16 v[80:83], v[64:67], a[104:107], v[80:83]
    ds_read_b128 v[56:59], v1 offset:12288
    s_waitcnt lgkmcnt(5)
    v_mfma_f32_16x16x32_bf16 v[72:75], a[28:31], v[68:71], v[72:75]
    v_mfma_f32_16x16x32_bf16 v[76:79], a[188:191], v[68:71], v[76:79]
    v_mfma_f32_16x16x32_bf16 v[80:83], v[68:71], a[108:111], v[80:83]
    ds_read_b128 v[60:63], v1 offset:13312
    s_waitcnt lgkmcnt(5)
    v_mfma_f32_16x16x32_bf16 v[72:75], a[32:35], v[40:43], v[72:75]
    v_mfma_f32_16x16x32_bf16 v[76:79], a[192:195], v[40:43], v[76:79]
    v_mfma_f32_16x16x32_bf16 v[80:83], v[40:43], a[112:115], v[80:83]
    ds_read_b128 v[64:67], v1 offset:14336
    s_waitcnt lgkmcnt(5)
    v_mfma_f32_16x16x32_bf16 v[72:75], a[36:39], v[44:47], v[72:75]
    v_mfma_f32_16x16x32_bf16 v[76:79], a[196:199], v[44:47], v[76:79]
    v_mfma_f32_16x16x32_bf16 v[80:83], v[44:47], a[116:119], v[80:83]
    ds_read_b128 v[68:71], v1 offset:15360
    s_waitcnt lgkmcnt(5)
    v_mfma_f32_16x16x32_bf16 v[72:75], a[40:43], v[48:51], v[72:75]
    v_mfma_f32_16x16x32_bf16 v[76:79], a[200:203], v[48:51], v[76:79]
    v_mfma_f32_16x16x32_bf16 v[80:83], v[48:51], a[120:123], v[80:83]
    ds_read_b128 v[40:43], v1 offset:16384
    s_waitcnt lgkmcnt(5)
    v_mfma_f32_16x16x32_bf16 v[72:75], a[44:47], v[52:55], v[72:75]
    v_mfma_f32_16x16x32_bf16 v[76:79], a[204:207], v[52:55], v[76:79]
    v_mfma_f32_16x16x32_bf16 v[80:83], v[52:55], a[124:127], v[80:83]
    ds_read_b128 v[44:47], v1 offset:17408
    s_waitcnt lgkmcnt(5)
    v_mfma_f32_16x16x32_bf16 v[72:75], a[48:51], v[56:59], v[72:75]
    v_mfma_f32_16x16x32_bf16 v[76:79], a[208:211], v[56:59], v[76:79]
    v_mfma_f32_16x16x32_bf16 v[80:83], v[56:59], a[128:131], v[80:83]
    ds_read_b128 v[48:51], v1 offset:18432
    s_waitcnt lgkmcnt(5)
    v_mfma_f32_16x16x32_bf16 v[72:75], a[52:55], v[60:63], v[72:75]
    v_mfma_f32_16x16x32_bf16 v[76:79], a[212:215], v[60:63], v[76:79]
    v_mfma_f32_16x16x32_bf16 v[80:83], v[60:63], a[132:135], v[80:83]
    ds_read_b128 v[52:55], v1 offset:19456
    s_waitcnt lgkmcnt(5)
    v_mfma_f32_16x16x32_bf16 v[72:75], a[56:59], v[64:67], v[72:75]
    v_mfma_f32_16x16x32_bf16 v[76:79], a[216:219], v[64:67], v[76:79]
    v_mfma_f32_16x16x32_bf16 v[80:83], v[64:67], a[136:139], v[80:83]
    s_waitcnt lgkmcnt(4)
    v_mfma_f32_16x16x32_bf16 v[72:75], a[60:63], v[68:71], v[72:75]
    v_mfma_f32_16x16x32_bf16 v[76:79], a[220:223], v[68:71], v[76:79]
    v_mfma_f32_16x16x32_bf16 v[80:83], v[68:71], a[140:143], v[80:83]
    s_waitcnt lgkmcnt(3)
    v_mfma_f32_16x16x32_bf16 v[72:75], a[64:67], v[40:43], v[72:75]
    v_mfma_f32_16x16x32_bf16 v[76:79], a[224:227], v[40:43], v[76:79]
    v_mfma_f32_16x16x32_bf16 v[80:83], v[40:43], a[144:147], v[80:83]
    s_waitcnt lgkmcnt(2)
    v_mfma_f32_16x16x32_bf16 v[72:75], a[68:71], v[44:47], v[72:75]
    v_mfma_f32_16x16x32_bf16 v[76:79], a[228:231], v[44:47], v[76:79]
    v_mfma_f32_16x16x32_bf16 v[80:83], v[44:47], a[148:151], v[80:83]
    s_waitcnt lgkmcnt(1)
    v_mfma_f32_16x16x32_bf16 v[72:75], a[72:75], v[48:51], v[72:75]
    v_mfma_f32_16x16x32_bf16 v[76:79], a[232:235], v[48:51], v[76:79]
    v_mfma_f32_16x16x32_bf16 v[80:83], v[48:51], a[152:155], v[80:83]
    s_waitcnt lgkmcnt(0)
    v_mfma_f32_16x16x32_bf16 v[72:75], a[76:79], v[52:55], v[72:75]
    v_mfma_f32_16x16x32_bf16 v[76:79], a[236:239], v[52:55], v[76:79]
    v_mfma_f32_16x16x32_bf16 v[80:83], v[52:55], a[156:159], v[80:83]
    s_nop 5
    v_pk_mul_f32 v[72:73], v[72:73], s[24:25]
    v_pk_mul_f32 v[74:75], v[74:75], s[24:25]
    v_pk_mul_f32 v[76:77], v[76:77], s[24:25]
    v_pk_mul_f32 v[78:79], v[78:79], s[24:25]
    v_cvt_pk_bf16_f32 v84, v72, v73
    v_cvt_pk_bf16_f32 v85, v74, v75
    v_cvt_pk_bf16_f32 v86, v76, v77
    v_cvt_pk_bf16_f32 v87, v78, v79
    buffer_store_dwordx4 v[84:87], v10, s[4:7], s34 offen sc1
    v_cvt_pk_bf16_f32 v88, v80, v81
    v_cvt_pk_bf16_f32 v89, v82, v83
    s_waitcnt vmcnt(1)
    s_barrier
    ds_read_b128 v[40:43], v1 offset:20480
    ds_read_b128 v[44:47], v1 offset:21504
    ds_read_b128 v[48:51], v1 offset:22528
    ds_read_b128 v[52:55], v1 offset:23552
    ds_read_b128 v[56:59], v1 offset:24576
    ds_read_b128 v[60:63], v1 offset:25600
    s_waitcnt lgkmcnt(5)
    v_mfma_f32_16x16x32_bf16 v[72:75], a[0:3], v[40:43], 0
    v_mov_b32 v6, s32
    v_mfma_f32_16x16x32_bf16 v[76:79], a[160:163], v[40:43], 0
    buffer_store_dword v6, v13, s[4:7], 0 offen sc1
    v_mfma_f32_16x16x32_bf16 v[80:83], v[40:43], a[80:83], 0
    s_add_u32 m0, s35, 0
    s_add_u32 s36, s33, 4096
    ds_read_b128 v[64:67], v1 offset:26624
    s_waitcnt lgkmcnt(5)
    v_mfma_f32_16x16x32_bf16 v[72:75], a[4:7], v[44:47], v[72:75]
    buffer_load_dwordx4 v1, s[4:7], s33 offen offset:0 sc1 lds
    v_mfma_f32_16x16x32_bf16 v[76:79], a[164:167], v[44:47], v[76:79]
    buffer_load_dwordx4 v1, s[4:7], s33 offen offset:1024 sc1 lds
    v_mfma_f32_16x16x32_bf16 v[80:83], v[44:47], a[84:87], v[80:83]
    buffer_load_dwordx4 v1, s[4:7], s33 offen offset:2048 sc1 lds
    ds_read_b128 v[68:71], v1 offset:27648
    s_waitcnt lgkmcnt(5)
    v_mfma_f32_16x16x32_bf16 v[72:75], a[8:11], v[48:51], v[72:75]
    buffer_load_dwordx4 v1, s[4:7], s33 offen offset:3072 sc1 lds
    v_mfma_f32_16x16x32_bf16 v[76:79], a[168:171], v[48:51], v[76:79]
    s_add_u32 m0, s35, 4096
    s_add_u32 s33, s33, 20480
    v_mfma_f32_16x16x32_bf16 v[80:83], v[48:51], a[88:91], v[80:83]
    buffer_load_dwordx4 v1, s[4:7], s36 offen sc1 lds
    ds_read_b128 v[40:43], v1 offset:28672
    s_waitcnt lgkmcnt(5)
    v_mfma_f32_16x16x32_bf16 v[72:75], a[12:15], v[52:55], v[72:75]
    v_mfma_f32_16x16x32_bf16 v[76:79], a[172:175], v[52:55], v[76:79]
    v_mfma_f32_16x16x32_bf16 v[80:83], v[52:55], a[92:95], v[80:83]
    ds_read_b128 v[44:47], v1 offset:29696
    s_waitcnt lgkmcnt(5)
    v_mfma_f32_16x16x32_bf16 v[72:75], a[16:19], v[56:59], v[72:75]
    v_mfma_f32_16x16x32_bf16 v[76:79], a[176:179], v[56:59], v[76:79]
    v_mfma_f32_16x16x32_bf16 v[80:83], v[56:59], a[96:99], v[80:83]
    ds_read_b128 v[48:51], v1 offset:30720
    s_waitcnt lgkmcnt(5)
    v_mfma_f32_16x16x32_bf16 v[72:75], a[20:23], v[60:63], v[72:75]
    v_mfma_f32_16x16x32_bf16 v[76:79], a[180:183], v[60:63], v[76:79]
    v_mfma_f32_16x16x32_bf16 v[80:83], v[60:63], a[100:103], v[80:83]
    ds_read_b128 v[52:55], v1 offset:31744
    s_waitcnt lgkmcnt(5)
    v_mfma_f32_16x16x32_bf16 v[72:75], a[24:27], v[64:67], v[72:75]
    v_mfma_f32_16x16x32_bf16 v[76:79], a[184:187], v[64:67], v[76:79]
    v_mfma_f32_16x16x32_bf16 v[80:83], v[64:67], a[104:107], v[80:83]
    ds_read_b128 v[56:59], v1 offset:32768
    s_waitcnt lgkmcnt(5)
    v_mfma_f32_16x16x32_bf16 v[72:75], a[28:31], v[68:71], v[72:75]
    v_mfma_f32_16x16x32_bf16 v[76:79], a[188:191], v[68:71], v[76:79]
    v_mfma_f32_16x16x32_bf16 v[80:83], v[68:71], a[108:111], v[80:83]
    ds_read_b128 v[60:63], v1 offset:33792
    s_waitcnt lgkmcnt(5)
    v_mfma_f32_16x16x32_bf16 v[72:75], a[32:35], v[40:43], v[72:75]
    v_mfma_f32_16x16x32_bf16 v[76:79], a[192:195], v[40:43], v[76:79]
    v_mfma_f32_16x16x32_bf16 v[80:83], v[40:43], a[112:115], v[80:83]
    ds_read_b128 v[64:67], v1 offset:34816
    s_waitcnt lgkmcnt(5)
    v_mfma_f32_16x16x32_bf16 v[72:75], a[36:39], v[44:47], v[72:75]
    v_mfma_f32_16x16x32_bf16 v[76:79], a[196:199], v[44:47], v[76:79]
    v_mfma_f32_16x16x32_bf16 v[80:83], v[44:47], a[116:119], v[80:83]
    ds_read_b128 v[68:71], v1 offset:35840
    s_waitcnt lgkmcnt(5)
    v_mfma_f32_16x16x32_bf16 v[72:75], a[40:43], v[48:51], v[72:75]
    v_mfma_f32_16x16x32_bf16 v[76:79], a[200:203], v[48:51], v[76:79]
    v_mfma_f32_16x16x32_bf16 v[80:83], v[48:51], a[120:123], v[80:83]
    ds_read_b128 v[40:43], v1 offset:36864
    s_waitcnt lgkmcnt(5)
    v_mfma_f32_16x16x32_bf16 v[72:75], a[44:47], v[52:55], v[72:75]
    v_mfma_f32_16x16x32_bf16 v[76:79], a[204:207], v[52:55], v[76:79]
    v_mfma_f32_16x16x32_bf16 v[80:83], v[52:55], a[124:127], v[80:83]
    ds_read_b128 v[44:47], v1 offset:37888
    s_waitcnt lgkmcnt(5)
    v_mfma_f32_16x16x32_bf16 v[72:75], a[48:51], v[56:59], v[72:75]
    v_mfma_f32_16x16x32_bf16 v[76:79], a[208:211], v[56:59], v[76:79]
    v_mfma_f32_16x16x32_bf16 v[80:83], v[56:59], a[128:131], v[80:83]
    ds_read_b128 v[48:51], v1 offset:38912
    s_waitcnt lgkmcnt(5)
    v_mfma_f32_16x16x32_bf16 v[72:75], a[52:55], v[60:63], v[72:75]
    v_mfma_f32_16x16x32_bf16 v[76:79], a[212:215], v[60:63], v[76:79]
    v_mfma_f32_16x16x32_bf16 v[80:83], v[60:63], a[132:135], v[80:83]
    ds_read_b128 v[52:55], v1 offset:39936
    s_waitcnt lgkmcnt(5)
    v_mfma_f32_16x16x32_bf16 v[72:75], a[56:59], v[64:67], v[72:75]
    v_mfma_f32_16x16x32_bf16 v[76:79], a[216:219], v[64:67], v[76:79]
    v_mfma_f32_16x16x32_bf16 v[80:83], v[64:67], a[136:139], v[80:83]
    s_waitcnt lgkmcnt(4)
    v_mfma_f32_16x16x32_bf16 v[72:75], a[60:63], v[68:71], v[72:75]
    v_mfma_f32_16x16x32_bf16 v[76:79], a[220:223], v[68:71], v[76:79]
    v_mfma_f32_16x16x32_bf16 v[80:83], v[68:71], a[140:143], v[80:83]
    s_waitcnt lgkmcnt(3)
    v_mfma_f32_16x16x32_bf16 v[72:75], a[64:67], v[40:43], v[72:75]
    v_mfma_f32_16x16x32_bf16 v[76:79], a[224:227], v[40:43], v[76:79]
    v_mfma_f32_16x16x32_bf16 v[80:83], v[40:43], a[144:147], v[80:83]
    s_waitcnt lgkmcnt(2)
    v_mfma_f32_16x16x32_bf16 v[72:75], a[68:71], v[44:47], v[72:75]
    v_mfma_f32_16x16x32_bf16 v[76:79], a[228:231], v[44:47], v[76:79]
    v_mfma_f32_16x16x32_bf16 v[80:83], v[44:47], a[148:151], v[80:83]
    s_waitcnt lgkmcnt(1)
    v_mfma_f32_16x16x32_bf16 v[72:75], a[72:75], v[48:51], v[72:75]
    v_mfma_f32_16x16x32_bf16 v[76:79], a[232:235], v[48:51], v[76:79]
    v_mfma_f32_16x16x32_bf16 v[80:83], v[48:51], a[152:155], v[80:83]
    s_waitcnt lgkmcnt(0)
    v_mfma_f32_16x16x32_bf16 v[72:75], a[76:79], v[52:55], v[72:75]
    v_mfma_f32_16x16x32_bf16 v[76:79], a[236:239], v[52:55], v[76:79]
    v_mfma_f32_16x16x32_bf16 v[80:83], v[52:55], a[156:159], v[80:83]
    s_add_u32 s37, s34, 4096
    s_nop 5
    v_pk_mul_f32 v[72:73], v[72:73], s[24:25]
    v_pk_mul_f32 v[74:75], v[74:75], s[24:25]
    v_pk_mul_f32 v[76:77], v[76:77], s[24:25]
    v_pk_mul_f32 v[78:79], v[78:79], s[24:25]
    v_cvt_pk_bf16_f32 v84, v72, v73
    v_cvt_pk_bf16_f32 v85, v74, v75
    v_cvt_pk_bf16_f32 v86, v76, v77
    v_cvt_pk_bf16_f32 v87, v78, v79
    buffer_store_dwordx4 v[84:87], v10, s[4:7], s37 offen sc1
    v_cvt_pk_bf16_f32 v90, v80, v81
    v_cvt_pk_bf16_f32 v91, v82, v83
    buffer_store_dwordx4 v[88:91], v11, s[4:7], s34 offen sc1
    s_add_u32 s34, s34, 1572864
    s_add_u32 s32, s32, 1
    s_cmp_eq_u32 s32, 1
    s_cbranch_scc1 q_fill0
    s_cmp_eq_u32 s32, 6
    s_cbranch_scc1 q_fill
    s_cmp_eq_u32 s32, 16
    s_cbranch_scc1 q_fill2
q_back:
    s_cmp_lt_u32 s32, 32
    s_cbranch_scc1 q_loop
    s_branch q_done
q_fill0:
    s_waitcnt vmcnt(0)
    s_barrier
    v_mov_b32 v6, s32
    buffer_store_dword v6, v13, s[4:7], 0 offen sc1
    v_mov_b32 v24, -1
    v_mov_b32 v25, -1
    v_mov_b32 v26, -1
    v_mov_b32 v27, -1
    v_readlane_b32 s36, v15, s42
    s_cmp_lt_u32 s42, 3
    s_cselect_b32 s36, 0x40000000, s36
    s_add_u32 s42, s42, 8
    s_nop 3
    buffer_store_dwordx4 v[24:27], v17, s[4:7], s36 offen sc1
    buffer_store_dwordx4 v[24:27], v18, s[4:7], s36 offen sc1
    buffer_store_dwordx4 v[24:27], v19, s[4:7], s36 offen sc1
    buffer_store_dwordx4 v[24:27], v20, s[4:7], s36 offen sc1
    buffer_store_dwordx4 v[24:27], v21, s[4:7], s36 offen sc1
    s_waitcnt vmcnt(0)
    s_barrier
    s_lshl_b32 s36, s31, 2
    s_add_u32 s36, s36, 5671936
    buffer_store_dword v16, v16, s[4:7], s36 offen sc1
    s_branch q_back
q_fill:
    v_mov_b32 v24, -1
    v_mov_b32 v25, -1
    v_mov_b32 v26, -1
    v_mov_b32 v27, -1
    v_readlane_b32 s36, v15, s42
    s_add_u32 s42, s42, 8
    s_nop 3
    buffer_store_dwordx4 v[24:27], v17, s[4:7], s36 offen sc1
    buffer_store_dwordx4 v[24:27], v18, s[4:7], s36 offen sc1
    buffer_store_dwordx4 v[24:27], v19, s[4:7], s36 offen sc1
    buffer_store_dwordx4 v[24:27], v20, s[4:7], s36 offen sc1
    buffer_store_dwordx4 v[24:27], v21, s[4:7], s36 offen sc1
    v_readlane_b32 s36, v15, s42
    s_add_u32 s42, s42, 8
    s_nop 3
    buffer_store_dwordx4 v[24:27], v17, s[4:7], s36 offen sc1
    buffer_store_dwordx4 v[24:27], v18, s[4:7], s36 offen sc1
    buffer_store_dwordx4 v[24:27], v19, s[4:7], s36 offen sc1
    buffer_store_dwordx4 v[24:27], v20, s[4:7], s36 offen sc1
    buffer_store_dwordx4 v[24:27], v21, s[4:7], s36 offen sc1
    s_waitcnt vmcnt(0)
    s_barrier
    s_lshl_b32 s36, s31, 2
    s_add_u32 s36, s36, 5672448
    buffer_store_dword v16, v16, s[4:7], s36 offen sc1
    s_branch q_back
q_fill2:
    v_mov_b32 v24, -1
    v_mov_b32 v25, -1
    v_mov_b32 v26, -1
    v_mov_b32 v27, -1
    v_readlane_b32 s36, v15, s42
    s_add_u32 s42, s42, 8
    s_nop 3
    buffer_store_dwordx4 v[24:27], v17, s[4:7], s36 offen sc1
    buffer_store_dwordx4 v[24:27], v18, s[4:7], s36 offen sc1
    buffer_store_dwordx4 v[24:27], v19, s[4:7], s36 offen sc1
    buffer_store_dwordx4 v[24:27], v20, s[4:7], s36 offen sc1
    buffer_store_dwordx4 v[24:27], v21, s[4:7], s36 offen sc1
    v_readlane_b32 s36, v15, s42
    s_add_u32 s42, s42, 8
    s_nop 3
    buffer_store_dwordx4 v[24:27], v17, s[4:7], s36 offen sc1
    buffer_store_dwordx4 v[24:27], v18, s[4:7], s36 offen sc1
    buffer_store_dwordx4 v[24:27], v19, s[4:7], s36 offen sc1
    buffer_store_dwordx4 v[24:27], v20, s[4:7], s36 offen sc1
    buffer_store_dwordx4 v[24:27], v21, s[4:7], s36 offen sc1
    v_readlane_b32 s36, v15, s42
    s_add_u32 s42, s42, 8
    s_nop 3
    buffer_store_dwordx4 v[24:27], v17, s[4:7], s36 offen sc1
    buffer_store_dwordx4 v[24:27], v18, s[4:7], s36 offen sc1
    buffer_store_dwordx4 v[24:27], v19, s[4:7], s36 offen sc1
    buffer_store_dwordx4 v[24:27], v20, s[4:7], s36 offen sc1
    buffer_store_dwordx4 v[24:27], v21, s[4:7], s36 offen sc1
    v_readlane_b32 s36, v15, s42
    s_add_u32 s42, s42, 8
    s_nop 3
    buffer_store_dwordx4 v[24:27], v17, s[4:7], s36 offen sc1
    buffer_store_dwordx4 v[24:27], v18, s[4:7], s36 offen sc1
    buffer_store_dwordx4 v[24:27], v19, s[4:7], s36 offen sc1
    buffer_store_dwordx4 v[24:27], v20, s[4:7], s36 offen sc1
    buffer_store_dwordx4 v[24:27], v21, s[4:7], s36 offen sc1
    v_readlane_b32 s36, v15, s42
    s_add_u32 s42, s42, 8
    s_nop 3
    buffer_store_dwordx4 v[24:27], v17, s[4:7], s36 offen sc1
    buffer_store_dwordx4 v[24:27], v18, s[4:7], s36 offen sc1
    buffer_store_dwordx4 v[24:27], v19, s[4:7], s36 offen sc1
    buffer_store_dwordx4 v[24:27], v20, s[4:7], s36 offen sc1
    buffer_store_dwordx4 v[24:27], v21, s[4:7], s36 offen sc1
    s_waitcnt vmcnt(0)
    s_barrier
    s_lshl_b32 s36, s31, 2
    s_add_u32 s36, s36, 5672960
    buffer_store_dword v16, v16, s[4:7], s36 offen sc1
    s_branch q_back
q_done:
    s_waitcnt vmcnt(0)
    s_barrier
    v_mov_b32 v6, 64
    buffer_store_dword v6, v13, s[4:7], 0 offen sc1
    s_mov_b32 s8, s44
    s_and_b32 s9, s45, 0xffff
    s_mov_b32 s10, 0x21c000
    s_mov_b32 s11, 0x00020000
    s_mov_b32 s12, s46
    s_and_b32 s13, s47, 0xffff
    s_mov_b32 s14, 0x21c000
    s_mov_b32 s15, 0x00020000
    s_mov_b32 s16, s48
    s_and_b32 s17, s49, 0xffff
    s_mov_b32 s18, 0x21c000
    s_mov_b32 s19, 0x00020000
    v_lshrrev_b32 v200, 0x3, v0
    v_lshlrev_b32 v201, 0x5, v200
    v_lshrrev_b32 v202, 0x2, v248
    v_add_u32 v203, v202, v201
    v_mul_u32_u24 v204, 0xd80, v203
    v_and_b32 v205, 0x7, v0
    v_lshlrev_b32 v206, 0x2, v205
    v_and_b32 v207, 0x3, v248
    v_add_u32 v208, v207, v206
    v_lshlrev_b32 v209, 0x7, v208
    v_add_u32 v210, v209, v204
    v_cmp_gt_u32 vcc, 160, v0
    v_mov_b32 v211, 0x40000000
    s_nop 1
    v_cndmask_b32 v212, v211, v210, vcc
    v_mov_b32 v8, v212
    buffer_load_dword v64, v8, s[8:11], 0 offen
    buffer_load_dword v65, v8, s[12:15], 0 offen
    v_mul_u32_u24 v200, 0x199a, v0
    v_lshrrev_b32 v201, 0x10, v200
    v_mov_b32 v9, v201
    v_lshrrev_b32 v200, 0x1, v9
    v_lshlrev_b32 v201, 0x2, v200
    v_and_b32 v202, 0x3, v248
    v_add_u32 v203, v202, v201
    v_lshlrev_b32 v204, 0x6, v203
    v_and_b32 v205, 0x1, v9
    v_lshlrev_b32 v206, 0x5, v205
    v_add_u32 v207, v206, v204
    v_lshrrev_b32 v208, 0x2, v248
    v_add_u32 v209, v208, v207
    v_mul_u32_u24 v210, 0x500, v209
    v_mul_u32_u24 v211, 0xa, v9
    v_subrev_u32 v212, v211, v0
    v_lshlrev_b32 v213, 0x7, v212
    v_add_u32 v214, v213, v210
    v_cmp_gt_u32 vcc, 140, v0
    v_mov_b32 v215, 0x40000000
    s_nop 1
    v_cndmask_b32 v216, v215, v214, vcc
    v_mov_b32 v8, v216
    buffer_load_dword v66, v8, s[16:19], 0 offen
    s_and_b32 s39, s31, 0x7c
    s_add_u32 s39, s39, s30
    s_mul_i32 s36, s39, 20480
    buffer_load_dwordx4 a[0:3], v1, s[4:7], s36 offen offset:0 sc1
    buffer_load_dwordx4 a[4:7], v1, s[4:7], s36 offen offset:1024 sc1
    buffer_load_dwordx4 a[8:11], v1, s[4:7], s36 offen offset:2048 sc1
    buffer_load_dwordx4 a[12:15], v1, s[4:7], s36 offen offset:3072 sc1
    s_add_u32 s36, s36, 4096
    buffer_load_dwordx4 a[16:19], v1, s[4:7], s36 offen offset:0 sc1
    buffer_load_dwordx4 a[20:23], v1, s[4:7], s36 offen offset:1024 sc1
    buffer_load_dwordx4 a[24:27], v1, s[4:7], s36 offen offset:2048 sc1
    buffer_load_dwordx4 a[28:31], v1, s[4:7], s36 offen offset:3072 sc1
    s_add_u32 s36, s36, 4096
    buffer_load_dwordx4 a[32:35], v1, s[4:7], s36 offen offset:0 sc1
    buffer_load_dwordx4 a[36:39], v1, s[4:7], s36 offen offset:1024 sc1
    buffer_load_dwordx4 a[40:43], v1, s[4:7], s36 offen offset:2048 sc1
    buffer_load_dwordx4 a[44:47], v1, s[4:7], s36 offen offset:3072 sc1
    s_add_u32 s36, s36, 4096
    buffer_load_dwordx4 a[48:51], v1, s[4:7], s36 offen offset:0 sc1
    buffer_load_dwordx4 a[52:55], v1, s[4:7], s36 offen offset:1024 sc1
    buffer_load_dwordx4 a[56:59], v1, s[4:7], s36 offen offset:2048 sc1
    buffer_load_dwordx4 a[60:63], v1, s[4:7], s36 offen offset:3072 sc1
    s_add_u32 s36, s36, 4096
    buffer_load_dwordx4 a[64:67], v1, s[4:7], s36 offen offset:0 sc1
    buffer_load_dwordx4 a[68:71], v1, s[4:7], s36 offen offset:1024 sc1
    buffer_load_dwordx4 a[72:75], v1, s[4:7], s36 offen offset:2048 sc1
    buffer_load_dwordx4 a[76:79], v1, s[4:7], s36 offen offset:3072 sc1
    v_lshlrev_b32 v200, 0x3, v247
    v_lshrrev_b32 v201, 0x3, v244
    v_add_u32 v202, v201, v200
    v_mul_u32_u24 v203, 0xd80, v202
    v_lshrrev_b32 v204, 0x1, v244
    v_and_b32 v205, 0x3, v204
    v_lshrrev_b32 v206, 0x4, v244
    v_and_b32 v207, 0x1, v206
    v_and_b32 v208, 0x1, v247
    v_lshlrev_b32 v209, 0x1, v208
    v_or_b32 v210, v209, v207
    v_xor_b32 v211, v210, v205
    v_lshlrev_b32 v212, 0x1, v211
    v_and_b32 v213, 0x1, v244
    v_add_u32 v214, v213, v212
    v_lshlrev_b32 v215, 0x4, v214
    v_add_u32 v216, v215, v203
    v_mov_b32 v2, v216
    v_lshlrev_b32 v200, 0x3, v247
    v_lshrrev_b32 v201, 0x4, v244
    v_add_u32 v202, v201, v200
    v_mul_u32_u24 v203, 0x500, v202
    v_lshrrev_b32 v204, 0x1, v244
    v_and_b32 v205, 0x7, v204
    v_lshrrev_b32 v206, 0x4, v244
    v_xor_b32 v207, v206, v205
    v_lshlrev_b32 v208, 0x1, v207
    v_and_b32 v209, 0x1, v244
    v_add_u32 v210, v209, v208
    v_lshlrev_b32 v211, 0x4, v210
    v_add_u32 v212, v211, v203
    v_mov_b32 v3, v212
    v_lshlrev_b32 v200, 0x3, v247
    v_lshrrev_b32 v201, 0x4, v244
    v_add_u32 v202, v201, v200
    v_add_u32 v203, 0x4, v202
    v_mul_u32_u24 v204, 0x500, v203
    v_lshrrev_b32 v205, 0x1, v244
    v_and_b32 v206, 0x7, v205
    v_lshrrev_b32 v207, 0x4, v244
    v_add_u32 v208, 0x4, v207
    v_xor_b32 v209, v208, v206
    v_lshlrev_b32 v210, 0x1, v209
    v_and_b32 v211, 0x1, v244
    v_add_u32 v212, v211, v210
    v_lshlrev_b32 v213, 0x4, v212
    v_add_u32 v214, v213, v204
    v_mov_b32 v4, v214
    v_lshlrev_b32 v200, 0x3, v245
    v_lshrrev_b32 v201, 0x2, v244
    v_and_b32 v202, 0x3, v201
    v_add_u32 v203, v202, v200
    v_lshlrev_b32 v204, 0x7, v203
    v_lshrrev_b32 v205, 0x3, v244
    v_and_b32 v206, 0x1, v205
    v_and_b32 v207, 0x1, v245
    v_lshlrev_b32 v208, 0x1, v207
    v_or_b32 v209, v208, v206
    v_xor_b32 v210, 0x0, v209
    v_lshlrev_b32 v211, 0x5, v210
    v_add_u32 v212, v211, v204
    v_and_b32 v213, 0x3, v244
    v_lshlrev_b32 v214, 0x3, v213
    v_add_u32 v215, v214, v212
    v_mov_b32 v100, v215
    v_add_u32 v200, 0x10000, v100
    v_mov_b32 v104, v200
    v_lshlrev_b32 v200, 0x3, v245
    v_lshrrev_b32 v201, 0x2, v244
    v_and_b32 v202, 0x3, v201
    v_add_u32 v203, v202, v200
    v_lshlrev_b32 v204, 0x7, v203
    v_lshrrev_b32 v205, 0x3, v244
    v_and_b32 v206, 0x1, v205
    v_and_b32 v207, 0x1, v245
    v_lshlrev_b32 v208, 0x1, v207
    v_or_b32 v209, v208, v206
    v_xor_b32 v210, 0x1, v209
    v_lshlrev_b32 v211, 0x5, v210
    v_add_u32 v212, v211, v204
    v_and_b32 v213, 0x3, v244
    v_lshlrev_b32 v214, 0x3, v213
    v_add_u32 v215, v214, v212
    v_mov_b32 v101, v215
    v_add_u32 v200, 0x10000, v101
    v_mov_b32 v105, v200
    v_lshlrev_b32 v200, 0x3, v245
    v_lshrrev_b32 v201, 0x2, v244
    v_and_b32 v202, 0x3, v201
    v_add_u32 v203, v202, v200
    v_lshlrev_b32 v204, 0x7, v203
    v_lshrrev_b32 v205, 0x3, v244
    v_and_b32 v206, 0x1, v205
    v_and_b32 v207, 0x1, v245
    v_lshlrev_b32 v208, 0x1, v207
    v_or_b32 v209, v208, v206
    v_xor_b32 v210, 0x2, v209
    v_lshlrev_b32 v211, 0x5, v210
    v_add_u32 v212, v211, v204
    v_and_b32 v213, 0x3, v244
    v_lshlrev_b32 v214, 0x3, v213
    v_add_u32 v215, v214, v212
    v_mov_b32 v102, v215
    v_add_u32 v200, 0x10000, v102
    v_mov_b32 v106, v200
    v_lshlrev_b32 v200, 0x3, v245
    v_lshrrev_b32 v201, 0x2, v244
    v_and_b32 v202, 0x3, v201
    v_add_u32 v203, v202, v200
    v_lshlrev_b32 v204, 0x7, v203
    v_lshrrev_b32 v205, 0x3, v244
    v_and_b32 v206, 0x1, v205
    v_and_b32 v207, 0x1, v245
    v_lshlrev_b32 v208, 0x1, v207
    v_or_b32 v209, v208, v206
    v_xor_b32 v210, 0x3, v209
    v_lshlrev_b32 v211, 0x5, v210
    v_add_u32 v212, v211, v204
    v_and_b32 v213, 0x3, v244
    v_lshlrev_b32 v214, 0x3, v213
    v_add_u32 v215, v214, v212
    v_mov_b32 v103, v215
    v_add_u32 v200, 0x10000, v103
    v_mov_b32 v107, v200
    v_lshlrev_b32 v200, 0x2, v245
    v_lshrrev_b32 v201, 0x2, v244
    v_and_b32 v202, 0x3, v201
    v_add_u32 v203, v202, v200
    v_lshlrev_b32 v204, 0x8, v203
    v_and_b32 v205, 0x1, v245
    v_lshlrev_b32 v206, 0x2, v205
    v_lshrrev_b32 v207, 0x2, v244
    v_and_b32 v208, 0x3, v207
    v_add_u32 v209, v208, v206
    v_xor_b32 v210, 0x0, v209
    v_lshlrev_b32 v211, 0x5, v210
    v_add_u32 v212, v211, v204
    v_and_b32 v213, 0x3, v244
    v_lshlrev_b32 v214, 0x3, v213
    v_add_u32 v215, v214, v212
    v_mov_b32 v112, v215
    v_add_u32 v200, 0x10000, v112
    v_mov_b32 v120, v200
    v_lshlrev_b32 v200, 0x2, v245
    v_lshrrev_b32 v201, 0x2, v244
    v_and_b32 v202, 0x3, v201
    v_add_u32 v203, v202, v200
    v_lshlrev_b32 v204, 0x8, v203
    v_and_b32 v205, 0x1, v245
    v_lshlrev_b32 v206, 0x2, v205
    v_lshrrev_b32 v207, 0x2, v244
    v_and_b32 v208, 0x3, v207
    v_add_u32 v209, v208, v206
    v_xor_b32 v210, 0x1, v209
    v_lshlrev_b32 v211, 0x5, v210
    v_add_u32 v212, v211, v204
    v_and_b32 v213, 0x3, v244
    v_lshlrev_b32 v214, 0x3, v213
    v_add_u32 v215, v214, v212
    v_mov_b32 v113, v215
    v_add_u32 v200, 0x10000, v113
    v_mov_b32 v121, v200
    v_lshlrev_b32 v200, 0x2, v245
    v_lshrrev_b32 v201, 0x2, v244
    v_and_b32 v202, 0x3, v201
    v_add_u32 v203, v202, v200
    v_lshlrev_b32 v204, 0x8, v203
    v_and_b32 v205, 0x1, v245
    v_lshlrev_b32 v206, 0x2, v205
    v_lshrrev_b32 v207, 0x2, v244
    v_and_b32 v208, 0x3, v207
    v_add_u32 v209, v208, v206
    v_xor_b32 v210, 0x2, v209
    v_lshlrev_b32 v211, 0x5, v210
    v_add_u32 v212, v211, v204
    v_and_b32 v213, 0x3, v244
    v_lshlrev_b32 v214, 0x3, v213
    v_add_u32 v215, v214, v212
    v_mov_b32 v114, v215
    v_add_u32 v200, 0x10000, v114
    v_mov_b32 v122, v200
    v_lshlrev_b32 v200, 0x2, v245
    v_lshrrev_b32 v201, 0x2, v244
    v_and_b32 v202, 0x3, v201
    v_add_u32 v203, v202, v200
    v_lshlrev_b32 v204, 0x8, v203
    v_and_b32 v205, 0x1, v245
    v_lshlrev_b32 v206, 0x2, v205
    v_lshrrev_b32 v207, 0x2, v244
    v_and_b32 v208, 0x3, v207
    v_add_u32 v209, v208, v206
    v_xor_b32 v210, 0x3, v209
    v_lshlrev_b32 v211, 0x5, v210
    v_add_u32 v212, v211, v204
    v_and_b32 v213, 0x3, v244
    v_lshlrev_b32 v214, 0x3, v213
    v_add_u32 v215, v214, v212
    v_mov_b32 v115, v215
    v_add_u32 v200, 0x10000, v115
    v_mov_b32 v123, v200
    v_lshlrev_b32 v200, 0x2, v245
    v_lshrrev_b32 v201, 0x2, v244
    v_and_b32 v202, 0x3, v201
    v_add_u32 v203, v202, v200
    v_lshlrev_b32 v204, 0x8, v203
    v_and_b32 v205, 0x1, v245
    v_lshlrev_b32 v206, 0x2, v205
    v_lshrrev_b32 v207, 0x2, v244
    v_and_b32 v208, 0x3, v207
    v_add_u32 v209, v208, v206
    v_xor_b32 v210, 0x4, v209
    v_lshlrev_b32 v211, 0x5, v210
    v_add_u32 v212, v211, v204
    v_and_b32 v213, 0x3, v244
    v_lshlrev_b32 v214, 0x3, v213
    v_add_u32 v215, v214, v212
    v_mov_b32 v116, v215
    v_add_u32 v200, 0x10000, v116
    v_mov_b32 v124, v200
    v_lshlrev_b32 v200, 0x2, v245
    v_lshrrev_b32 v201, 0x2, v244
    v_and_b32 v202, 0x3, v201
    v_add_u32 v203, v202, v200
    v_lshlrev_b32 v204, 0x8, v203
    v_and_b32 v205, 0x1, v245
    v_lshlrev_b32 v206, 0x2, v205
    v_lshrrev_b32 v207, 0x2, v244
    v_and_b32 v208, 0x3, v207
    v_add_u32 v209, v208, v206
    v_xor_b32 v210, 0x5, v209
    v_lshlrev_b32 v211, 0x5, v210
    v_add_u32 v212, v211, v204
    v_and_b32 v213, 0x3, v244
    v_lshlrev_b32 v214, 0x3, v213
    v_add_u32 v215, v214, v212
    v_mov_b32 v117, v215
    v_add_u32 v200, 0x10000, v117
    v_mov_b32 v125, v200
    v_lshlrev_b32 v200, 0x2, v245
    v_lshrrev_b32 v201, 0x2, v244
    v_and_b32 v202, 0x3, v201
    v_add_u32 v203, v202, v200
    v_lshlrev_b32 v204, 0x8, v203
    v_and_b32 v205, 0x1, v245
    v_lshlrev_b32 v206, 0x2, v205
    v_lshrrev_b32 v207, 0x2, v244
    v_and_b32 v208, 0x3, v207
    v_add_u32 v209, v208, v206
    v_xor_b32 v210, 0x6, v209
    v_lshlrev_b32 v211, 0x5, v210
    v_add_u32 v212, v211, v204
    v_and_b32 v213, 0x3, v244
    v_lshlrev_b32 v214, 0x3, v213
    v_add_u32 v215, v214, v212
    v_mov_b32 v118, v215
    v_add_u32 v200, 0x10000, v118
    v_mov_b32 v126, v200
    v_lshlrev_b32 v200, 0x2, v245
    v_lshrrev_b32 v201, 0x2, v244
    v_and_b32 v202, 0x3, v201
    v_add_u32 v203, v202, v200
    v_lshlrev_b32 v204, 0x8, v203
    v_and_b32 v205, 0x1, v245
    v_lshlrev_b32 v206, 0x2, v205
    v_lshrrev_b32 v207, 0x2, v244
    v_and_b32 v208, 0x3, v207
    v_add_u32 v209, v208, v206
    v_xor_b32 v210, 0x7, v209
    v_lshlrev_b32 v211, 0x5, v210
    v_add_u32 v212, v211, v204
    v_and_b32 v213, 0x3, v244
    v_lshlrev_b32 v214, 0x3, v213
    v_add_u32 v215, v214, v212
    v_mov_b32 v119, v215
    v_add_u32 v200, 0x10000, v119
    v_mov_b32 v127, v200
    v_mov_b32 v6, 0
    v_accvgpr_write_b32 a80, v6
    v_accvgpr_write_b32 a81, v6
    v_accvgpr_write_b32 a82, v6
    v_accvgpr_write_b32 a83, v6
    v_accvgpr_write_b32 a84, v6
    v_accvgpr_write_b32 a85, v6
    v_accvgpr_write_b32 a86, v6
    v_accvgpr_write_b32 a87, v6
    v_accvgpr_write_b32 a88, v6
    v_accvgpr_write_b32 a89, v6
    v_accvgpr_write_b32 a90, v6
    v_accvgpr_write_b32 a91, v6
    v_accvgpr_write_b32 a92, v6
    v_accvgpr_write_b32 a93, v6
    v_accvgpr_write_b32 a94, v6
    v_accvgpr_write_b32 a95, v6
    v_accvgpr_write_b32 a96, v6
    v_accvgpr_write_b32 a97, v6
    v_accvgpr_write_b32 a98, v6
    v_accvgpr_write_b32 a99, v6
    v_accvgpr_write_b32 a100, v6
    v_accvgpr_write_b32 a101, v6
    v_accvgpr_write_b32 a102, v6
    v_accvgpr_write_b32 a103, v6
    v_accvgpr_write_b32 a104, v6
    v_accvgpr_write_b32 a105, v6
    v_accvgpr_write_b32 a106, v6
    v_accvgpr_write_b32 a107, v6
    v_accvgpr_write_b32 a108, v6
    v_accvgpr_write_b32 a109, v6
    v_accvgpr_write_b32 a110, v6
    v_accvgpr_write_b32 a111, v6
    v_accvgpr_write_b32 a112, v6
    v_accvgpr_write_b32 a113, v6
    v_accvgpr_write_b32 a114, v6
    v_accvgpr_write_b32 a115, v6
    v_accvgpr_write_b32 a116, v6
    v_accvgpr_write_b32 a117, v6
    v_accvgpr_write_b32 a118, v6
    v_accvgpr_write_b32 a119, v6
    v_accvgpr_write_b32 a120, v6
    v_accvgpr_write_b32 a121, v6
    v_accvgpr_write_b32 a122, v6
    v_accvgpr_write_b32 a123, v6
    v_accvgpr_write_b32 a124, v6
    v_accvgpr_write_b32 a125, v6
    v_accvgpr_write_b32 a126, v6
    v_accvgpr_write_b32 a127, v6
    v_accvgpr_write_b32 a128, v6
    v_accvgpr_write_b32 a129, v6
    v_accvgpr_write_b32 a130, v6
    v_accvgpr_write_b32 a131, v6
    v_accvgpr_write_b32 a132, v6
    v_accvgpr_write_b32 a133, v6
    v_accvgpr_write_b32 a134, v6
    v_accvgpr_write_b32 a135, v6
    v_accvgpr_write_b32 a136, v6
    v_accvgpr_write_b32 a137, v6
    v_accvgpr_write_b32 a138, v6
    v_accvgpr_write_b32 a139, v6
    v_accvgpr_write_b32 a140, v6
    v_accvgpr_write_b32 a141, v6
    v_accvgpr_write_b32 a142, v6
    v_accvgpr_write_b32 a143, v6
    v_accvgpr_write_b32 a144, v6
    v_accvgpr_write_b32 a145, v6
    v_accvgpr_write_b32 a146, v6
    v_accvgpr_write_b32 a147, v6
    v_accvgpr_write_b32 a148, v6
    v_accvgpr_write_b32 a149, v6
    v_accvgpr_write_b32 a150, v6
    v_accvgpr_write_b32 a151, v6
    v_accvgpr_write_b32 a152, v6
    v_accvgpr_write_b32 a153, v6
    v_accvgpr_write_b32 a154, v6
    v_accvgpr_write_b32 a155, v6
    v_accvgpr_write_b32 a156, v6
    v_accvgpr_write_b32 a157, v6
    v_accvgpr_write_b32 a158, v6
    v_accvgpr_write_b32 a159, v6
    v_accvgpr_write_b32 a160, v6
    v_accvgpr_write_b32 a161, v6
    v_accvgpr_write_b32 a162, v6
    v_accvgpr_write_b32 a163, v6
    v_accvgpr_write_b32 a164, v6
    v_accvgpr_write_b32 a165, v6
    v_accvgpr_write_b32 a166, v6
    v_accvgpr_write_b32 a167, v6
    v_accvgpr_write_b32 a168, v6
    v_accvgpr_write_b32 a169, v6
    v_accvgpr_write_b32 a170, v6
    v_accvgpr_write_b32 a171, v6
    v_accvgpr_write_b32 a172, v6
    v_accvgpr_write_b32 a173, v6
    v_accvgpr_write_b32 a174, v6
    v_accvgpr_write_b32 a175, v6
    v_accvgpr_write_b32 a176, v6
    v_accvgpr_write_b32 a177, v6
    v_accvgpr_write_b32 a178, v6
    v_accvgpr_write_b32 a179, v6
    v_accvgpr_write_b32 a180, v6
    v_accvgpr_write_b32 a181, v6
    v_accvgpr_write_b32 a182, v6
    v_accvgpr_write_b32 a183, v6
    v_accvgpr_write_b32 a184, v6
    v_accvgpr_write_b32 a185, v6
    v_accvgpr_write_b32 a186, v6
    v_accvgpr_write_b32 a187, v6
    v_accvgpr_write_b32 a188, v6
    v_accvgpr_write_b32 a189, v6
    v_accvgpr_write_b32 a190, v6
    v_accvgpr_write_b32 a191, v6
    v_accvgpr_write_b32 a192, v6
    v_accvgpr_write_b32 a193, v6
    v_accvgpr_write_b32 a194, v6
    v_accvgpr_write_b32 a195, v6
    v_accvgpr_write_b32 a196, v6
    v_accvgpr_write_b32 a197, v6
    v_accvgpr_write_b32 a198, v6
    v_accvgpr_write_b32 a199, v6
    v_accvgpr_write_b32 a200, v6
    v_accvgpr_write_b32 a201, v6
    v_accvgpr_write_b32 a202, v6
    v_accvgpr_write_b32 a203, v6
    v_accvgpr_write_b32 a204, v6
    v_accvgpr_write_b32 a205, v6
    v_accvgpr_write_b32 a206, v6
    v_accvgpr_write_b32 a207, v6
    v_accvgpr_write_b32 a208, v6
    v_accvgpr_write_b32 a209, v6
    v_accvgpr_write_b32 a210, v6
    v_accvgpr_write_b32 a211, v6
    v_accvgpr_write_b32 a212, v6
    v_accvgpr_write_b32 a213, v6
    v_accvgpr_write_b32 a214, v6
    v_accvgpr_write_b32 a215, v6
    v_accvgpr_write_b32 a216, v6
    v_accvgpr_write_b32 a217, v6
    v_accvgpr_write_b32 a218, v6
    v_accvgpr_write_b32 a219, v6
    v_accvgpr_write_b32 a220, v6
    v_accvgpr_write_b32 a221, v6
    v_accvgpr_write_b32 a222, v6
    v_accvgpr_write_b32 a223, v6
    v_accvgpr_write_b32 a224, v6
    v_accvgpr_write_b32 a225, v6
    v_accvgpr_write_b32 a226, v6
    v_accvgpr_write_b32 a227, v6
    v_accvgpr_write_b32 a228, v6
    v_accvgpr_write_b32 a229, v6
    v_accvgpr_write_b32 a230, v6
    v_accvgpr_write_b32 a231, v6
    v_accvgpr_write_b32 a232, v6
    v_accvgpr_write_b32 a233, v6
    v_accvgpr_write_b32 a234, v6
    v_accvgpr_write_b32 a235, v6
    v_accvgpr_write_b32 a236, v6
    v_accvgpr_write_b32 a237, v6
    v_accvgpr_write_b32 a238, v6
    v_accvgpr_write_b32 a239, v6
    s_cmp_lt_u32 s43, 3
    s_cselect_b32 s32, 7, 6
    s_lshl_b32 s33, s43, 7
    s_mul_i32 s34, s43, 81920
    s_lshl_b32 s35, s30, 10
    s_lshl_b32 s41, s30, 11
    s_waitcnt vmcnt(0)
    s_add_u32 m0, s35, 0
    s_add_u32 s36, s33, 0
    buffer_load_dwordx4 v2, s[8:11], s36 offen lds
    s_add_u32 m0, s35, 4096
    s_add_u32 s36, s33, 0
    buffer_load_dwordx4 v2, s[12:15], s36 offen lds
    s_add_u32 m0, s35, 8192
    s_add_u32 s36, s33, 110592
    buffer_load_dwordx4 v2, s[8:11], s36 offen lds
    s_add_u32 m0, s35, 12288
    s_add_u32 s36, s33, 110592
    buffer_load_dwordx4 v2, s[12:15], s36 offen lds
    s_add_u32 m0, s35, 16384
    s_add_u32 s36, s33, 221184
    buffer_load_dwordx4 v2, s[8:11], s36 offen lds
    s_add_u32 m0, s35, 20480
    s_add_u32 s36, s33, 221184
    buffer_load_dwordx4 v2, s[12:15], s36 offen lds
    s_add_u32 m0, s35, 24576
    s_add_u32 s36, s33, 331776
    buffer_load_dwordx4 v2, s[8:11], s36 offen lds
    s_add_u32 m0, s35, 28672
    s_add_u32 s36, s33, 331776
    buffer_load_dwordx4 v2, s[12:15], s36 offen lds
    s_add_u32 m0, s35, 32768
    s_add_u32 s36, s33, 442368
    buffer_load_dwordx4 v2, s[8:11], s36 offen lds
    s_add_u32 m0, s35, 36864
    s_add_u32 s36, s33, 442368
    buffer_load_dwordx4 v2, s[12:15], s36 offen lds
    s_add_u32 m0, s35, 40960
    s_add_u32 s36, s33, 552960
    buffer_load_dwordx4 v2, s[8:11], s36 offen lds
    s_add_u32 m0, s35, 45056
    s_add_u32 s36, s33, 552960
    buffer_load_dwordx4 v2, s[12:15], s36 offen lds
    s_add_u32 m0, s35, 49152
    s_add_u32 s36, s33, 663552
    buffer_load_dwordx4 v2, s[8:11], s36 offen lds
    s_add_u32 m0, s35, 53248
    s_add_u32 s36, s33, 663552
    buffer_load_dwordx4 v2, s[12:15], s36 offen lds
    s_add_u32 m0, s35, 57344
    s_add_u32 s36, s33, 774144
    buffer_load_dwordx4 v2, s[8:11], s36 offen lds
    s_add_u32 m0, s35, 61440
    s_add_u32 s36, s33, 774144
    buffer_load_dwordx4 v2, s[12:15], s36 offen lds
    s_add_u32 m0, s35, 65536
    s_add_u32 s36, s33, 884736
    buffer_load_dwordx4 v2, s[8:11], s36 offen lds
    s_add_u32 m0, s35, 69632
    s_add_u32 s36, s33, 884736
    buffer_load_dwordx4 v2, s[12:15], s36 offen lds
    s_add_u32 m0, s35, 73728
    s_add_u32 s36, s33, 995328
    buffer_load_dwordx4 v2, s[8:11], s36 offen lds
    s_add_u32 m0, s35, 77824
    s_add_u32 s36, s33, 995328
    buffer_load_dwordx4 v2, s[12:15], s36 offen lds
    s_add_u32 m0, s35, 81920
    s_add_u32 s36, s33, 1105920
    buffer_load_dwordx4 v2, s[8:11], s36 offen lds
    s_add_u32 m0, s35, 86016
    s_add_u32 s36, s33, 1105920
    buffer_load_dwordx4 v2, s[12:15], s36 offen lds
    s_add_u32 m0, s35, 90112
    s_add_u32 s36, s33, 1216512
    buffer_load_dwordx4 v2, s[8:11], s36 offen lds
    s_add_u32 m0, s35, 94208
    s_add_u32 s36, s33, 1216512
    buffer_load_dwordx4 v2, s[12:15], s36 offen lds
    s_add_u32 m0, s35, 98304
    s_add_u32 s36, s33, 1327104
    buffer_load_dwordx4 v2, s[8:11], s36 offen lds
    s_add_u32 m0, s35, 102400
    s_add_u32 s36, s33, 1327104
    buffer_load_dwordx4 v2, s[12:15], s36 offen lds
    s_add_u32 m0, s35, 106496
    s_add_u32 s36, s33, 1437696
    buffer_load_dwordx4 v2, s[8:11], s36 offen lds
    s_add_u32 m0, s35, 110592
    s_add_u32 s36, s33, 1437696
    buffer_load_dwordx4 v2, s[12:15], s36 offen lds
ffn_loop:
    s_waitcnt vmcnt(26)
    s_barrier
    ds_read_b64_tr_b16 v[64:65], v100 offset:0
    ds_read_b64_tr_b16 v[66:67], v100 offset:512
    ds_read_b64_tr_b16 v[68:69], v101 offset:0
    ds_read_b64_tr_b16 v[70:71], v101 offset:512
    ds_read_b64_tr_b16 v[72:73], v102 offset:0
    ds_read_b64_tr_b16 v[74:75], v102 offset:512
    ds_read_b64_tr_b16 v[76:77], v103 offset:0
    ds_read_b64_tr_b16 v[78:79], v103 offset:512
    ds_read_b64_tr_b16 v[80:81], v100 offset:4096
    ds_read_b64_tr_b16 v[82:83], v100 offset:4608
    ds_read_b64_tr_b16 v[84:85], v101 offset:4096
    ds_read_b64_tr_b16 v[86:87], v101 offset:4608
    ds_read_b64_tr_b16 v[88:89], v102 offset:4096
    ds_read_b64_tr_b16 v[90:91], v102 offset:4608
    ds_read_b64_tr_b16 v[92:93], v103 offset:4096
    ds_read_b64_tr_b16 v[94:95], v103 offset:4608
    s_waitcnt lgkmcnt(14)
    v_mfma_f32_16x16x32_bf16 v[32:35], v[64:67], a[0:3], 0
    s_add_u32 m0, s35, 114688
    s_add_u32 s36, s33, 1548288
    s_waitcnt lgkmcnt(12)
    v_mfma_f32_16x16x32_bf16 v[36:39], v[68:71], a[0:3], 0
    buffer_load_dwordx4 v2, s[8:11], s36 offen lds
    s_waitcnt lgkmcnt(10)
    v_mfma_f32_16x16x32_bf16 v[40:43], v[72:75], a[0:3], 0
    s_add_u32 m0, s35, 118784
    s_add_u32 s36, s33, 1548288
    s_waitcnt lgkmcnt(8)
    v_mfma_f32_16x16x32_bf16 v[44:47], v[76:79], a[0:3], 0
    buffer_load_dwordx4 v2, s[12:15], s36 offen lds
    s_waitcnt lgkmcnt(6)
    v_mfma_f32_16x16x32_bf16 v[48:51], v[80:83], a[0:3], 0
    s_waitcnt lgkmcnt(4)
    v_mfma_f32_16x16x32_bf16 v[52:55], v[84:87], a[0:3], 0
    s_waitcnt lgkmcnt(2)
    v_mfma_f32_16x16x32_bf16 v[56:59], v[88:91], a[0:3], 0
    s_waitcnt lgkmcnt(0)
    v_mfma_f32_16x16x32_bf16 v[60:63], v[92:95], a[0:3], 0
    s_waitcnt vmcnt(26)
    s_barrier
    ds_read_b64_tr_b16 v[64:65], v100 offset:8192
    ds_read_b64_tr_b16 v[66:67], v100 offset:8704
    ds_read_b64_tr_b16 v[68:69], v101 offset:8192
    ds_read_b64_tr_b16 v[70:71], v101 offset:8704
    ds_read_b64_tr_b16 v[72:73], v102 offset:8192
    ds_read_b64_tr_b16 v[74:75], v102 offset:8704
    ds_read_b64_tr_b16 v[76:77], v103 offset:8192
    ds_read_b64_tr_b16 v[78:79], v103 offset:8704
    ds_read_b64_tr_b16 v[80:81], v100 offset:12288
    ds_read_b64_tr_b16 v[82:83], v100 offset:12800
    ds_read_b64_tr_b16 v[84:85], v101 offset:12288
    ds_read_b64_tr_b16 v[86:87], v101 offset:12800
    ds_read_b64_tr_b16 v[88:89], v102 offset:12288
    ds_read_b64_tr_b16 v[90:91], v102 offset:12800
    ds_read_b64_tr_b16 v[92:93], v103 offset:12288
    ds_read_b64_tr_b16 v[94:95], v103 offset:12800
    s_waitcnt lgkmcnt(14)
    v_mfma_f32_16x16x32_bf16 v[32:35], v[64:67], a[4:7], v[32:35]
    s_add_u32 m0, s35, 0
    s_add_u32 s36, s33, 1658880
    s_waitcnt lgkmcnt(12)
    v_mfma_f32_16x16x32_bf16 v[36:39], v[68:71], a[4:7], v[36:39]
    buffer_load_dwordx4 v2, s[8:11], s36 offen lds
    s_waitcnt lgkmcnt(10)
    v_mfma_f32_16x16x32_bf16 v[40:43], v[72:75], a[4:7], v[40:43]
    s_add_u32 m0, s35, 4096
    s_add_u32 s36, s33, 1658880
    s_waitcnt lgkmcnt(8)
    v_mfma_f32_16x16x32_bf16 v[44:47], v[76:79], a[4:7], v[44:47]
    buffer_load_dwordx4 v2, s[12:15], s36 offen lds
    s_waitcnt lgkmcnt(6)
    v_mfma_f32_16x16x32_bf16 v[48:51], v[80:83], a[4:7], v[48:51]
    s_waitcnt lgkmcnt(4)
    v_mfma_f32_16x16x32_bf16 v[52:55], v[84:87], a[4:7], v[52:55]
    s_waitcnt lgkmcnt(2)
    v_mfma_f32_16x16x32_bf16 v[56:59], v[88:91], a[4:7], v[56:59]
    s_waitcnt lgkmcnt(0)
    v_mfma_f32_16x16x32_bf16 v[60:63], v[92:95], a[4:7], v[60:63]
    s_waitcnt vmcnt(26)
    s_barrier
    ds_read_b64_tr_b16 v[64:65], v100 offset:16384
    ds_read_b64_tr_b16 v[66:67], v100 offset:16896
    ds_read_b64_tr_b16 v[68:69], v101 offset:16384
    ds_read_b64_tr_b16 v[70:71], v101 offset:16896
    ds_read_b64_tr_b16 v[72:73], v102 offset:16384
    ds_read_b64_tr_b16 v[74:75], v102 offset:16896
    ds_read_b64_tr_b16 v[76:77], v103 offset:16384
    ds_read_b64_tr_b16 v[78:79], v103 offset:16896
    ds_read_b64_tr_b16 v[80:81], v100 offset:20480
    ds_read_b64_tr_b16 v[82:83], v100 offset:20992
    ds_read_b64_tr_b16 v[84:85], v101 offset:20480
    ds_read_b64_tr_b16 v[86:87], v101 offset:20992
    ds_read_b64_tr_b16 v[88:89], v102 offset:20480
    ds_read_b64_tr_b16 v[90:91], v102 offset:20992
    ds_read_b64_tr_b16 v[92:93], v103 offset:20480
    ds_read_b64_tr_b16 v[94:95], v103 offset:20992
    s_waitcnt lgkmcnt(14)
    v_mfma_f32_16x16x32_bf16 v[32:35], v[64:67], a[8:11], v[32:35]
    s_add_u32 m0, s35, 8192
    s_add_u32 s36, s33, 1769472
    s_waitcnt lgkmcnt(12)
    v_mfma_f32_16x16x32_bf16 v[36:39], v[68:71], a[8:11], v[36:39]
    buffer_load_dwordx4 v2, s[8:11], s36 offen lds
    s_waitcnt lgkmcnt(10)
    v_mfma_f32_16x16x32_bf16 v[40:43], v[72:75], a[8:11], v[40:43]
    s_add_u32 m0, s35, 12288
    s_add_u32 s36, s33, 1769472
    s_waitcnt lgkmcnt(8)
    v_mfma_f32_16x16x32_bf16 v[44:47], v[76:79], a[8:11], v[44:47]
    buffer_load_dwordx4 v2, s[12:15], s36 offen lds
    s_waitcnt lgkmcnt(6)
    v_mfma_f32_16x16x32_bf16 v[48:51], v[80:83], a[8:11], v[48:51]
    s_waitcnt lgkmcnt(4)
    v_mfma_f32_16x16x32_bf16 v[52:55], v[84:87], a[8:11], v[52:55]
    s_waitcnt lgkmcnt(2)
    v_mfma_f32_16x16x32_bf16 v[56:59], v[88:91], a[8:11], v[56:59]
    s_waitcnt lgkmcnt(0)
    v_mfma_f32_16x16x32_bf16 v[60:63], v[92:95], a[8:11], v[60:63]
    s_waitcnt vmcnt(26)
    s_barrier
    ds_read_b64_tr_b16 v[64:65], v100 offset:24576
    ds_read_b64_tr_b16 v[66:67], v100 offset:25088
    ds_read_b64_tr_b16 v[68:69], v101 offset:24576
    ds_read_b64_tr_b16 v[70:71], v101 offset:25088
    ds_read_b64_tr_b16 v[72:73], v102 offset:24576
    ds_read_b64_tr_b16 v[74:75], v102 offset:25088
    ds_read_b64_tr_b16 v[76:77], v103 offset:24576
    ds_read_b64_tr_b16 v[78:79], v103 offset:25088
    ds_read_b64_tr_b16 v[80:81], v100 offset:28672
    ds_read_b64_tr_b16 v[82:83], v100 offset:29184
    ds_read_b64_tr_b16 v[84:85], v101 offset:28672
    ds_read_b64_tr_b16 v[86:87], v101 offset:29184
    ds_read_b64_tr_b16 v[88:89], v102 offset:28672
    ds_read_b64_tr_b16 v[90:91], v102 offset:29184
    ds_read_b64_tr_b16 v[92:93], v103 offset:28672
    ds_read_b64_tr_b16 v[94:95], v103 offset:29184
    s_waitcnt lgkmcnt(14)
    v_mfma_f32_16x16x32_bf16 v[32:35], v[64:67], a[12:15], v[32:35]
    s_add_u32 m0, s35, 16384
    s_add_u32 s36, s33, 1880064
    s_waitcnt lgkmcnt(12)
    v_mfma_f32_16x16x32_bf16 v[36:39], v[68:71], a[12:15], v[36:39]
    buffer_load_dwordx4 v2, s[8:11], s36 offen lds
    s_waitcnt lgkmcnt(10)
    v_mfma_f32_16x16x32_bf16 v[40:43], v[72:75], a[12:15], v[40:43]
    s_add_u32 m0, s35, 20480
    s_add_u32 s36, s33, 1880064
    s_waitcnt lgkmcnt(8)
    v_mfma_f32_16x16x32_bf16 v[44:47], v[76:79], a[12:15], v[44:47]
    buffer_load_dwordx4 v2, s[12:15], s36 offen lds
    s_waitcnt lgkmcnt(6)
    v_mfma_f32_16x16x32_bf16 v[48:51], v[80:83], a[12:15], v[48:51]
    s_waitcnt lgkmcnt(4)
    v_mfma_f32_16x16x32_bf16 v[52:55], v[84:87], a[12:15], v[52:55]
    s_waitcnt lgkmcnt(2)
    v_mfma_f32_16x16x32_bf16 v[56:59], v[88:91], a[12:15], v[56:59]
    s_waitcnt lgkmcnt(0)
    v_mfma_f32_16x16x32_bf16 v[60:63], v[92:95], a[12:15], v[60:63]
    s_waitcnt vmcnt(26)
    s_barrier
    ds_read_b64_tr_b16 v[64:65], v100 offset:32768
    ds_read_b64_tr_b16 v[66:67], v100 offset:33280
    ds_read_b64_tr_b16 v[68:69], v101 offset:32768
    ds_read_b64_tr_b16 v[70:71], v101 offset:33280
    ds_read_b64_tr_b16 v[72:73], v102 offset:32768
    ds_read_b64_tr_b16 v[74:75], v102 offset:33280
    ds_read_b64_tr_b16 v[76:77], v103 offset:32768
    ds_read_b64_tr_b16 v[78:79], v103 offset:33280
    ds_read_b64_tr_b16 v[80:81], v100 offset:36864
    ds_read_b64_tr_b16 v[82:83], v100 offset:37376
    ds_read_b64_tr_b16 v[84:85], v101 offset:36864
    ds_read_b64_tr_b16 v[86:87], v101 offset:37376
    ds_read_b64_tr_b16 v[88:89], v102 offset:36864
    ds_read_b64_tr_b16 v[90:91], v102 offset:37376
    ds_read_b64_tr_b16 v[92:93], v103 offset:36864
    ds_read_b64_tr_b16 v[94:95], v103 offset:37376
    s_waitcnt lgkmcnt(14)
    v_mfma_f32_16x16x32_bf16 v[32:35], v[64:67], a[16:19], v[32:35]
    s_add_u32 m0, s35, 24576
    s_add_u32 s36, s33, 1990656
    s_waitcnt lgkmcnt(12)
    v_mfma_f32_16x16x32_bf16 v[36:39], v[68:71], a[16:19], v[36:39]
    buffer_load_dwordx4 v2, s[8:11], s36 offen lds
    s_waitcnt lgkmcnt(10)
    v_mfma_f32_16x16x32_bf16 v[40:43], v[72:75], a[16:19], v[40:43]
    s_add_u32 m0, s35, 28672
    s_add_u32 s36, s33, 1990656
    s_waitcnt lgkmcnt(8)
    v_mfma_f32_16x16x32_bf16 v[44:47], v[76:79], a[16:19], v[44:47]
    buffer_load_dwordx4 v2, s[12:15], s36 offen lds
    s_waitcnt lgkmcnt(6)
    v_mfma_f32_16x16x32_bf16 v[48:51], v[80:83], a[16:19], v[48:51]
    s_waitcnt lgkmcnt(4)
    v_mfma_f32_16x16x32_bf16 v[52:55], v[84:87], a[16:19], v[52:55]
    s_waitcnt lgkmcnt(2)
    v_mfma_f32_16x16x32_bf16 v[56:59], v[88:91], a[16:19], v[56:59]
    s_waitcnt lgkmcnt(0)
    v_mfma_f32_16x16x32_bf16 v[60:63], v[92:95], a[16:19], v[60:63]
    s_waitcnt vmcnt(26)
    s_barrier
    ds_read_b64_tr_b16 v[64:65], v100 offset:40960
    ds_read_b64_tr_b16 v[66:67], v100 offset:41472
    ds_read_b64_tr_b16 v[68:69], v101 offset:40960
    ds_read_b64_tr_b16 v[70:71], v101 offset:41472
    ds_read_b64_tr_b16 v[72:73], v102 offset:40960
    ds_read_b64_tr_b16 v[74:75], v102 offset:41472
    ds_read_b64_tr_b16 v[76:77], v103 offset:40960
    ds_read_b64_tr_b16 v[78:79], v103 offset:41472
    ds_read_b64_tr_b16 v[80:81], v100 offset:45056
    ds_read_b64_tr_b16 v[82:83], v100 offset:45568
    ds_read_b64_tr_b16 v[84:85], v101 offset:45056
    ds_read_b64_tr_b16 v[86:87], v101 offset:45568
    ds_read_b64_tr_b16 v[88:89], v102 offset:45056
    ds_read_b64_tr_b16 v[90:91], v102 offset:45568
    ds_read_b64_tr_b16 v[92:93], v103 offset:45056
    ds_read_b64_tr_b16 v[94:95], v103 offset:45568
    s_waitcnt lgkmcnt(14)
    v_mfma_f32_16x16x32_bf16 v[32:35], v[64:67], a[20:23], v[32:35]
    s_add_u32 m0, s35, 32768
    s_add_u32 s36, s33, 2101248
    s_waitcnt lgkmcnt(12)
    v_mfma_f32_16x16x32_bf16 v[36:39], v[68:71], a[20:23], v[36:39]
    buffer_load_dwordx4 v2, s[8:11], s36 offen lds
    s_waitcnt lgkmcnt(10)
    v_mfma_f32_16x16x32_bf16 v[40:43], v[72:75], a[20:23], v[40:43]
    s_add_u32 m0, s35, 36864
    s_add_u32 s36, s33, 2101248
    s_waitcnt lgkmcnt(8)
    v_mfma_f32_16x16x32_bf16 v[44:47], v[76:79], a[20:23], v[44:47]
    buffer_load_dwordx4 v2, s[12:15], s36 offen lds
    s_waitcnt lgkmcnt(6)
    v_mfma_f32_16x16x32_bf16 v[48:51], v[80:83], a[20:23], v[48:51]
    s_waitcnt lgkmcnt(4)
    v_mfma_f32_16x16x32_bf16 v[52:55], v[84:87], a[20:23], v[52:55]
    s_waitcnt lgkmcnt(2)
    v_mfma_f32_16x16x32_bf16 v[56:59], v[88:91], a[20:23], v[56:59]
    s_waitcnt lgkmcnt(0)
    v_mfma_f32_16x16x32_bf16 v[60:63], v[92:95], a[20:23], v[60:63]
    s_waitcnt vmcnt(26)
    s_barrier
    ds_read_b64_tr_b16 v[64:65], v100 offset:49152
    ds_read_b64_tr_b16 v[66:67], v100 offset:49664
    ds_read_b64_tr_b16 v[68:69], v101 offset:49152
    ds_read_b64_tr_b16 v[70:71], v101 offset:49664
    ds_read_b64_tr_b16 v[72:73], v102 offset:49152
    ds_read_b64_tr_b16 v[74:75], v102 offset:49664
    ds_read_b64_tr_b16 v[76:77], v103 offset:49152
    ds_read_b64_tr_b16 v[78:79], v103 offset:49664
    ds_read_b64_tr_b16 v[80:81], v100 offset:53248
    ds_read_b64_tr_b16 v[82:83], v100 offset:53760
    ds_read_b64_tr_b16 v[84:85], v101 offset:53248
    ds_read_b64_tr_b16 v[86:87], v101 offset:53760
    ds_read_b64_tr_b16 v[88:89], v102 offset:53248
    ds_read_b64_tr_b16 v[90:91], v102 offset:53760
    ds_read_b64_tr_b16 v[92:93], v103 offset:53248
    ds_read_b64_tr_b16 v[94:95], v103 offset:53760
    s_waitcnt lgkmcnt(14)
    v_mfma_f32_16x16x32_bf16 v[32:35], v[64:67], a[24:27], v[32:35]
    s_add_u32 m0, s41, 40960
    s_add_u32 s36, s34, 0
    s_waitcnt lgkmcnt(12)
    v_mfma_f32_16x16x32_bf16 v[36:39], v[68:71], a[24:27], v[36:39]
    buffer_load_dwordx4 v3, s[16:19], s36 offen lds
    s_waitcnt lgkmcnt(10)
    v_mfma_f32_16x16x32_bf16 v[40:43], v[72:75], a[24:27], v[40:43]
    s_add_u32 m0, s41, 41984
    s_add_u32 s36, s34, 0
    s_waitcnt lgkmcnt(8)
    v_mfma_f32_16x16x32_bf16 v[44:47], v[76:79], a[24:27], v[44:47]
    buffer_load_dwordx4 v4, s[16:19], s36 offen lds
    s_waitcnt lgkmcnt(6)
    v_mfma_f32_16x16x32_bf16 v[48:51], v[80:83], a[24:27], v[48:51]
    s_waitcnt lgkmcnt(4)
    v_mfma_f32_16x16x32_bf16 v[52:55], v[84:87], a[24:27], v[52:55]
    s_waitcnt lgkmcnt(2)
    v_mfma_f32_16x16x32_bf16 v[56:59], v[88:91], a[24:27], v[56:59]
    s_waitcnt lgkmcnt(0)
    v_mfma_f32_16x16x32_bf16 v[60:63], v[92:95], a[24:27], v[60:63]
    s_waitcnt vmcnt(26)
    s_barrier
    ds_read_b64_tr_b16 v[64:65], v100 offset:57344
    ds_read_b64_tr_b16 v[66:67], v100 offset:57856
    ds_read_b64_tr_b16 v[68:69], v101 offset:57344
    ds_read_b64_tr_b16 v[70:71], v101 offset:57856
    ds_read_b64_tr_b16 v[72:73], v102 offset:57344
    ds_read_b64_tr_b16 v[74:75], v102 offset:57856
    ds_read_b64_tr_b16 v[76:77], v103 offset:57344
    ds_read_b64_tr_b16 v[78:79], v103 offset:57856
    ds_read_b64_tr_b16 v[80:81], v100 offset:61440
    ds_read_b64_tr_b16 v[82:83], v100 offset:61952
    ds_read_b64_tr_b16 v[84:85], v101 offset:61440
    ds_read_b64_tr_b16 v[86:87], v101 offset:61952
    ds_read_b64_tr_b16 v[88:89], v102 offset:61440
    ds_read_b64_tr_b16 v[90:91], v102 offset:61952
    ds_read_b64_tr_b16 v[92:93], v103 offset:61440
    ds_read_b64_tr_b16 v[94:95], v103 offset:61952
    s_waitcnt lgkmcnt(14)
    v_mfma_f32_16x16x32_bf16 v[32:35], v[64:67], a[28:31], v[32:35]
    s_add_u32 m0, s41, 49152
    s_add_u32 s36, s34, 256
    s_waitcnt lgkmcnt(12)
    v_mfma_f32_16x16x32_bf16 v[36:39], v[68:71], a[28:31], v[36:39]
    buffer_load_dwordx4 v3, s[16:19], s36 offen lds
    s_waitcnt lgkmcnt(10)
    v_mfma_f32_16x16x32_bf16 v[40:43], v[72:75], a[28:31], v[40:43]
    s_add_u32 m0, s41, 50176
    s_add_u32 s36, s34, 256
    s_waitcnt lgkmcnt(8)
    v_mfma_f32_16x16x32_bf16 v[44:47], v[76:79], a[28:31], v[44:47]
    buffer_load_dwordx4 v4, s[16:19], s36 offen lds
    s_waitcnt lgkmcnt(6)
    v_mfma_f32_16x16x32_bf16 v[48:51], v[80:83], a[28:31], v[48:51]
    s_waitcnt lgkmcnt(4)
    v_mfma_f32_16x16x32_bf16 v[52:55], v[84:87], a[28:31], v[52:55]
    s_waitcnt lgkmcnt(2)
    v_mfma_f32_16x16x32_bf16 v[56:59], v[88:91], a[28:31], v[56:59]
    s_waitcnt lgkmcnt(0)
    v_mfma_f32_16x16x32_bf16 v[60:63], v[92:95], a[28:31], v[60:63]
    s_waitcnt vmcnt(26)
    s_barrier
    ds_read_b64_tr_b16 v[64:65], v104 offset:0
    ds_read_b64_tr_b16 v[66:67], v104 offset:512
    ds_read_b64_tr_b16 v[68:69], v105 offset:0
    ds_read_b64_tr_b16 v[70:71], v105 offset:512
    ds_read_b64_tr_b16 v[72:73], v106 offset:0
    ds_read_b64_tr_b16 v[74:75], v106 offset:512
    ds_read_b64_tr_b16 v[76:77], v107 offset:0
    ds_read_b64_tr_b16 v[78:79], v107 offset:512
    ds_read_b64_tr_b16 v[80:81], v104 offset:4096
    ds_read_b64_tr_b16 v[82:83], v104 offset:4608
    ds_read_b64_tr_b16 v[84:85], v105 offset:4096
    ds_read_b64_tr_b16 v[86:87], v105 offset:4608
    ds_read_b64_tr_b16 v[88:89], v106 offset:4096
    ds_read_b64_tr_b16 v[90:91], v106 offset:4608
    ds_read_b64_tr_b16 v[92:93], v107 offset:4096
    ds_read_b64_tr_b16 v[94:95], v107 offset:4608
    s_waitcnt lgkmcnt(14)
    v_mfma_f32_16x16x32_bf16 v[32:35], v[64:67], a[32:35], v[32:35]
    s_add_u32 m0, s41, 57344
    s_add_u32 s36, s34, 512
    s_waitcnt lgkmcnt(12)
    v_mfma_f32_16x16x32_bf16 v[36:39], v[68:71], a[32:35], v[36:39]
    buffer_load_dwordx4 v3, s[16:19], s36 offen lds
    s_waitcnt lgkmcnt(10)
    v_mfma_f32_16x16x32_bf16 v[40:43], v[72:75], a[32:35], v[40:43]
    s_add_u32 m0, s41, 58368
    s_add_u32 s36, s34, 512
    s_waitcnt lgkmcnt(8)
    v_mfma_f32_16x16x32_bf16 v[44:47], v[76:79], a[32:35], v[44:47]
    buffer_load_dwordx4 v4, s[16:19], s36 offen lds
    s_waitcnt lgkmcnt(6)
    v_mfma_f32_16x16x32_bf16 v[48:51], v[80:83], a[32:35], v[48:51]
    s_waitcnt lgkmcnt(4)
    v_mfma_f32_16x16x32_bf16 v[52:55], v[84:87], a[32:35], v[52:55]
    s_waitcnt lgkmcnt(2)
    v_mfma_f32_16x16x32_bf16 v[56:59], v[88:91], a[32:35], v[56:59]
    s_waitcnt lgkmcnt(0)
    v_mfma_f32_16x16x32_bf16 v[60:63], v[92:95], a[32:35], v[60:63]
    s_waitcnt vmcnt(26)
    s_barrier
    ds_read_b64_tr_b16 v[64:65], v104 offset:8192
    ds_read_b64_tr_b16 v[66:67], v104 offset:8704
    ds_read_b64_tr_b16 v[68:69], v105 offset:8192
    ds_read_b64_tr_b16 v[70:71], v105 offset:8704
    ds_read_b64_tr_b16 v[72:73], v106 offset:8192
    ds_read_b64_tr_b16 v[74:75], v106 offset:8704
    ds_read_b64_tr_b16 v[76:77], v107 offset:8192
    ds_read_b64_tr_b16 v[78:79], v107 offset:8704
    ds_read_b64_tr_b16 v[80:81], v104 offset:12288
    ds_read_b64_tr_b16 v[82:83], v104 offset:12800
    ds_read_b64_tr_b16 v[84:85], v105 offset:12288
    ds_read_b64_tr_b16 v[86:87], v105 offset:12800
    ds_read_b64_tr_b16 v[88:89], v106 offset:12288
    ds_read_b64_tr_b16 v[90:91], v106 offset:12800
    ds_read_b64_tr_b16 v[92:93], v107 offset:12288
    ds_read_b64_tr_b16 v[94:95], v107 offset:12800
    s_waitcnt lgkmcnt(14)
    v_mfma_f32_16x16x32_bf16 v[32:35], v[64:67], a[36:39], v[32:35]
    s_add_u32 m0, s41, 65536
    s_add_u32 s36, s34, 768
    s_waitcnt lgkmcnt(12)
    v_mfma_f32_16x16x32_bf16 v[36:39], v[68:71], a[36:39], v[36:39]
    buffer_load_dwordx4 v3, s[16:19], s36 offen lds
    s_waitcnt lgkmcnt(10)
    v_mfma_f32_16x16x32_bf16 v[40:43], v[72:75], a[36:39], v[40:43]
    s_add_u32 m0, s41, 66560
    s_add_u32 s36, s34, 768
    s_waitcnt lgkmcnt(8)
    v_mfma_f32_16x16x32_bf16 v[44:47], v[76:79], a[36:39], v[44:47]
    buffer_load_dwordx4 v4, s[16:19], s36 offen lds
    s_waitcnt lgkmcnt(6)
    v_mfma_f32_16x16x32_bf16 v[48:51], v[80:83], a[36:39], v[48:51]
    s_waitcnt lgkmcnt(4)
    v_mfma_f32_16x16x32_bf16 v[52:55], v[84:87], a[36:39], v[52:55]
    s_waitcnt lgkmcnt(2)
    v_mfma_f32_16x16x32_bf16 v[56:59], v[88:91], a[36:39], v[56:59]
    s_waitcnt lgkmcnt(0)
    v_mfma_f32_16x16x32_bf16 v[60:63], v[92:95], a[36:39], v[60:63]
    s_waitcnt vmcnt(26)
    s_barrier
    ds_read_b64_tr_b16 v[64:65], v104 offset:16384
    ds_read_b64_tr_b16 v[66:67], v104 offset:16896
    ds_read_b64_tr_b16 v[68:69], v105 offset:16384
    ds_read_b64_tr_b16 v[70:71], v105 offset:16896
    ds_read_b64_tr_b16 v[72:73], v106 offset:16384
    ds_read_b64_tr_b16 v[74:75], v106 offset:16896
    ds_read_b64_tr_b16 v[76:77], v107 offset:16384
    ds_read_b64_tr_b16 v[78:79], v107 offset:16896
    ds_read_b64_tr_b16 v[80:81], v104 offset:20480
    ds_read_b64_tr_b16 v[82:83], v104 offset:20992
    ds_read_b64_tr_b16 v[84:85], v105 offset:20480
    ds_read_b64_tr_b16 v[86:87], v105 offset:20992
    ds_read_b64_tr_b16 v[88:89], v106 offset:20480
    ds_read_b64_tr_b16 v[90:91], v106 offset:20992
    ds_read_b64_tr_b16 v[92:93], v107 offset:20480
    ds_read_b64_tr_b16 v[94:95], v107 offset:20992
    s_waitcnt lgkmcnt(14)
    v_mfma_f32_16x16x32_bf16 v[32:35], v[64:67], a[40:43], v[32:35]
    s_add_u32 m0, s41, 73728
    s_add_u32 s36, s34, 1024
    s_waitcnt lgkmcnt(12)
    v_mfma_f32_16x16x32_bf16 v[36:39], v[68:71], a[40:43], v[36:39]
    buffer_load_dwordx4 v3, s[16:19], s36 offen lds
    s_waitcnt lgkmcnt(10)
    v_mfma_f32_16x16x32_bf16 v[40:43], v[72:75], a[40:43], v[40:43]
    s_add_u32 m0, s41, 74752
    s_add_u32 s36, s34, 1024
    s_waitcnt lgkmcnt(8)
    v_mfma_f32_16x16x32_bf16 v[44:47], v[76:79], a[40:43], v[44:47]
    buffer_load_dwordx4 v4, s[16:19], s36 offen lds
    s_waitcnt lgkmcnt(6)
    v_mfma_f32_16x16x32_bf16 v[48:51], v[80:83], a[40:43], v[48:51]
    s_waitcnt lgkmcnt(4)
    v_mfma_f32_16x16x32_bf16 v[52:55], v[84:87], a[40:43], v[52:55]
    s_waitcnt lgkmcnt(2)
    v_mfma_f32_16x16x32_bf16 v[56:59], v[88:91], a[40:43], v[56:59]
    s_waitcnt lgkmcnt(0)
    v_mfma_f32_16x16x32_bf16 v[60:63], v[92:95], a[40:43], v[60:63]
    s_waitcnt vmcnt(26)
    s_barrier
    ds_read_b64_tr_b16 v[64:65], v104 offset:24576
    ds_read_b64_tr_b16 v[66:67], v104 offset:25088
    ds_read_b64_tr_b16 v[68:69], v105 offset:24576
    ds_read_b64_tr_b16 v[70:71], v105 offset:25088
    ds_read_b64_tr_b16 v[72:73], v106 offset:24576
    ds_read_b64_tr_b16 v[74:75], v106 offset:25088
    ds_read_b64_tr_b16 v[76:77], v107 offset:24576
    ds_read_b64_tr_b16 v[78:79], v107 offset:25088
    ds_read_b64_tr_b16 v[80:81], v104 offset:28672
    ds_read_b64_tr_b16 v[82:83], v104 offset:29184
    ds_read_b64_tr_b16 v[84:85], v105 offset:28672
    ds_read_b64_tr_b16 v[86:87], v105 offset:29184
    ds_read_b64_tr_b16 v[88:89], v106 offset:28672
    ds_read_b64_tr_b16 v[90:91], v106 offset:29184
    ds_read_b64_tr_b16 v[92:93], v107 offset:28672
    ds_read_b64_tr_b16 v[94:95], v107 offset:29184
    s_waitcnt lgkmcnt(14)
    v_mfma_f32_16x16x32_bf16 v[32:35], v[64:67], a[44:47], v[32:35]
    s_add_u32 m0, s41, 81920
    s_add_u32 s36, s34, 40960
    s_waitcnt lgkmcnt(12)
    v_mfma_f32_16x16x32_bf16 v[36:39], v[68:71], a[44:47], v[36:39]
    buffer_load_dwordx4 v3, s[16:19], s36 offen lds
    s_waitcnt lgkmcnt(10)
    v_mfma_f32_16x16x32_bf16 v[40:43], v[72:75], a[44:47], v[40:43]
    s_add_u32 m0, s41, 82944
    s_add_u32 s36, s34, 40960
    s_waitcnt lgkmcnt(8)
    v_mfma_f32_16x16x32_bf16 v[44:47], v[76:79], a[44:47], v[44:47]
    buffer_load_dwordx4 v4, s[16:19], s36 offen lds
    s_waitcnt lgkmcnt(6)
    v_mfma_f32_16x16x32_bf16 v[48:51], v[80:83], a[44:47], v[48:51]
    s_waitcnt lgkmcnt(4)
    v_mfma_f32_16x16x32_bf16 v[52:55], v[84:87], a[44:47], v[52:55]
    s_waitcnt lgkmcnt(2)
    v_mfma_f32_16x16x32_bf16 v[56:59], v[88:91], a[44:47], v[56:59]
    s_waitcnt lgkmcnt(0)
    v_mfma_f32_16x16x32_bf16 v[60:63], v[92:95], a[44:47], v[60:63]
    s_waitcnt vmcnt(26)
    s_barrier
    ds_read_b64_tr_b16 v[64:65], v104 offset:32768
    ds_read_b64_tr_b16 v[66:67], v104 offset:33280
    ds_read_b64_tr_b16 v[68:69], v105 offset:32768
    ds_read_b64_tr_b16 v[70:71], v105 offset:33280
    ds_read_b64_tr_b16 v[72:73], v106 offset:32768
    ds_read_b64_tr_b16 v[74:75], v106 offset:33280
    ds_read_b64_tr_b16 v[76:77], v107 offset:32768
    ds_read_b64_tr_b16 v[78:79], v107 offset:33280
    ds_read_b64_tr_b16 v[80:81], v104 offset:36864
    ds_read_b64_tr_b16 v[82:83], v104 offset:37376
    ds_read_b64_tr_b16 v[84:85], v105 offset:36864
    ds_read_b64_tr_b16 v[86:87], v105 offset:37376
    ds_read_b64_tr_b16 v[88:89], v106 offset:36864
    ds_read_b64_tr_b16 v[90:91], v106 offset:37376
    ds_read_b64_tr_b16 v[92:93], v107 offset:36864
    ds_read_b64_tr_b16 v[94:95], v107 offset:37376
    s_waitcnt lgkmcnt(14)
    v_mfma_f32_16x16x32_bf16 v[32:35], v[64:67], a[48:51], v[32:35]
    s_add_u32 m0, s41, 90112
    s_add_u32 s36, s34, 41216
    s_waitcnt lgkmcnt(12)
    v_mfma_f32_16x16x32_bf16 v[36:39], v[68:71], a[48:51], v[36:39]
    buffer_load_dwordx4 v3, s[16:19], s36 offen lds
    s_waitcnt lgkmcnt(10)
    v_mfma_f32_16x16x32_bf16 v[40:43], v[72:75], a[48:51], v[40:43]
    s_add_u32 m0, s41, 91136
    s_add_u32 s36, s34, 41216
    s_waitcnt lgkmcnt(8)
    v_mfma_f32_16x16x32_bf16 v[44:47], v[76:79], a[48:51], v[44:47]
    buffer_load_dwordx4 v4, s[16:19], s36 offen lds
    s_waitcnt lgkmcnt(6)
    v_mfma_f32_16x16x32_bf16 v[48:51], v[80:83], a[48:51], v[48:51]
    s_waitcnt lgkmcnt(4)
    v_mfma_f32_16x16x32_bf16 v[52:55], v[84:87], a[48:51], v[52:55]
    s_waitcnt lgkmcnt(2)
    v_mfma_f32_16x16x32_bf16 v[56:59], v[88:91], a[48:51], v[56:59]
    s_waitcnt lgkmcnt(0)
    v_mfma_f32_16x16x32_bf16 v[60:63], v[92:95], a[48:51], v[60:63]
    s_waitcnt vmcnt(26)
    s_barrier
    ds_read_b64_tr_b16 v[64:65], v104 offset:40960
    ds_read_b64_tr_b16 v[66:67], v104 offset:41472
    ds_read_b64_tr_b16 v[68:69], v105 offset:40960
    ds_read_b64_tr_b16 v[70:71], v105 offset:41472
    ds_read_b64_tr_b16 v[72:73], v106 offset:40960
    ds_read_b64_tr_b16 v[74:75], v106 offset:41472
    ds_read_b64_tr_b16 v[76:77], v107 offset:40960
    ds_read_b64_tr_b16 v[78:79], v107 offset:41472
    ds_read_b64_tr_b16 v[80:81], v104 offset:45056
    ds_read_b64_tr_b16 v[82:83], v104 offset:45568
    ds_read_b64_tr_b16 v[84:85], v105 offset:45056
    ds_read_b64_tr_b16 v[86:87], v105 offset:45568
    ds_read_b64_tr_b16 v[88:89], v106 offset:45056
    ds_read_b64_tr_b16 v[90:91], v106 offset:45568
    ds_read_b64_tr_b16 v[92:93], v107 offset:45056
    ds_read_b64_tr_b16 v[94:95], v107 offset:45568
    s_waitcnt lgkmcnt(14)
    v_mfma_f32_16x16x32_bf16 v[32:35], v[64:67], a[52:55], v[32:35]
    s_add_u32 m0, s41, 98304
    s_add_u32 s36, s34, 41472
    s_waitcnt lgkmcnt(12)
    v_mfma_f32_16x16x32_bf16 v[36:39], v[68:71], a[52:55], v[36:39]
    buffer_load_dwordx4 v3, s[16:19], s36 offen lds
    s_waitcnt lgkmcnt(10)
    v_mfma_f32_16x16x32_bf16 v[40:43], v[72:75], a[52:55], v[40:43]
    s_add_u32 m0, s41, 99328
    s_add_u32 s36, s34, 41472
    s_waitcnt lgkmcnt(8)
    v_mfma_f32_16x16x32_bf16 v[44:47], v[76:79], a[52:55], v[44:47]
    buffer_load_dwordx4 v4, s[16:19], s36 offen lds
    s_waitcnt lgkmcnt(6)
    v_mfma_f32_16x16x32_bf16 v[48:51], v[80:83], a[52:55], v[48:51]
    s_waitcnt lgkmcnt(4)
    v_mfma_f32_16x16x32_bf16 v[52:55], v[84:87], a[52:55], v[52:55]
    s_waitcnt lgkmcnt(2)
    v_mfma_f32_16x16x32_bf16 v[56:59], v[88:91], a[52:55], v[56:59]
    s_waitcnt lgkmcnt(0)
    v_mfma_f32_16x16x32_bf16 v[60:63], v[92:95], a[52:55], v[60:63]
    s_waitcnt vmcnt(26)
    s_barrier
    ds_read_b64_tr_b16 v[64:65], v104 offset:49152
    ds_read_b64_tr_b16 v[66:67], v104 offset:49664
    ds_read_b64_tr_b16 v[68:69], v105 offset:49152
    ds_read_b64_tr_b16 v[70:71], v105 offset:49664
    ds_read_b64_tr_b16 v[72:73], v106 offset:49152
    ds_read_b64_tr_b16 v[74:75], v106 offset:49664
    ds_read_b64_tr_b16 v[76:77], v107 offset:49152
    ds_read_b64_tr_b16 v[78:79], v107 offset:49664
    ds_read_b64_tr_b16 v[80:81], v104 offset:53248
    ds_read_b64_tr_b16 v[82:83], v104 offset:53760
    ds_read_b64_tr_b16 v[84:85], v105 offset:53248
    ds_read_b64_tr_b16 v[86:87], v105 offset:53760
    ds_read_b64_tr_b16 v[88:89], v106 offset:53248
    ds_read_b64_tr_b16 v[90:91], v106 offset:53760
    ds_read_b64_tr_b16 v[92:93], v107 offset:53248
    ds_read_b64_tr_b16 v[94:95], v107 offset:53760
    s_waitcnt lgkmcnt(14)
    v_mfma_f32_16x16x32_bf16 v[32:35], v[64:67], a[56:59], v[32:35]
    s_add_u32 m0, s41, 106496
    s_add_u32 s36, s34, 41728
    s_waitcnt lgkmcnt(12)
    v_mfma_f32_16x16x32_bf16 v[36:39], v[68:71], a[56:59], v[36:39]
    buffer_load_dwordx4 v3, s[16:19], s36 offen lds
    s_waitcnt lgkmcnt(10)
    v_mfma_f32_16x16x32_bf16 v[40:43], v[72:75], a[56:59], v[40:43]
    s_add_u32 m0, s41, 107520
    s_add_u32 s36, s34, 41728
    s_waitcnt lgkmcnt(8)
    v_mfma_f32_16x16x32_bf16 v[44:47], v[76:79], a[56:59], v[44:47]
    buffer_load_dwordx4 v4, s[16:19], s36 offen lds
    s_waitcnt lgkmcnt(6)
    v_mfma_f32_16x16x32_bf16 v[48:51], v[80:83], a[56:59], v[48:51]
    s_waitcnt lgkmcnt(4)
    v_mfma_f32_16x16x32_bf16 v[52:55], v[84:87], a[56:59], v[52:55]
    s_waitcnt lgkmcnt(2)
    v_mfma_f32_16x16x32_bf16 v[56:59], v[88:91], a[56:59], v[56:59]
    s_waitcnt lgkmcnt(0)
    v_mfma_f32_16x16x32_bf16 v[60:63], v[92:95], a[56:59], v[60:63]
    s_waitcnt vmcnt(26)
    s_barrier
    ds_read_b64_tr_b16 v[64:65], v100 offset:0
    ds_read_b64_tr_b16 v[66:67], v100 offset:512
    ds_read_b64_tr_b16 v[68:69], v101 offset:0
    ds_read_b64_tr_b16 v[70:71], v101 offset:512
    ds_read_b64_tr_b16 v[72:73], v102 offset:0
    ds_read_b64_tr_b16 v[74:75], v102 offset:512
    ds_read_b64_tr_b16 v[76:77], v103 offset:0
    ds_read_b64_tr_b16 v[78:79], v103 offset:512
    ds_read_b64_tr_b16 v[80:81], v100 offset:4096
    ds_read_b64_tr_b16 v[82:83], v100 offset:4608
    ds_read_b64_tr_b16 v[84:85], v101 offset:4096
    ds_read_b64_tr_b16 v[86:87], v101 offset:4608
    ds_read_b64_tr_b16 v[88:89], v102 offset:4096
    ds_read_b64_tr_b16 v[90:91], v102 offset:4608
    ds_read_b64_tr_b16 v[92:93], v103 offset:4096
    ds_read_b64_tr_b16 v[94:95], v103 offset:4608
    s_waitcnt lgkmcnt(14)
    v_mfma_f32_16x16x32_bf16 v[32:35], v[64:67], a[60:63], v[32:35]
    s_add_u32 m0, s41, 114688
    s_add_u32 s36, s34, 41984
    s_waitcnt lgkmcnt(12)
    v_mfma_f32_16x16x32_bf16 v[36:39], v[68:71], a[60:63], v[36:39]
    buffer_load_dwordx4 v3, s[16:19], s36 offen lds
    s_waitcnt lgkmcnt(10)
    v_mfma_f32_16x16x32_bf16 v[40:43], v[72:75], a[60:63], v[40:43]
    s_add_u32 m0, s41, 115712
    s_add_u32 s36, s34, 41984
    s_waitcnt lgkmcnt(8)
    v_mfma_f32_16x16x32_bf16 v[44:47], v[76:79], a[60:63], v[44:47]
    buffer_load_dwordx4 v4, s[16:19], s36 offen lds
    s_waitcnt lgkmcnt(6)
    v_mfma_f32_16x16x32_bf16 v[48:51], v[80:83], a[60:63], v[48:51]
    s_waitcnt lgkmcnt(4)
    v_mfma_f32_16x16x32_bf16 v[52:55], v[84:87], a[60:63], v[52:55]
    s_waitcnt lgkmcnt(2)
    v_mfma_f32_16x16x32_bf16 v[56:59], v[88:91], a[60:63], v[56:59]
    s_waitcnt lgkmcnt(0)
    v_mfma_f32_16x16x32_bf16 v[60:63], v[92:95], a[60:63], v[60:63]
    s_waitcnt vmcnt(26)
    s_barrier
    ds_read_b64_tr_b16 v[64:65], v100 offset:8192
    ds_read_b64_tr_b16 v[66:67], v100 offset:8704
    ds_read_b64_tr_b16 v[68:69], v101 offset:8192
    ds_read_b64_tr_b16 v[70:71], v101 offset:8704
    ds_read_b64_tr_b16 v[72:73], v102 offset:8192
    ds_read_b64_tr_b16 v[74:75], v102 offset:8704
    ds_read_b64_tr_b16 v[76:77], v103 offset:8192
    ds_read_b64_tr_b16 v[78:79], v103 offset:8704
    ds_read_b64_tr_b16 v[80:81], v100 offset:12288
    ds_read_b64_tr_b16 v[82:83], v100 offset:12800
    ds_read_b64_tr_b16 v[84:85], v101 offset:12288
    ds_read_b64_tr_b16 v[86:87], v101 offset:12800
    ds_read_b64_tr_b16 v[88:89], v102 offset:12288
    ds_read_b64_tr_b16 v[90:91], v102 offset:12800
    ds_read_b64_tr_b16 v[92:93], v103 offset:12288
    ds_read_b64_tr_b16 v[94:95], v103 offset:12800
    s_waitcnt lgkmcnt(14)
    v_mfma_f32_16x16x32_bf16 v[32:35], v[64:67], a[64:67], v[32:35]
    s_add_u32 m0, s35, 0
    s_add_u32 s36, s33, 512
    s_waitcnt lgkmcnt(12)
    v_mfma_f32_16x16x32_bf16 v[36:39], v[68:71], a[64:67], v[36:39]
    buffer_load_dwordx4 v2, s[8:11], s36 offen lds
    s_waitcnt lgkmcnt(10)
    v_mfma_f32_16x16x32_bf16 v[40:43], v[72:75], a[64:67], v[40:43]
    s_add_u32 m0, s35, 4096
    s_add_u32 s36, s33, 512
    s_waitcnt lgkmcnt(8)
    v_mfma_f32_16x16x32_bf16 v[44:47], v[76:79], a[64:67], v[44:47]
    buffer_load_dwordx4 v2, s[12:15], s36 offen lds
    s_waitcnt lgkmcnt(6)
    v_mfma_f32_16x16x32_bf16 v[48:51], v[80:83], a[64:67], v[48:51]
    s_waitcnt lgkmcnt(4)
    v_mfma_f32_16x16x32_bf16 v[52:55], v[84:87], a[64:67], v[52:55]
    s_waitcnt lgkmcnt(2)
    v_mfma_f32_16x16x32_bf16 v[56:59], v[88:91], a[64:67], v[56:59]
    s_waitcnt lgkmcnt(0)
    v_mfma_f32_16x16x32_bf16 v[60:63], v[92:95], a[64:67], v[60:63]
    s_waitcnt vmcnt(26)
    s_barrier
    ds_read_b64_tr_b16 v[64:65], v100 offset:16384
    ds_read_b64_tr_b16 v[66:67], v100 offset:16896
    ds_read_b64_tr_b16 v[68:69], v101 offset:16384
    ds_read_b64_tr_b16 v[70:71], v101 offset:16896
    ds_read_b64_tr_b16 v[72:73], v102 offset:16384
    ds_read_b64_tr_b16 v[74:75], v102 offset:16896
    ds_read_b64_tr_b16 v[76:77], v103 offset:16384
    ds_read_b64_tr_b16 v[78:79], v103 offset:16896
    ds_read_b64_tr_b16 v[80:81], v100 offset:20480
    ds_read_b64_tr_b16 v[82:83], v100 offset:20992
    ds_read_b64_tr_b16 v[84:85], v101 offset:20480
    ds_read_b64_tr_b16 v[86:87], v101 offset:20992
    ds_read_b64_tr_b16 v[88:89], v102 offset:20480
    ds_read_b64_tr_b16 v[90:91], v102 offset:20992
    ds_read_b64_tr_b16 v[92:93], v103 offset:20480
    ds_read_b64_tr_b16 v[94:95], v103 offset:20992
    s_waitcnt lgkmcnt(14)
    v_mfma_f32_16x16x32_bf16 v[32:35], v[64:67], a[68:71], v[32:35]
    s_add_u32 m0, s35, 8192
    s_add_u32 s36, s33, 111104
    s_waitcnt lgkmcnt(12)
    v_mfma_f32_16x16x32_bf16 v[36:39], v[68:71], a[68:71], v[36:39]
    buffer_load_dwordx4 v2, s[8:11], s36 offen lds
    s_waitcnt lgkmcnt(10)
    v_mfma_f32_16x16x32_bf16 v[40:43], v[72:75], a[68:71], v[40:43]
    s_add_u32 m0, s35, 12288
    s_add_u32 s36, s33, 111104
    s_waitcnt lgkmcnt(8)
    v_mfma_f32_16x16x32_bf16 v[44:47], v[76:79], a[68:71], v[44:47]
    buffer_load_dwordx4 v2, s[12:15], s36 offen lds
    s_waitcnt lgkmcnt(6)
    v_mfma_f32_16x16x32_bf16 v[48:51], v[80:83], a[68:71], v[48:51]
    s_waitcnt lgkmcnt(4)
    v_mfma_f32_16x16x32_bf16 v[52:55], v[84:87], a[68:71], v[52:55]
    s_waitcnt lgkmcnt(2)
    v_mfma_f32_16x16x32_bf16 v[56:59], v[88:91], a[68:71], v[56:59]
    s_waitcnt lgkmcnt(0)
    v_mfma_f32_16x16x32_bf16 v[60:63], v[92:95], a[68:71], v[60:63]
    s_waitcnt vmcnt(26)
    s_barrier
    ds_read_b64_tr_b16 v[64:65], v100 offset:24576
    ds_read_b64_tr_b16 v[66:67], v100 offset:25088
    ds_read_b64_tr_b16 v[68:69], v101 offset:24576
    ds_read_b64_tr_b16 v[70:71], v101 offset:25088
    ds_read_b64_tr_b16 v[72:73], v102 offset:24576
    ds_read_b64_tr_b16 v[74:75], v102 offset:25088
    ds_read_b64_tr_b16 v[76:77], v103 offset:24576
    ds_read_b64_tr_b16 v[78:79], v103 offset:25088
    ds_read_b64_tr_b16 v[80:81], v100 offset:28672
    ds_read_b64_tr_b16 v[82:83], v100 offset:29184
    ds_read_b64_tr_b16 v[84:85], v101 offset:28672
    ds_read_b64_tr_b16 v[86:87], v101 offset:29184
    ds_read_b64_tr_b16 v[88:89], v102 offset:28672
    ds_read_b64_tr_b16 v[90:91], v102 offset:29184
    ds_read_b64_tr_b16 v[92:93], v103 offset:28672
    ds_read_b64_tr_b16 v[94:95], v103 offset:29184
    s_waitcnt lgkmcnt(14)
    v_mfma_f32_16x16x32_bf16 v[32:35], v[64:67], a[72:75], v[32:35]
    s_add_u32 m0, s35, 16384
    s_add_u32 s36, s33, 221696
    s_waitcnt lgkmcnt(12)
    v_mfma_f32_16x16x32_bf16 v[36:39], v[68:71], a[72:75], v[36:39]
    buffer_load_dwordx4 v2, s[8:11], s36 offen lds
    s_waitcnt lgkmcnt(10)
    v_mfma_f32_16x16x32_bf16 v[40:43], v[72:75], a[72:75], v[40:43]
    s_add_u32 m0, s35, 20480
    s_add_u32 s36, s33, 221696
    s_waitcnt lgkmcnt(8)
    v_mfma_f32_16x16x32_bf16 v[44:47], v[76:79], a[72:75], v[44:47]
    buffer_load_dwordx4 v2, s[12:15], s36 offen lds
    s_waitcnt lgkmcnt(6)
    v_mfma_f32_16x16x32_bf16 v[48:51], v[80:83], a[72:75], v[48:51]
    s_waitcnt lgkmcnt(4)
    v_mfma_f32_16x16x32_bf16 v[52:55], v[84:87], a[72:75], v[52:55]
    s_waitcnt lgkmcnt(2)
    v_mfma_f32_16x16x32_bf16 v[56:59], v[88:91], a[72:75], v[56:59]
    s_waitcnt lgkmcnt(0)
    v_mfma_f32_16x16x32_bf16 v[60:63], v[92:95], a[72:75], v[60:63]
    s_waitcnt vmcnt(26)
    s_barrier
    ds_read_b64_tr_b16 v[64:65], v100 offset:32768
    ds_read_b64_tr_b16 v[66:67], v100 offset:33280
    ds_read_b64_tr_b16 v[68:69], v101 offset:32768
    ds_read_b64_tr_b16 v[70:71], v101 offset:33280
    ds_read_b64_tr_b16 v[72:73], v102 offset:32768
    ds_read_b64_tr_b16 v[74:75], v102 offset:33280
    ds_read_b64_tr_b16 v[76:77], v103 offset:32768
    ds_read_b64_tr_b16 v[78:79], v103 offset:33280
    ds_read_b64_tr_b16 v[80:81], v100 offset:36864
    ds_read_b64_tr_b16 v[82:83], v100 offset:37376
    ds_read_b64_tr_b16 v[84:85], v101 offset:36864
    ds_read_b64_tr_b16 v[86:87], v101 offset:37376
    ds_read_b64_tr_b16 v[88:89], v102 offset:36864
    ds_read_b64_tr_b16 v[90:91], v102 offset:37376
    ds_read_b64_tr_b16 v[92:93], v103 offset:36864
    ds_read_b64_tr_b16 v[94:95], v103 offset:37376
    s_waitcnt lgkmcnt(14)
    v_mfma_f32_16x16x32_bf16 v[32:35], v[64:67], a[76:79], v[32:35]
    s_add_u32 m0, s35, 24576
    s_add_u32 s36, s33, 332288
    s_waitcnt lgkmcnt(12)
    v_mfma_f32_16x16x32_bf16 v[36:39], v[68:71], a[76:79], v[36:39]
    buffer_load_dwordx4 v2, s[8:11], s36 offen lds
    s_waitcnt lgkmcnt(10)
    v_mfma_f32_16x16x32_bf16 v[40:43], v[72:75], a[76:79], v[40:43]
    s_add_u32 m0, s35, 28672
    s_add_u32 s36, s33, 332288
    s_waitcnt lgkmcnt(8)
    v_mfma_f32_16x16x32_bf16 v[44:47], v[76:79], a[76:79], v[44:47]
    buffer_load_dwordx4 v2, s[12:15], s36 offen lds
    s_waitcnt lgkmcnt(6)
    v_mfma_f32_16x16x32_bf16 v[48:51], v[80:83], a[76:79], v[48:51]
    s_waitcnt lgkmcnt(4)
    v_mfma_f32_16x16x32_bf16 v[52:55], v[84:87], a[76:79], v[52:55]
    s_waitcnt lgkmcnt(2)
    v_mfma_f32_16x16x32_bf16 v[56:59], v[88:91], a[76:79], v[56:59]
    s_waitcnt lgkmcnt(0)
    v_mfma_f32_16x16x32_bf16 v[60:63], v[92:95], a[76:79], v[60:63]
    s_waitcnt vmcnt(26)
    s_barrier
    ds_read_b64_tr_b16 v[64:65], v112 offset:40960
    ds_read_b64_tr_b16 v[66:67], v112 offset:45056
    ds_read_b64_tr_b16 v[68:69], v113 offset:40960
    ds_read_b64_tr_b16 v[70:71], v113 offset:45056
    ds_read_b64_tr_b16 v[72:73], v114 offset:40960
    ds_read_b64_tr_b16 v[74:75], v114 offset:45056
    ds_read_b64_tr_b16 v[76:77], v115 offset:40960
    ds_read_b64_tr_b16 v[78:79], v115 offset:45056
    ds_read_b64_tr_b16 v[80:81], v116 offset:40960
    ds_read_b64_tr_b16 v[82:83], v116 offset:45056
    ds_read_b64_tr_b16 v[84:85], v117 offset:40960
    ds_read_b64_tr_b16 v[86:87], v117 offset:45056
    ds_read_b64_tr_b16 v[88:89], v118 offset:40960
    ds_read_b64_tr_b16 v[90:91], v118 offset:45056
    ds_read_b64_tr_b16 v[92:93], v119 offset:40960
    ds_read_b64_tr_b16 v[94:95], v119 offset:45056
    v_cvt_pk_bf16_f32 v6, v32, v33
    v_lshlrev_b32 v32, 16, v6
    v_and_b32 v33, 0xffff0000, v6
    v_cvt_pk_bf16_f32 v6, v48, v49
    v_lshlrev_b32 v48, 16, v6
    v_and_b32 v49, 0xffff0000, v6
    v_mul_f32 v6, 0xbfb8aa3b, v32
    v_exp_f32 v6, v6
    s_nop 0
    v_add_f32 v6, 1.0, v6
    v_rcp_f32 v6, v6
    s_nop 0
    v_mul_f32 v32, v32, v6
    v_mul_f32 v7, 0xbfb8aa3b, v33
    v_exp_f32 v7, v7
    s_nop 0
    v_add_f32 v7, 1.0, v7
    v_rcp_f32 v7, v7
    s_nop 0
    v_mul_f32 v33, v33, v7
    v_cvt_pk_bf16_f32 v6, v32, v33
    v_lshlrev_b32 v32, 16, v6
    v_and_b32 v33, 0xffff0000, v6
    v_mul_f32 v32, v32, v48
    v_mul_f32 v33, v33, v49
    v_cvt_pk_bf16_f32 v24, v32, v33
    v_cvt_pk_bf16_f32 v6, v34, v35
    v_lshlrev_b32 v34, 16, v6
    v_and_b32 v35, 0xffff0000, v6
    v_cvt_pk_bf16_f32 v6, v50, v51
    v_lshlrev_b32 v50, 16, v6
    v_and_b32 v51, 0xffff0000, v6
    v_mul_f32 v6, 0xbfb8aa3b, v34
    v_exp_f32 v6, v6
    s_nop 0
    v_add_f32 v6, 1.0, v6
    v_rcp_f32 v6, v6
    s_nop 0
    v_mul_f32 v34, v34, v6
    v_mul_f32 v7, 0xbfb8aa3b, v35
    v_exp_f32 v7, v7
    s_nop 0
    v_add_f32 v7, 1.0, v7
    v_rcp_f32 v7, v7
    s_nop 0
    v_mul_f32 v35, v35, v7
    v_cvt_pk_bf16_f32 v6, v34, v35
    v_lshlrev_b32 v34, 16, v6
    v_and_b32 v35, 0xffff0000, v6
    v_mul_f32 v34, v34, v50
    v_mul_f32 v35, v35, v51
    v_cvt_pk_bf16_f32 v25, v34, v35
    v_cvt_pk_bf16_f32 v6, v36, v37
    v_lshlrev_b32 v36, 16, v6
    v_and_b32 v37, 0xffff0000, v6
    v_cvt_pk_bf16_f32 v6, v52, v53
    v_lshlrev_b32 v52, 16, v6
    v_and_b32 v53, 0xffff0000, v6
    v_mul_f32 v6, 0xbfb8aa3b, v36
    v_exp_f32 v6, v6
    s_nop 0
    v_add_f32 v6, 1.0, v6
    v_rcp_f32 v6, v6
    s_nop 0
    v_mul_f32 v36, v36, v6
    v_mul_f32 v7, 0xbfb8aa3b, v37
    v_exp_f32 v7, v7
    s_nop 0
    v_add_f32 v7, 1.0, v7
    v_rcp_f32 v7, v7
    s_nop 0
    v_mul_f32 v37, v37, v7
    v_cvt_pk_bf16_f32 v6, v36, v37
    v_lshlrev_b32 v36, 16, v6
    v_and_b32 v37, 0xffff0000, v6
    v_mul_f32 v36, v36, v52
    v_mul_f32 v37, v37, v53
    v_cvt_pk_bf16_f32 v26, v36, v37
    v_cvt_pk_bf16_f32 v6, v38, v39
    v_lshlrev_b32 v38, 16, v6
    v_and_b32 v39, 0xffff0000, v6
    v_cvt_pk_bf16_f32 v6, v54, v55
    v_lshlrev_b32 v54, 16, v6
    v_and_b32 v55, 0xffff0000, v6
    v_mul_f32 v6, 0xbfb8aa3b, v38
    v_exp_f32 v6, v6
    s_nop 0
    v_add_f32 v6, 1.0, v6
    v_rcp_f32 v6, v6
    s_nop 0
    v_mul_f32 v38, v38, v6
    v_mul_f32 v7, 0xbfb8aa3b, v39
    v_exp_f32 v7, v7
    s_nop 0
    v_add_f32 v7, 1.0, v7
    v_rcp_f32 v7, v7
    s_nop 0
    v_mul_f32 v39, v39, v7
    v_cvt_pk_bf16_f32 v6, v38, v39
    v_lshlrev_b32 v38, 16, v6
    v_and_b32 v39, 0xffff0000, v6
    v_mul_f32 v38, v38, v54
    v_mul_f32 v39, v39, v55
    v_cvt_pk_bf16_f32 v27, v38, v39
    v_cvt_pk_bf16_f32 v6, v40, v41
    v_lshlrev_b32 v40, 16, v6
    v_and_b32 v41, 0xffff0000, v6
    v_cvt_pk_bf16_f32 v6, v56, v57
    v_lshlrev_b32 v56, 16, v6
    v_and_b32 v57, 0xffff0000, v6
    v_mul_f32 v6, 0xbfb8aa3b, v40
    v_exp_f32 v6, v6
    s_nop 0
    v_add_f32 v6, 1.0, v6
    v_rcp_f32 v6, v6
    s_nop 0
    v_mul_f32 v40, v40, v6
    v_mul_f32 v7, 0xbfb8aa3b, v41
    v_exp_f32 v7, v7
    s_nop 0
    v_add_f32 v7, 1.0, v7
    v_rcp_f32 v7, v7
    s_nop 0
    v_mul_f32 v41, v41, v7
    v_cvt_pk_bf16_f32 v6, v40, v41
    v_lshlrev_b32 v40, 16, v6
    v_and_b32 v41, 0xffff0000, v6
    v_mul_f32 v40, v40, v56
    v_mul_f32 v41, v41, v57
    v_cvt_pk_bf16_f32 v28, v40, v41
    v_cvt_pk_bf16_f32 v6, v42, v43
    v_lshlrev_b32 v42, 16, v6
    v_and_b32 v43, 0xffff0000, v6
    v_cvt_pk_bf16_f32 v6, v58, v59
    v_lshlrev_b32 v58, 16, v6
    v_and_b32 v59, 0xffff0000, v6
    v_mul_f32 v6, 0xbfb8aa3b, v42
    v_exp_f32 v6, v6
    s_nop 0
    v_add_f32 v6, 1.0, v6
    v_rcp_f32 v6, v6
    s_nop 0
    v_mul_f32 v42, v42, v6
    v_mul_f32 v7, 0xbfb8aa3b, v43
    v_exp_f32 v7, v7
    s_nop 0
    v_add_f32 v7, 1.0, v7
    v_rcp_f32 v7, v7
    s_nop 0
    v_mul_f32 v43, v43, v7
    v_cvt_pk_bf16_f32 v6, v42, v43
    v_lshlrev_b32 v42, 16, v6
    v_and_b32 v43, 0xffff0000, v6
    v_mul_f32 v42, v42, v58
    v_mul_f32 v43, v43, v59
    v_cvt_pk_bf16_f32 v29, v42, v43
    v_cvt_pk_bf16_f32 v6, v44, v45
    v_lshlrev_b32 v44, 16, v6
    v_and_b32 v45, 0xffff0000, v6
    v_cvt_pk_bf16_f32 v6, v60, v61
    v_lshlrev_b32 v60, 16, v6
    v_and_b32 v61, 0xffff0000, v6
    v_mul_f32 v6, 0xbfb8aa3b, v44
    v_exp_f32 v6, v6
    s_nop 0
    v_add_f32 v6, 1.0, v6
    v_rcp_f32 v6, v6
    s_nop 0
    v_mul_f32 v44, v44, v6
    v_mul_f32 v7, 0xbfb8aa3b, v45
    v_exp_f32 v7, v7
    s_nop 0
    v_add_f32 v7, 1.0, v7
    v_rcp_f32 v7, v7
    s_nop 0
    v_mul_f32 v45, v45, v7
    v_cvt_pk_bf16_f32 v6, v44, v45
    v_lshlrev_b32 v44, 16, v6
    v_and_b32 v45, 0xffff0000, v6
    v_mul_f32 v44, v44, v60
    v_mul_f32 v45, v45, v61
    v_cvt_pk_bf16_f32 v30, v44, v45
    v_cvt_pk_bf16_f32 v6, v46, v47
    v_lshlrev_b32 v46, 16, v6
    v_and_b32 v47, 0xffff0000, v6
    v_cvt_pk_bf16_f32 v6, v62, v63
    v_lshlrev_b32 v62, 16, v6
    v_and_b32 v63, 0xffff0000, v6
    v_mul_f32 v6, 0xbfb8aa3b, v46
    v_exp_f32 v6, v6
    s_nop 0
    v_add_f32 v6, 1.0, v6
    v_rcp_f32 v6, v6
    s_nop 0
    v_mul_f32 v46, v46, v6
    v_mul_f32 v7, 0xbfb8aa3b, v47
    v_exp_f32 v7, v7
    s_nop 0
    v_add_f32 v7, 1.0, v7
    v_rcp_f32 v7, v7
    s_nop 0
    v_mul_f32 v47, v47, v7
    v_cvt_pk_bf16_f32 v6, v46, v47
    v_lshlrev_b32 v46, 16, v6
    v_and_b32 v47, 0xffff0000, v6
    v_mul_f32 v46, v46, v62
    v_mul_f32 v47, v47, v63
    v_cvt_pk_bf16_f32 v31, v46, v47
    s_nop 0
    s_waitcnt lgkmcnt(14)
    v_mfma_f32_16x16x32_bf16 a[80:83], v[64:67], v[24:27], a[80:83]
    s_add_u32 m0, s35, 32768
    s_add_u32 s36, s33, 442880
    s_waitcnt lgkmcnt(12)
    v_mfma_f32_16x16x32_bf16 a[84:87], v[68:71], v[24:27], a[84:87]
    buffer_load_dwordx4 v2, s[8:11], s36 offen lds
    s_waitcnt lgkmcnt(10)
    v_mfma_f32_16x16x32_bf16 a[88:91], v[72:75], v[24:27], a[88:91]
    s_add_u32 m0, s35, 36864
    s_add_u32 s36, s33, 442880
    s_waitcnt lgkmcnt(8)
    v_mfma_f32_16x16x32_bf16 a[92:95], v[76:79], v[24:27], a[92:95]
    buffer_load_dwordx4 v2, s[12:15], s36 offen lds
    s_waitcnt lgkmcnt(6)
    v_mfma_f32_16x16x32_bf16 a[96:99], v[80:83], v[24:27], a[96:99]
    s_waitcnt lgkmcnt(4)
    v_mfma_f32_16x16x32_bf16 a[100:103], v[84:87], v[24:27], a[100:103]
    s_waitcnt lgkmcnt(2)
    v_mfma_f32_16x16x32_bf16 a[104:107], v[88:91], v[24:27], a[104:107]
    s_waitcnt lgkmcnt(0)
    v_mfma_f32_16x16x32_bf16 a[108:111], v[92:95], v[24:27], a[108:111]
    s_waitcnt vmcnt(26)
    s_barrier
    ds_read_b64_tr_b16 v[64:65], v112 offset:49152
    ds_read_b64_tr_b16 v[66:67], v112 offset:53248
    ds_read_b64_tr_b16 v[68:69], v113 offset:49152
    ds_read_b64_tr_b16 v[70:71], v113 offset:53248
    ds_read_b64_tr_b16 v[72:73], v114 offset:49152
    ds_read_b64_tr_b16 v[74:75], v114 offset:53248
    ds_read_b64_tr_b16 v[76:77], v115 offset:49152
    ds_read_b64_tr_b16 v[78:79], v115 offset:53248
    ds_read_b64_tr_b16 v[80:81], v116 offset:49152
    ds_read_b64_tr_b16 v[82:83], v116 offset:53248
    ds_read_b64_tr_b16 v[84:85], v117 offset:49152
    ds_read_b64_tr_b16 v[86:87], v117 offset:53248
    ds_read_b64_tr_b16 v[88:89], v118 offset:49152
    ds_read_b64_tr_b16 v[90:91], v118 offset:53248
    ds_read_b64_tr_b16 v[92:93], v119 offset:49152
    ds_read_b64_tr_b16 v[94:95], v119 offset:53248
    s_waitcnt lgkmcnt(14)
    v_mfma_f32_16x16x32_bf16 a[112:115], v[64:67], v[24:27], a[112:115]
    s_add_u32 m0, s35, 40960
    s_add_u32 s36, s33, 553472
    s_waitcnt lgkmcnt(12)
    v_mfma_f32_16x16x32_bf16 a[116:119], v[68:71], v[24:27], a[116:119]
    buffer_load_dwordx4 v2, s[8:11], s36 offen lds
    s_waitcnt lgkmcnt(10)
    v_mfma_f32_16x16x32_bf16 a[120:123], v[72:75], v[24:27], a[120:123]
    s_add_u32 m0, s35, 45056
    s_add_u32 s36, s33, 553472
    s_waitcnt lgkmcnt(8)
    v_mfma_f32_16x16x32_bf16 a[124:127], v[76:79], v[24:27], a[124:127]
    buffer_load_dwordx4 v2, s[12:15], s36 offen lds
    s_waitcnt lgkmcnt(6)
    v_mfma_f32_16x16x32_bf16 a[128:131], v[80:83], v[24:27], a[128:131]
    s_waitcnt lgkmcnt(4)
    v_mfma_f32_16x16x32_bf16 a[132:135], v[84:87], v[24:27], a[132:135]
    s_waitcnt lgkmcnt(2)
    v_mfma_f32_16x16x32_bf16 a[136:139], v[88:91], v[24:27], a[136:139]
    s_waitcnt lgkmcnt(0)
    v_mfma_f32_16x16x32_bf16 a[140:143], v[92:95], v[24:27], a[140:143]
    s_waitcnt vmcnt(26)
    s_barrier
    ds_read_b64_tr_b16 v[64:65], v112 offset:57344
    ds_read_b64_tr_b16 v[66:67], v112 offset:61440
    ds_read_b64_tr_b16 v[68:69], v113 offset:57344
    ds_read_b64_tr_b16 v[70:71], v113 offset:61440
    ds_read_b64_tr_b16 v[72:73], v114 offset:57344
    ds_read_b64_tr_b16 v[74:75], v114 offset:61440
    ds_read_b64_tr_b16 v[76:77], v115 offset:57344
    ds_read_b64_tr_b16 v[78:79], v115 offset:61440
    ds_read_b64_tr_b16 v[80:81], v116 offset:57344
    ds_read_b64_tr_b16 v[82:83], v116 offset:61440
    ds_read_b64_tr_b16 v[84:85], v117 offset:57344
    ds_read_b64_tr_b16 v[86:87], v117 offset:61440
    ds_read_b64_tr_b16 v[88:89], v118 offset:57344
    ds_read_b64_tr_b16 v[90:91], v118 offset:61440
    ds_read_b64_tr_b16 v[92:93], v119 offset:57344
    ds_read_b64_tr_b16 v[94:95], v119 offset:61440
    s_waitcnt lgkmcnt(14)
    v_mfma_f32_16x16x32_bf16 a[144:147], v[64:67], v[24:27], a[144:147]
    s_add_u32 m0, s35, 49152
    s_add_u32 s36, s33, 664064
    s_waitcnt lgkmcnt(12)
    v_mfma_f32_16x16x32_bf16 a[148:151], v[68:71], v[24:27], a[148:151]
    buffer_load_dwordx4 v2, s[8:11], s36 offen lds
    s_waitcnt lgkmcnt(10)
    v_mfma_f32_16x16x32_bf16 a[152:155], v[72:75], v[24:27], a[152:155]
    s_add_u32 m0, s35, 53248
    s_add_u32 s36, s33, 664064
    s_waitcnt lgkmcnt(8)
    v_mfma_f32_16x16x32_bf16 a[156:159], v[76:79], v[24:27], a[156:159]
    buffer_load_dwordx4 v2, s[12:15], s36 offen lds
    s_waitcnt lgkmcnt(6)
    v_mfma_f32_16x16x32_bf16 a[160:163], v[80:83], v[24:27], a[160:163]
    s_waitcnt lgkmcnt(4)
    v_mfma_f32_16x16x32_bf16 a[164:167], v[84:87], v[24:27], a[164:167]
    s_waitcnt lgkmcnt(2)
    v_mfma_f32_16x16x32_bf16 a[168:171], v[88:91], v[24:27], a[168:171]
    s_waitcnt lgkmcnt(0)
    v_mfma_f32_16x16x32_bf16 a[172:175], v[92:95], v[24:27], a[172:175]
    s_waitcnt vmcnt(26)
    s_barrier
    ds_read_b64_tr_b16 v[64:65], v120 offset:0
    ds_read_b64_tr_b16 v[66:67], v120 offset:4096
    ds_read_b64_tr_b16 v[68:69], v121 offset:0
    ds_read_b64_tr_b16 v[70:71], v121 offset:4096
    ds_read_b64_tr_b16 v[72:73], v122 offset:0
    ds_read_b64_tr_b16 v[74:75], v122 offset:4096
    ds_read_b64_tr_b16 v[76:77], v123 offset:0
    ds_read_b64_tr_b16 v[78:79], v123 offset:4096
    ds_read_b64_tr_b16 v[80:81], v124 offset:0
    ds_read_b64_tr_b16 v[82:83], v124 offset:4096
    ds_read_b64_tr_b16 v[84:85], v125 offset:0
    ds_read_b64_tr_b16 v[86:87], v125 offset:4096
    ds_read_b64_tr_b16 v[88:89], v126 offset:0
    ds_read_b64_tr_b16 v[90:91], v126 offset:4096
    ds_read_b64_tr_b16 v[92:93], v127 offset:0
    ds_read_b64_tr_b16 v[94:95], v127 offset:4096
    s_waitcnt lgkmcnt(14)
    v_mfma_f32_16x16x32_bf16 a[176:179], v[64:67], v[24:27], a[176:179]
    s_add_u32 m0, s35, 57344
    s_add_u32 s36, s33, 774656
    s_waitcnt lgkmcnt(12)
    v_mfma_f32_16x16x32_bf16 a[180:183], v[68:71], v[24:27], a[180:183]
    buffer_load_dwordx4 v2, s[8:11], s36 offen lds
    s_waitcnt lgkmcnt(10)
    v_mfma_f32_16x16x32_bf16 a[184:187], v[72:75], v[24:27], a[184:187]
    s_add_u32 m0, s35, 61440
    s_add_u32 s36, s33, 774656
    s_waitcnt lgkmcnt(8)
    v_mfma_f32_16x16x32_bf16 a[188:191], v[76:79], v[24:27], a[188:191]
    buffer_load_dwordx4 v2, s[12:15], s36 offen lds
    s_waitcnt lgkmcnt(6)
    v_mfma_f32_16x16x32_bf16 a[192:195], v[80:83], v[24:27], a[192:195]
    s_waitcnt lgkmcnt(4)
    v_mfma_f32_16x16x32_bf16 a[196:199], v[84:87], v[24:27], a[196:199]
    s_waitcnt lgkmcnt(2)
    v_mfma_f32_16x16x32_bf16 a[200:203], v[88:91], v[24:27], a[200:203]
    s_waitcnt lgkmcnt(0)
    v_mfma_f32_16x16x32_bf16 a[204:207], v[92:95], v[24:27], a[204:207]
    s_waitcnt vmcnt(26)
    s_barrier
    ds_read_b64_tr_b16 v[64:65], v120 offset:8192
    ds_read_b64_tr_b16 v[66:67], v120 offset:12288
    ds_read_b64_tr_b16 v[68:69], v121 offset:8192
    ds_read_b64_tr_b16 v[70:71], v121 offset:12288
    ds_read_b64_tr_b16 v[72:73], v122 offset:8192
    ds_read_b64_tr_b16 v[74:75], v122 offset:12288
    ds_read_b64_tr_b16 v[76:77], v123 offset:8192
    ds_read_b64_tr_b16 v[78:79], v123 offset:12288
    ds_read_b64_tr_b16 v[80:81], v124 offset:8192
    ds_read_b64_tr_b16 v[82:83], v124 offset:12288
    ds_read_b64_tr_b16 v[84:85], v125 offset:8192
    ds_read_b64_tr_b16 v[86:87], v125 offset:12288
    ds_read_b64_tr_b16 v[88:89], v126 offset:8192
    ds_read_b64_tr_b16 v[90:91], v126 offset:12288
    ds_read_b64_tr_b16 v[92:93], v127 offset:8192
    ds_read_b64_tr_b16 v[94:95], v127 offset:12288
    s_waitcnt lgkmcnt(14)
    v_mfma_f32_16x16x32_bf16 a[208:211], v[64:67], v[24:27], a[208:211]
    s_add_u32 m0, s35, 65536
    s_add_u32 s36, s33, 885248
    s_waitcnt lgkmcnt(12)
    v_mfma_f32_16x16x32_bf16 a[212:215], v[68:71], v[24:27], a[212:215]
    buffer_load_dwordx4 v2, s[8:11], s36 offen lds
    s_waitcnt lgkmcnt(10)
    v_mfma_f32_16x16x32_bf16 a[216:219], v[72:75], v[24:27], a[216:219]
    s_add_u32 m0, s35, 69632
    s_add_u32 s36, s33, 885248
    s_waitcnt lgkmcnt(8)
    v_mfma_f32_16x16x32_bf16 a[220:223], v[76:79], v[24:27], a[220:223]
    buffer_load_dwordx4 v2, s[12:15], s36 offen lds
    s_waitcnt lgkmcnt(6)
    v_mfma_f32_16x16x32_bf16 a[224:227], v[80:83], v[24:27], a[224:227]
    s_waitcnt lgkmcnt(4)
    v_mfma_f32_16x16x32_bf16 a[228:231], v[84:87], v[24:27], a[228:231]
    s_waitcnt lgkmcnt(2)
    v_mfma_f32_16x16x32_bf16 a[232:235], v[88:91], v[24:27], a[232:235]
    s_waitcnt lgkmcnt(0)
    v_mfma_f32_16x16x32_bf16 a[236:239], v[92:95], v[24:27], a[236:239]
    s_waitcnt vmcnt(26)
    s_barrier
    ds_read_b64_tr_b16 v[64:65], v120 offset:16384
    ds_read_b64_tr_b16 v[66:67], v120 offset:20480
    ds_read_b64_tr_b16 v[68:69], v121 offset:16384
    ds_read_b64_tr_b16 v[70:71], v121 offset:20480
    ds_read_b64_tr_b16 v[72:73], v122 offset:16384
    ds_read_b64_tr_b16 v[74:75], v122 offset:20480
    ds_read_b64_tr_b16 v[76:77], v123 offset:16384
    ds_read_b64_tr_b16 v[78:79], v123 offset:20480
    ds_read_b64_tr_b16 v[80:81], v124 offset:16384
    ds_read_b64_tr_b16 v[82:83], v124 offset:20480
    ds_read_b64_tr_b16 v[84:85], v125 offset:16384
    ds_read_b64_tr_b16 v[86:87], v125 offset:20480
    ds_read_b64_tr_b16 v[88:89], v126 offset:16384
    ds_read_b64_tr_b16 v[90:91], v126 offset:20480
    ds_read_b64_tr_b16 v[92:93], v127 offset:16384
    ds_read_b64_tr_b16 v[94:95], v127 offset:20480
    s_waitcnt lgkmcnt(14)
    v_mfma_f32_16x16x32_bf16 a[80:83], v[64:67], v[28:31], a[80:83]
    s_add_u32 m0, s35, 73728
    s_add_u32 s36, s33, 995840
    s_waitcnt lgkmcnt(12)
    v_mfma_f32_16x16x32_bf16 a[84:87], v[68:71], v[28:31], a[84:87]
    buffer_load_dwordx4 v2, s[8:11], s36 offen lds
    s_waitcnt lgkmcnt(10)
    v_mfma_f32_16x16x32_bf16 a[88:91], v[72:75], v[28:31], a[88:91]
    s_add_u32 m0, s35, 77824
    s_add_u32 s36, s33, 995840
    s_waitcnt lgkmcnt(8)
    v_mfma_f32_16x16x32_bf16 a[92:95], v[76:79], v[28:31], a[92:95]
    buffer_load_dwordx4 v2, s[12:15], s36 offen lds
    s_waitcnt lgkmcnt(6)
    v_mfma_f32_16x16x32_bf16 a[96:99], v[80:83], v[28:31], a[96:99]
    s_waitcnt lgkmcnt(4)
    v_mfma_f32_16x16x32_bf16 a[100:103], v[84:87], v[28:31], a[100:103]
    s_waitcnt lgkmcnt(2)
    v_mfma_f32_16x16x32_bf16 a[104:107], v[88:91], v[28:31], a[104:107]
    s_waitcnt lgkmcnt(0)
    v_mfma_f32_16x16x32_bf16 a[108:111], v[92:95], v[28:31], a[108:111]
    s_waitcnt vmcnt(26)
    s_barrier
    ds_read_b64_tr_b16 v[64:65], v120 offset:24576
    ds_read_b64_tr_b16 v[66:67], v120 offset:28672
    ds_read_b64_tr_b16 v[68:69], v121 offset:24576
    ds_read_b64_tr_b16 v[70:71], v121 offset:28672
    ds_read_b64_tr_b16 v[72:73], v122 offset:24576
    ds_read_b64_tr_b16 v[74:75], v122 offset:28672
    ds_read_b64_tr_b16 v[76:77], v123 offset:24576
    ds_read_b64_tr_b16 v[78:79], v123 offset:28672
    ds_read_b64_tr_b16 v[80:81], v124 offset:24576
    ds_read_b64_tr_b16 v[82:83], v124 offset:28672
    ds_read_b64_tr_b16 v[84:85], v125 offset:24576
    ds_read_b64_tr_b16 v[86:87], v125 offset:28672
    ds_read_b64_tr_b16 v[88:89], v126 offset:24576
    ds_read_b64_tr_b16 v[90:91], v126 offset:28672
    ds_read_b64_tr_b16 v[92:93], v127 offset:24576
    ds_read_b64_tr_b16 v[94:95], v127 offset:28672
    s_waitcnt lgkmcnt(14)
    v_mfma_f32_16x16x32_bf16 a[112:115], v[64:67], v[28:31], a[112:115]
    s_add_u32 m0, s35, 81920
    s_add_u32 s36, s33, 1106432
    s_waitcnt lgkmcnt(12)
    v_mfma_f32_16x16x32_bf16 a[116:119], v[68:71], v[28:31], a[116:119]
    buffer_load_dwordx4 v2, s[8:11], s36 offen lds
    s_waitcnt lgkmcnt(10)
    v_mfma_f32_16x16x32_bf16 a[120:123], v[72:75], v[28:31], a[120:123]
    s_add_u32 m0, s35, 86016
    s_add_u32 s36, s33, 1106432
    s_waitcnt lgkmcnt(8)
    v_mfma_f32_16x16x32_bf16 a[124:127], v[76:79], v[28:31], a[124:127]
    buffer_load_dwordx4 v2, s[12:15], s36 offen lds
    s_waitcnt lgkmcnt(6)
    v_mfma_f32_16x16x32_bf16 a[128:131], v[80:83], v[28:31], a[128:131]
    s_waitcnt lgkmcnt(4)
    v_mfma_f32_16x16x32_bf16 a[132:135], v[84:87], v[28:31], a[132:135]
    s_waitcnt lgkmcnt(2)
    v_mfma_f32_16x16x32_bf16 a[136:139], v[88:91], v[28:31], a[136:139]
    s_waitcnt lgkmcnt(0)
    v_mfma_f32_16x16x32_bf16 a[140:143], v[92:95], v[28:31], a[140:143]
    s_waitcnt vmcnt(26)
    s_barrier
    ds_read_b64_tr_b16 v[64:65], v120 offset:32768
    ds_read_b64_tr_b16 v[66:67], v120 offset:36864
    ds_read_b64_tr_b16 v[68:69], v121 offset:32768
    ds_read_b64_tr_b16 v[70:71], v121 offset:36864
    ds_read_b64_tr_b16 v[72:73], v122 offset:32768
    ds_read_b64_tr_b16 v[74:75], v122 offset:36864
    ds_read_b64_tr_b16 v[76:77], v123 offset:32768
    ds_read_b64_tr_b16 v[78:79], v123 offset:36864
    ds_read_b64_tr_b16 v[80:81], v124 offset:32768
    ds_read_b64_tr_b16 v[82:83], v124 offset:36864
    ds_read_b64_tr_b16 v[84:85], v125 offset:32768
    ds_read_b64_tr_b16 v[86:87], v125 offset:36864
    ds_read_b64_tr_b16 v[88:89], v126 offset:32768
    ds_read_b64_tr_b16 v[90:91], v126 offset:36864
    ds_read_b64_tr_b16 v[92:93], v127 offset:32768
    ds_read_b64_tr_b16 v[94:95], v127 offset:36864
    s_waitcnt lgkmcnt(14)
    v_mfma_f32_16x16x32_bf16 a[144:147], v[64:67], v[28:31], a[144:147]
    s_add_u32 m0, s35, 90112
    s_add_u32 s36, s33, 1217024
    s_waitcnt lgkmcnt(12)
    v_mfma_f32_16x16x32_bf16 a[148:151], v[68:71], v[28:31], a[148:151]
    buffer_load_dwordx4 v2, s[8:11], s36 offen lds
    s_waitcnt lgkmcnt(10)
    v_mfma_f32_16x16x32_bf16 a[152:155], v[72:75], v[28:31], a[152:155]
    s_add_u32 m0, s35, 94208
    s_add_u32 s36, s33, 1217024
    s_waitcnt lgkmcnt(8)
    v_mfma_f32_16x16x32_bf16 a[156:159], v[76:79], v[28:31], a[156:159]
    buffer_load_dwordx4 v2, s[12:15], s36 offen lds
    s_waitcnt lgkmcnt(6)
    v_mfma_f32_16x16x32_bf16 a[160:163], v[80:83], v[28:31], a[160:163]
    s_waitcnt lgkmcnt(4)
    v_mfma_f32_16x16x32_bf16 a[164:167], v[84:87], v[28:31], a[164:167]
    s_waitcnt lgkmcnt(2)
    v_mfma_f32_16x16x32_bf16 a[168:171], v[88:91], v[28:31], a[168:171]
    s_waitcnt lgkmcnt(0)
    v_mfma_f32_16x16x32_bf16 a[172:175], v[92:95], v[28:31], a[172:175]
    s_waitcnt vmcnt(26)
    s_barrier
    ds_read_b64_tr_b16 v[64:65], v120 offset:40960
    ds_read_b64_tr_b16 v[66:67], v120 offset:45056
    ds_read_b64_tr_b16 v[68:69], v121 offset:40960
    ds_read_b64_tr_b16 v[70:71], v121 offset:45056
    ds_read_b64_tr_b16 v[72:73], v122 offset:40960
    ds_read_b64_tr_b16 v[74:75], v122 offset:45056
    ds_read_b64_tr_b16 v[76:77], v123 offset:40960
    ds_read_b64_tr_b16 v[78:79], v123 offset:45056
    ds_read_b64_tr_b16 v[80:81], v124 offset:40960
    ds_read_b64_tr_b16 v[82:83], v124 offset:45056
    ds_read_b64_tr_b16 v[84:85], v125 offset:40960
    ds_read_b64_tr_b16 v[86:87], v125 offset:45056
    ds_read_b64_tr_b16 v[88:89], v126 offset:40960
    ds_read_b64_tr_b16 v[90:91], v126 offset:45056
    ds_read_b64_tr_b16 v[92:93], v127 offset:40960
    ds_read_b64_tr_b16 v[94:95], v127 offset:45056
    s_waitcnt lgkmcnt(14)
    v_mfma_f32_16x16x32_bf16 a[176:179], v[64:67], v[28:31], a[176:179]
    s_add_u32 m0, s35, 98304
    s_add_u32 s36, s33, 1327616
    s_waitcnt lgkmcnt(12)
    v_mfma_f32_16x16x32_bf16 a[180:183], v[68:71], v[28:31], a[180:183]
    buffer_load_dwordx4 v2, s[8:11], s36 offen lds
    s_waitcnt lgkmcnt(10)
    v_mfma_f32_16x16x32_bf16 a[184:187], v[72:75], v[28:31], a[184:187]
    s_add_u32 m0, s35, 102400
    s_add_u32 s36, s33, 1327616
    s_waitcnt lgkmcnt(8)
    v_mfma_f32_16x16x32_bf16 a[188:191], v[76:79], v[28:31], a[188:191]
    buffer_load_dwordx4 v2, s[12:15], s36 offen lds
    s_waitcnt lgkmcnt(6)
    v_mfma_f32_16x16x32_bf16 a[192:195], v[80:83], v[28:31], a[192:195]
    s_waitcnt lgkmcnt(4)
    v_mfma_f32_16x16x32_bf16 a[196:199], v[84:87], v[28:31], a[196:199]
    s_waitcnt lgkmcnt(2)
    v_mfma_f32_16x16x32_bf16 a[200:203], v[88:91], v[28:31], a[200:203]
    s_waitcnt lgkmcnt(0)
    v_mfma_f32_16x16x32_bf16 a[204:207], v[92:95], v[28:31], a[204:207]
    s_waitcnt vmcnt(26)
    s_barrier
    ds_read_b64_tr_b16 v[64:65], v120 offset:49152
    ds_read_b64_tr_b16 v[66:67], v120 offset:53248
    ds_read_b64_tr_b16 v[68:69], v121 offset:49152
    ds_read_b64_tr_b16 v[70:71], v121 offset:53248
    ds_read_b64_tr_b16 v[72:73], v122 offset:49152
    ds_read_b64_tr_b16 v[74:75], v122 offset:53248
    ds_read_b64_tr_b16 v[76:77], v123 offset:49152
    ds_read_b64_tr_b16 v[78:79], v123 offset:53248
    ds_read_b64_tr_b16 v[80:81], v124 offset:49152
    ds_read_b64_tr_b16 v[82:83], v124 offset:53248
    ds_read_b64_tr_b16 v[84:85], v125 offset:49152
    ds_read_b64_tr_b16 v[86:87], v125 offset:53248
    ds_read_b64_tr_b16 v[88:89], v126 offset:49152
    ds_read_b64_tr_b16 v[90:91], v126 offset:53248
    ds_read_b64_tr_b16 v[92:93], v127 offset:49152
    ds_read_b64_tr_b16 v[94:95], v127 offset:53248
    s_waitcnt lgkmcnt(14)
    v_mfma_f32_16x16x32_bf16 a[208:211], v[64:67], v[28:31], a[208:211]
    s_add_u32 m0, s35, 106496
    s_add_u32 s36, s33, 1438208
    s_waitcnt lgkmcnt(12)
    v_mfma_f32_16x16x32_bf16 a[212:215], v[68:71], v[28:31], a[212:215]
    buffer_load_dwordx4 v2, s[8:11], s36 offen lds
    s_waitcnt lgkmcnt(10)
    v_mfma_f32_16x16x32_bf16 a[216:219], v[72:75], v[28:31], a[216:219]
    s_add_u32 m0, s35, 110592
    s_add_u32 s36, s33, 1438208
    s_waitcnt lgkmcnt(8)
    v_mfma_f32_16x16x32_bf16 a[220:223], v[76:79], v[28:31], a[220:223]
    buffer_load_dwordx4 v2, s[12:15], s36 offen lds
    s_waitcnt lgkmcnt(6)
    v_mfma_f32_16x16x32_bf16 a[224:227], v[80:83], v[28:31], a[224:227]
    s_waitcnt lgkmcnt(4)
    v_mfma_f32_16x16x32_bf16 a[228:231], v[84:87], v[28:31], a[228:231]
    s_waitcnt lgkmcnt(2)
    v_mfma_f32_16x16x32_bf16 a[232:235], v[88:91], v[28:31], a[232:235]
    s_waitcnt lgkmcnt(0)
    v_mfma_f32_16x16x32_bf16 a[236:239], v[92:95], v[28:31], a[236:239]
    s_add_u32 s33, s33, 512
    s_add_u32 s34, s34, 327680
    s_sub_u32 s32, s32, 1
    s_cmp_lg_u32 s32, 0
    s_cbranch_scc1 ffn_loop
    s_waitcnt vmcnt(0)
    s_barrier
    s_lshl_b32 s36, s43, 7
    s_add_u32 s36, s36, s39
    s_mul_i32 s36, s36, 40960
    s_add_u32 s36, s36, 127401984
    buffer_store_dwordx4 a[80:83], v1, s[4:7], s36 offen offset:0 sc1
    buffer_store_dwordx4 a[84:87], v1, s[4:7], s36 offen offset:1024 sc1
    buffer_store_dwordx4 a[88:91], v1, s[4:7], s36 offen offset:2048 sc1
    buffer_store_dwordx4 a[92:95], v1, s[4:7], s36 offen offset:3072 sc1
    s_add_u32 s36, s36, 4096
    buffer_store_dwordx4 a[96:99], v1, s[4:7], s36 offen offset:0 sc1
    buffer_store_dwordx4 a[100:103], v1, s[4:7], s36 offen offset:1024 sc1
    buffer_store_dwordx4 a[104:107], v1, s[4:7], s36 offen offset:2048 sc1
    buffer_store_dwordx4 a[108:111], v1, s[4:7], s36 offen offset:3072 sc1
    s_add_u32 s36, s36, 4096
    buffer_store_dwordx4 a[112:115], v1, s[4:7], s36 offen offset:0 sc1
    buffer_store_dwordx4 a[116:119], v1, s[4:7], s36 offen offset:1024 sc1
    buffer_store_dwordx4 a[120:123], v1, s[4:7], s36 offen offset:2048 sc1
    buffer_store_dwordx4 a[124:127], v1, s[4:7], s36 offen offset:3072 sc1
    s_add_u32 s36, s36, 4096
    buffer_store_dwordx4 a[128:131], v1, s[4:7], s36 offen offset:0 sc1
    buffer_store_dwordx4 a[132:135], v1, s[4:7], s36 offen offset:1024 sc1
    buffer_store_dwordx4 a[136:139], v1, s[4:7], s36 offen offset:2048 sc1
    buffer_store_dwordx4 a[140:143], v1, s[4:7], s36 offen offset:3072 sc1
    s_add_u32 s36, s36, 4096
    buffer_store_dwordx4 a[144:147], v1, s[4:7], s36 offen offset:0 sc1
    buffer_store_dwordx4 a[148:151], v1, s[4:7], s36 offen offset:1024 sc1
    buffer_store_dwordx4 a[152:155], v1, s[4:7], s36 offen offset:2048 sc1
    buffer_store_dwordx4 a[156:159], v1, s[4:7], s36 offen offset:3072 sc1
    s_add_u32 s36, s36, 4096
    buffer_store_dwordx4 a[160:163], v1, s[4:7], s36 offen offset:0 sc1
    buffer_store_dwordx4 a[164:167], v1, s[4:7], s36 offen offset:1024 sc1
    buffer_store_dwordx4 a[168:171], v1, s[4:7], s36 offen offset:2048 sc1
    buffer_store_dwordx4 a[172:175], v1, s[4:7], s36 offen offset:3072 sc1
    s_add_u32 s36, s36, 4096
    buffer_store_dwordx4 a[176:179], v1, s[4:7], s36 offen offset:0 sc1
    buffer_store_dwordx4 a[180:183], v1, s[4:7], s36 offen offset:1024 sc1
    buffer_store_dwordx4 a[184:187], v1, s[4:7], s36 offen offset:2048 sc1
    buffer_store_dwordx4 a[188:191], v1, s[4:7], s36 offen offset:3072 sc1
    s_add_u32 s36, s36, 4096
    buffer_store_dwordx4 a[192:195], v1, s[4:7], s36 offen offset:0 sc1
    buffer_store_dwordx4 a[196:199], v1, s[4:7], s36 offen offset:1024 sc1
    buffer_store_dwordx4 a[200:203], v1, s[4:7], s36 offen offset:2048 sc1
    buffer_store_dwordx4 a[204:207], v1, s[4:7], s36 offen offset:3072 sc1
    s_add_u32 s36, s36, 4096
    buffer_store_dwordx4 a[208:211], v1, s[4:7], s36 offen offset:0 sc1
    buffer_store_dwordx4 a[212:215], v1, s[4:7], s36 offen offset:1024 sc1
    buffer_store_dwordx4 a[216:219], v1, s[4:7], s36 offen offset:2048 sc1
    buffer_store_dwordx4 a[220:223], v1, s[4:7], s36 offen offset:3072 sc1
    s_add_u32 s36, s36, 4096
    buffer_store_dwordx4 a[224:227], v1, s[4:7], s36 offen offset:0 sc1
    buffer_store_dwordx4 a[228:231], v1, s[4:7], s36 offen offset:1024 sc1
    buffer_store_dwordx4 a[232:235], v1, s[4:7], s36 offen offset:2048 sc1
    buffer_store_dwordx4 a[236:239], v1, s[4:7], s36 offen offset:3072 sc1
    s_waitcnt vmcnt(0)
    s_barrier
    s_lshl_b32 s36, s31, 2
    s_add_u32 s36, s36, 5670912
    buffer_store_dword v16, v16, s[4:7], s36 offen sc1
    s_cmp_ge_u32 s31, 120
    s_cbranch_scc1 bulk_end
    s_mul_i32 s39, s31, 3277
    s_lshr_b32 s39, s39, 16
    s_mul_i32 s3, s39, 20
    s_sub_u32 s40, s31, s3
    s_mov_b32 s8, s56
    s_and_b32 s9, s57, 0xffff
    s_mov_b32 s10, 0x500000
    s_mov_b32 s11, 0x00020000
    s_mov_b32 s12, s60
    s_and_b32 s13, s61, 0xffff
    s_mov_b32 s14, 0x280000
    s_mov_b32 s15, 0x00020000
    s_mov_b32 s16, s50
    s_and_b32 s17, s51, 0xffff
    s_mov_b32 s18, 0x280000
    s_mov_b32 s19, 0x00020000
    v_lshrrev_b32 v200, 0x2, v244
    v_mul_u32_u24 v201, 0x500, v200
    v_and_b32 v202, 0x3, v244
    v_lshlrev_b32 v203, 0x4, v202
    v_add_u32 v204, v203, v201
    v_mov_b32 v2, v204
    v_mul_u32_u24 v200, 0xa000, v247
    v_lshlrev_b32 v201, 0x2, v245
    v_lshrrev_b32 v202, 0x2, v244
    v_and_b32 v203, 0x3, v202
    v_add_u32 v204, v203, v201
    v_lshlrev_b32 v205, 0x6, v204
    v_add_u32 v206, v205, v200
    v_and_b32 v207, 0x3, v244
    v_lshlrev_b32 v208, 0x3, v207
    v_add_u32 v209, v208, v206
    v_mov_b32 v5, v209
    s_mul_i32 s33, s30, 1310720
    s_lshl_b32 s3, s40, 6
    s_add_u32 s33, s33, s3
    s_mul_i32 s35, s30, 40960
    s_add_u32 m0, s35, 0
    s_add_u32 s37, s33, 0
    buffer_load_dwordx4 v2, s[8:11], s37 offen lds
    s_add_u32 m0, s35, 1024
    s_add_u32 s37, s33, 20480
    buffer_load_dwordx4 v2, s[8:11], s37 offen lds
    s_add_u32 m0, s35, 2048
    s_add_u32 s37, s33, 40960
    buffer_load_dwordx4 v2, s[8:11], s37 offen lds
    s_add_u32 m0, s35, 3072
    s_add_u32 s37, s33, 61440
    buffer_load_dwordx4 v2, s[8:11], s37 offen lds
    s_add_u32 m0, s35, 4096
    s_add_u32 s37, s33, 81920
    buffer_load_dwordx4 v2, s[8:11], s37 offen lds
    s_add_u32 m0, s35, 5120
    s_add_u32 s37, s33, 102400
    buffer_load_dwordx4 v2, s[8:11], s37 offen lds
    s_add_u32 m0, s35, 6144
    s_add_u32 s37, s33, 122880
    buffer_load_dwordx4 v2, s[8:11], s37 offen lds
    s_add_u32 m0, s35, 7168
    s_add_u32 s37, s33, 143360
    buffer_load_dwordx4 v2, s[8:11], s37 offen lds
    s_add_u32 m0, s35, 8192
    s_add_u32 s37, s33, 163840
    buffer_load_dwordx4 v2, s[8:11], s37 offen lds
    s_add_u32 m0, s35, 9216
    s_add_u32 s37, s33, 184320
    buffer_load_dwordx4 v2, s[8:11], s37 offen lds
    s_add_u32 m0, s35, 10240
    s_add_u32 s37, s33, 204800
    buffer_load_dwordx4 v2, s[8:11], s37 offen lds
    s_add_u32 m0, s35, 11264
    s_add_u32 s37, s33, 225280
    buffer_load_dwordx4 v2, s[8:11], s37 offen lds
    s_add_u32 m0, s35, 12288
    s_add_u32 s37, s33, 245760
    buffer_load_dwordx4 v2, s[8:11], s37 offen lds
    s_add_u32 m0, s35, 13312
    s_add_u32 s37, s33, 266240
    buffer_load_dwordx4 v2, s[8:11], s37 offen lds
    s_add_u32 m0, s35, 14336
    s_add_u32 s37, s33, 286720
    buffer_load_dwordx4 v2, s[8:11], s37 offen lds
    s_add_u32 m0, s35, 15360
    s_add_u32 s37, s33, 307200
    buffer_load_dwordx4 v2, s[8:11], s37 offen lds
    s_add_u32 m0, s35, 16384
    s_add_u32 s37, s33, 327680
    buffer_load_dwordx4 v2, s[8:11], s37 offen lds
    s_add_u32 m0, s35, 17408
    s_add_u32 s37, s33, 348160
    buffer_load_dwordx4 v2, s[8:11], s37 offen lds
    s_add_u32 m0, s35, 18432
    s_add_u32 s37, s33, 368640
    buffer_load_dwordx4 v2, s[8:11], s37 offen lds
    s_add_u32 m0, s35, 19456
    s_add_u32 s37, s33, 389120
    buffer_load_dwordx4 v2, s[8:11], s37 offen lds
    s_add_u32 m0, s35, 20480
    s_add_u32 s37, s33, 409600
    buffer_load_dwordx4 v2, s[8:11], s37 offen lds
    s_add_u32 m0, s35, 21504
    s_add_u32 s37, s33, 430080
    buffer_load_dwordx4 v2, s[8:11], s37 offen lds
    s_add_u32 m0, s35, 22528
    s_add_u32 s37, s33, 450560
    buffer_load_dwordx4 v2, s[8:11], s37 offen lds
    s_add_u32 m0, s35, 23552
    s_add_u32 s37, s33, 471040
    buffer_load_dwordx4 v2, s[8:11], s37 offen lds
    s_add_u32 m0, s35, 24576
    s_add_u32 s37, s33, 491520
    buffer_load_dwordx4 v2, s[8:11], s37 offen lds
    s_add_u32 m0, s35, 25600
    s_add_u32 s37, s33, 512000
    buffer_load_dwordx4 v2, s[8:11], s37 offen lds
    s_add_u32 m0, s35, 26624
    s_add_u32 s37, s33, 532480
    buffer_load_dwordx4 v2, s[8:11], s37 offen lds
    s_add_u32 m0, s35, 27648
    s_add_u32 s37, s33, 552960
    buffer_load_dwordx4 v2, s[8:11], s37 offen lds
    s_add_u32 m0, s35, 28672
    s_add_u32 s37, s33, 573440
    buffer_load_dwordx4 v2, s[8:11], s37 offen lds
    s_add_u32 m0, s35, 29696
    s_add_u32 s37, s33, 593920
    buffer_load_dwordx4 v2, s[8:11], s37 offen lds
    s_add_u32 m0, s35, 30720
    s_add_u32 s37, s33, 614400
    buffer_load_dwordx4 v2, s[8:11], s37 offen lds
    s_add_u32 m0, s35, 31744
    s_add_u32 s37, s33, 634880
    buffer_load_dwordx4 v2, s[8:11], s37 offen lds
    s_waitcnt vmcnt(0)
    ds_read_b64_tr_b16 a[0:1], v5 offset:0
    ds_read_b64_tr_b16 a[2:3], v5 offset:1024
    ds_read_b64_tr_b16 a[4:5], v5 offset:32
    ds_read_b64_tr_b16 a[6:7], v5 offset:1056
    ds_read_b64_tr_b16 a[8:9], v5 offset:2048
    ds_read_b64_tr_b16 a[10:11], v5 offset:3072
    ds_read_b64_tr_b16 a[12:13], v5 offset:2080
    ds_read_b64_tr_b16 a[14:15], v5 offset:3104
    s_waitcnt lgkmcnt(4)
    ds_read_b64_tr_b16 a[16:17], v5 offset:4096
    ds_read_b64_tr_b16 a[18:19], v5 offset:5120
    ds_read_b64_tr_b16 a[20:21], v5 offset:4128
    ds_read_b64_tr_b16 a[22:23], v5 offset:5152
    ds_read_b64_tr_b16 a[24:25], v5 offset:6144
    ds_read_b64_tr_b16 a[26:27], v5 offset:7168
    ds_read_b64_tr_b16 a[28:29], v5 offset:6176
    ds_read_b64_tr_b16 a[30:31], v5 offset:7200
    s_waitcnt lgkmcnt(4)
    ds_read_b64_tr_b16 a[32:33], v5 offset:8192
    ds_read_b64_tr_b16 a[34:35], v5 offset:9216
    ds_read_b64_tr_b16 a[36:37], v5 offset:8224
    ds_read_b64_tr_b16 a[38:39], v5 offset:9248
    ds_read_b64_tr_b16 a[40:41], v5 offset:10240
    ds_read_b64_tr_b16 a[42:43], v5 offset:11264
    ds_read_b64_tr_b16 a[44:45], v5 offset:10272
    ds_read_b64_tr_b16 a[46:47], v5 offset:11296
    s_waitcnt lgkmcnt(4)
    ds_read_b64_tr_b16 a[48:49], v5 offset:12288
    ds_read_b64_tr_b16 a[50:51], v5 offset:13312
    ds_read_b64_tr_b16 a[52:53], v5 offset:12320
    ds_read_b64_tr_b16 a[54:55], v5 offset:13344
    ds_read_b64_tr_b16 a[56:57], v5 offset:14336
    ds_read_b64_tr_b16 a[58:59], v5 offset:15360
    ds_read_b64_tr_b16 a[60:61], v5 offset:14368
    ds_read_b64_tr_b16 a[62:63], v5 offset:15392
    s_waitcnt lgkmcnt(4)
    ds_read_b64_tr_b16 a[64:65], v5 offset:16384
    ds_read_b64_tr_b16 a[66:67], v5 offset:17408
    ds_read_b64_tr_b16 a[68:69], v5 offset:16416
    ds_read_b64_tr_b16 a[70:71], v5 offset:17440
    ds_read_b64_tr_b16 a[72:73], v5 offset:18432
    ds_read_b64_tr_b16 a[74:75], v5 offset:19456
    ds_read_b64_tr_b16 a[76:77], v5 offset:18464
    ds_read_b64_tr_b16 a[78:79], v5 offset:19488
    s_waitcnt lgkmcnt(4)
    ds_read_b64_tr_b16 a[80:81], v5 offset:20480
    ds_read_b64_tr_b16 a[82:83], v5 offset:21504
    ds_read_b64_tr_b16 a[84:85], v5 offset:20512
    ds_read_b64_tr_b16 a[86:87], v5 offset:21536
    ds_read_b64_tr_b16 a[88:89], v5 offset:22528
    ds_read_b64_tr_b16 a[90:91], v5 offset:23552
    ds_read_b64_tr_b16 a[92:93], v5 offset:22560
    ds_read_b64_tr_b16 a[94:95], v5 offset:23584
    s_waitcnt lgkmcnt(4)
    ds_read_b64_tr_b16 a[96:97], v5 offset:24576
    ds_read_b64_tr_b16 a[98:99], v5 offset:25600
    ds_read_b64_tr_b16 a[100:101], v5 offset:24608
    ds_read_b64_tr_b16 a[102:103], v5 offset:25632
    ds_read_b64_tr_b16 a[104:105], v5 offset:26624
    ds_read_b64_tr_b16 a[106:107], v5 offset:27648
    ds_read_b64_tr_b16 a[108:109], v5 offset:26656
    ds_read_b64_tr_b16 a[110:111], v5 offset:27680
    s_waitcnt lgkmcnt(4)
    ds_read_b64_tr_b16 a[112:113], v5 offset:28672
    ds_read_b64_tr_b16 a[114:115], v5 offset:29696
    ds_read_b64_tr_b16 a[116:117], v5 offset:28704
    ds_read_b64_tr_b16 a[118:119], v5 offset:29728
    ds_read_b64_tr_b16 a[120:121], v5 offset:30720
    ds_read_b64_tr_b16 a[122:123], v5 offset:31744
    ds_read_b64_tr_b16 a[124:125], v5 offset:30752
    ds_read_b64_tr_b16 a[126:127], v5 offset:31776
    s_waitcnt lgkmcnt(4)
    s_waitcnt lgkmcnt(0)
    s_add_u32 m0, s35, 0
    s_add_u32 s37, s33, 655360
    buffer_load_dwordx4 v2, s[8:11], s37 offen lds
    s_add_u32 m0, s35, 1024
    s_add_u32 s37, s33, 675840
    buffer_load_dwordx4 v2, s[8:11], s37 offen lds
    s_add_u32 m0, s35, 2048
    s_add_u32 s37, s33, 696320
    buffer_load_dwordx4 v2, s[8:11], s37 offen lds
    s_add_u32 m0, s35, 3072
    s_add_u32 s37, s33, 716800
    buffer_load_dwordx4 v2, s[8:11], s37 offen lds
    s_add_u32 m0, s35, 4096
    s_add_u32 s37, s33, 737280
    buffer_load_dwordx4 v2, s[8:11], s37 offen lds
    s_add_u32 m0, s35, 5120
    s_add_u32 s37, s33, 757760
    buffer_load_dwordx4 v2, s[8:11], s37 offen lds
    s_add_u32 m0, s35, 6144
    s_add_u32 s37, s33, 778240
    buffer_load_dwordx4 v2, s[8:11], s37 offen lds
    s_add_u32 m0, s35, 7168
    s_add_u32 s37, s33, 798720
    buffer_load_dwordx4 v2, s[8:11], s37 offen lds
    s_add_u32 m0, s35, 8192
    s_add_u32 s37, s33, 819200
    buffer_load_dwordx4 v2, s[8:11], s37 offen lds
    s_add_u32 m0, s35, 9216
    s_add_u32 s37, s33, 839680
    buffer_load_dwordx4 v2, s[8:11], s37 offen lds
    s_add_u32 m0, s35, 10240
    s_add_u32 s37, s33, 860160
    buffer_load_dwordx4 v2, s[8:11], s37 offen lds
    s_add_u32 m0, s35, 11264
    s_add_u32 s37, s33, 880640
    buffer_load_dwordx4 v2, s[8:11], s37 offen lds
    s_add_u32 m0, s35, 12288
    s_add_u32 s37, s33, 901120
    buffer_load_dwordx4 v2, s[8:11], s37 offen lds
    s_add_u32 m0, s35, 13312
    s_add_u32 s37, s33, 921600
    buffer_load_dwordx4 v2, s[8:11], s37 offen lds
    s_add_u32 m0, s35, 14336
    s_add_u32 s37, s33, 942080
    buffer_load_dwordx4 v2, s[8:11], s37 offen lds
    s_add_u32 m0, s35, 15360
    s_add_u32 s37, s33, 962560
    buffer_load_dwordx4 v2, s[8:11], s37 offen lds
    s_add_u32 m0, s35, 16384
    s_add_u32 s37, s33, 983040
    buffer_load_dwordx4 v2, s[8:11], s37 offen lds
    s_add_u32 m0, s35, 17408
    s_add_u32 s37, s33, 1003520
    buffer_load_dwordx4 v2, s[8:11], s37 offen lds
    s_add_u32 m0, s35, 18432
    s_add_u32 s37, s33, 1024000
    buffer_load_dwordx4 v2, s[8:11], s37 offen lds
    s_add_u32 m0, s35, 19456
    s_add_u32 s37, s33, 1044480
    buffer_load_dwordx4 v2, s[8:11], s37 offen lds
    s_add_u32 m0, s35, 20480
    s_add_u32 s37, s33, 1064960
    buffer_load_dwordx4 v2, s[8:11], s37 offen lds
    s_add_u32 m0, s35, 21504
    s_add_u32 s37, s33, 1085440
    buffer_load_dwordx4 v2, s[8:11], s37 offen lds
    s_add_u32 m0, s35, 22528
    s_add_u32 s37, s33, 1105920
    buffer_load_dwordx4 v2, s[8:11], s37 offen lds
    s_add_u32 m0, s35, 23552
    s_add_u32 s37, s33, 1126400
    buffer_load_dwordx4 v2, s[8:11], s37 offen lds
    s_add_u32 m0, s35, 24576
    s_add_u32 s37, s33, 1146880
    buffer_load_dwordx4 v2, s[8:11], s37 offen lds
    s_add_u32 m0, s35, 25600
    s_add_u32 s37, s33, 1167360
    buffer_load_dwordx4 v2, s[8:11], s37 offen lds
    s_add_u32 m0, s35, 26624
    s_add_u32 s37, s33, 1187840
    buffer_load_dwordx4 v2, s[8:11], s37 offen lds
    s_add_u32 m0, s35, 27648
    s_add_u32 s37, s33, 1208320
    buffer_load_dwordx4 v2, s[8:11], s37 offen lds
    s_add_u32 m0, s35, 28672
    s_add_u32 s37, s33, 1228800
    buffer_load_dwordx4 v2, s[8:11], s37 offen lds
    s_add_u32 m0, s35, 29696
    s_add_u32 s37, s33, 1249280
    buffer_load_dwordx4 v2, s[8:11], s37 offen lds
    s_add_u32 m0, s35, 30720
    s_add_u32 s37, s33, 1269760
    buffer_load_dwordx4 v2, s[8:11], s37 offen lds
    s_add_u32 m0, s35, 31744
    s_add_u32 s37, s33, 1290240
    buffer_load_dwordx4 v2, s[8:11], s37 offen lds
    s_waitcnt vmcnt(0)
    ds_read_b64_tr_b16 a[128:129], v5 offset:0
    ds_read_b64_tr_b16 a[130:131], v5 offset:1024
    ds_read_b64_tr_b16 a[132:133], v5 offset:32
    ds_read_b64_tr_b16 a[134:135], v5 offset:1056
    ds_read_b64_tr_b16 a[136:137], v5 offset:2048
    ds_read_b64_tr_b16 a[138:139], v5 offset:3072
    ds_read_b64_tr_b16 a[140:141], v5 offset:2080
    ds_read_b64_tr_b16 a[142:143], v5 offset:3104
    s_waitcnt lgkmcnt(4)
    ds_read_b64_tr_b16 a[144:145], v5 offset:4096
    ds_read_b64_tr_b16 a[146:147], v5 offset:5120
    ds_read_b64_tr_b16 a[148:149], v5 offset:4128
    ds_read_b64_tr_b16 a[150:151], v5 offset:5152
    ds_read_b64_tr_b16 a[152:153], v5 offset:6144
    ds_read_b64_tr_b16 a[154:155], v5 offset:7168
    ds_read_b64_tr_b16 a[156:157], v5 offset:6176
    ds_read_b64_tr_b16 a[158:159], v5 offset:7200
    s_waitcnt lgkmcnt(4)
    ds_read_b64_tr_b16 a[160:161], v5 offset:8192
    ds_read_b64_tr_b16 a[162:163], v5 offset:9216
    ds_read_b64_tr_b16 a[164:165], v5 offset:8224
    ds_read_b64_tr_b16 a[166:167], v5 offset:9248
    ds_read_b64_tr_b16 a[168:169], v5 offset:10240
    ds_read_b64_tr_b16 a[170:171], v5 offset:11264
    ds_read_b64_tr_b16 a[172:173], v5 offset:10272
    ds_read_b64_tr_b16 a[174:175], v5 offset:11296
    s_waitcnt lgkmcnt(4)
    ds_read_b64_tr_b16 a[176:177], v5 offset:12288
    ds_read_b64_tr_b16 a[178:179], v5 offset:13312
    ds_read_b64_tr_b16 a[180:181], v5 offset:12320
    ds_read_b64_tr_b16 a[182:183], v5 offset:13344
    ds_read_b64_tr_b16 a[184:185], v5 offset:14336
    ds_read_b64_tr_b16 a[186:187], v5 offset:15360
    ds_read_b64_tr_b16 a[188:189], v5 offset:14368
    ds_read_b64_tr_b16 a[190:191], v5 offset:15392
    s_waitcnt lgkmcnt(4)
    ds_read_b64_tr_b16 a[192:193], v5 offset:16384
    ds_read_b64_tr_b16 a[194:195], v5 offset:17408
    ds_read_b64_tr_b16 a[196:197], v5 offset:16416
    ds_read_b64_tr_b16 a[198:199], v5 offset:17440
    ds_read_b64_tr_b16 a[200:201], v5 offset:18432
    ds_read_b64_tr_b16 a[202:203], v5 offset:19456
    ds_read_b64_tr_b16 a[204:205], v5 offset:18464
    ds_read_b64_tr_b16 a[206:207], v5 offset:19488
    s_waitcnt lgkmcnt(4)
    ds_read_b64_tr_b16 a[208:209], v5 offset:20480
    ds_read_b64_tr_b16 a[210:211], v5 offset:21504
    ds_read_b64_tr_b16 a[212:213], v5 offset:20512
    ds_read_b64_tr_b16 a[214:215], v5 offset:21536
    ds_read_b64_tr_b16 a[216:217], v5 offset:22528
    ds_read_b64_tr_b16 a[218:219], v5 offset:23552
    ds_read_b64_tr_b16 a[220:221], v5 offset:22560
    ds_read_b64_tr_b16 a[222:223], v5 offset:23584
    s_waitcnt lgkmcnt(4)
    ds_read_b64_tr_b16 a[224:225], v5 offset:24576
    ds_read_b64_tr_b16 a[226:227], v5 offset:25600
    ds_read_b64_tr_b16 a[228:229], v5 offset:24608
    ds_read_b64_tr_b16 a[230:231], v5 offset:25632
    ds_read_b64_tr_b16 a[232:233], v5 offset:26624
    ds_read_b64_tr_b16 a[234:235], v5 offset:27648
    ds_read_b64_tr_b16 a[236:237], v5 offset:26656
    ds_read_b64_tr_b16 a[238:239], v5 offset:27680
    s_waitcnt lgkmcnt(4)
    ds_read_b64_tr_b16 a[240:241], v5 offset:28672
    ds_read_b64_tr_b16 a[242:243], v5 offset:29696
    ds_read_b64_tr_b16 a[244:245], v5 offset:28704
    ds_read_b64_tr_b16 a[246:247], v5 offset:29728
    ds_read_b64_tr_b16 a[248:249], v5 offset:30720
    ds_read_b64_tr_b16 a[250:251], v5 offset:31744
    ds_read_b64_tr_b16 a[252:253], v5 offset:30752
    ds_read_b64_tr_b16 a[254:255], v5 offset:31776
    s_waitcnt lgkmcnt(4)
    s_waitcnt lgkmcnt(0)
    v_lshlrev_b32 v200, 0xb, v247
    v_add_u32 v201, v1, v200
    v_mov_b32 v12, v201
    v_and_b32 v200, 0x1, v247
    v_lshlrev_b32 v201, 0xa, v200
    v_add_u32 v202, v1, v201
    v_mov_b32 v13, v202
    v_lshlrev_b32 v200, 0xf, v247
    v_add_u32 v201, v1, v200
    v_mov_b32 v3, v201
    v_and_b32 v200, 0x1, v247
    v_lshlrev_b32 v201, 0xa, v200
    v_add_u32 v202, v1, v201
    v_mov_b32 v10, v202
    v_mul_u32_u24 v200, 0x500, v246
    v_and_b32 v201, 0x1, v247
    v_lshlrev_b32 v202, 0x5, v201
    v_add_u32 v203, v202, v200
    v_lshlrev_b32 v204, 0x3, v245
    v_add_u32 v205, v204, v203
    v_mov_b32 v11, v205
g_poll:
    s_mov_b32 s36, 5670912
    buffer_load_dwordx2 v[6:7], v14, s[4:7], s36 offen sc1
    s_waitcnt vmcnt(0)
    v_max_u32 v6, v6, v7
    v_cmp_eq_u32 vcc, -1, v6
    s_cbranch_vccz g_ok
    s_sleep 8
    s_sub_u32 s38, s38, 1
    s_cbranch_scc0 g_poll
    s_branch bulk_abort
g_ok:
    s_barrier
    s_mov_b32 s41, 0
op_loop:
    s_lshr_b32 s36, s39, 1
    s_cmp_ge_u32 s36, 62
    s_cbranch_scc1 op_final
    s_lshl_b32 s36, s36, 7
    s_add_u32 s36, s36, 5677056
    v_mov_b32 v8, 0
p_poll:
    buffer_load_dword v6, v8, s[4:7], s36 offen sc1
    s_waitcnt vmcnt(0)
    v_cmp_eq_u32 vcc, -1, v6
    s_cbranch_vccz op_go
    s_sleep 8
    s_sub_u32 s38, s38, 1
    s_cbranch_scc0 p_poll
    s_branch bulk_abort
op_final:
    s_mov_b32 s36, 5669888
    buffer_load_dwordx2 v[6:7], v14, s[4:7], s36 offen sc1
    s_waitcnt vmcnt(0)
    v_max_u32 v6, v6, v7
    v_cmp_eq_u32 vcc, -1, v6
    s_cbranch_vccz op_go
    s_sleep 2
    s_sub_u32 s38, s38, 1
    s_cbranch_scc0 op_final
    s_branch bulk_abort
op_go:
    s_lshl_b32 s36, s39, 17
    s_add_u32 s36, s36, 110624768
    buffer_load_dwordx4 v[112:115], v3, s[4:7], s36 offen offset:0 sc1
    buffer_load_dwordx4 v[116:119], v3, s[4:7], s36 offen offset:1024 sc1
    buffer_load_dwordx4 v[120:123], v3, s[4:7], s36 offen offset:2048 sc1
    buffer_load_dwordx4 v[124:127], v3, s[4:7], s36 offen offset:3072 sc1
    s_add_u32 s36, s36, 4096
    buffer_load_dwordx4 v[128:131], v3, s[4:7], s36 offen offset:0 sc1
    buffer_load_dwordx4 v[132:135], v3, s[4:7], s36 offen offset:1024 sc1
    buffer_load_dwordx4 v[136:139], v3, s[4:7], s36 offen offset:2048 sc1
    buffer_load_dwordx4 v[140:143], v3, s[4:7], s36 offen offset:3072 sc1
    s_add_u32 s36, s36, 4096
    buffer_load_dwordx4 v[144:147], v3, s[4:7], s36 offen offset:0 sc1
    buffer_load_dwordx4 v[148:151], v3, s[4:7], s36 offen offset:1024 sc1
    buffer_load_dwordx4 v[152:155], v3, s[4:7], s36 offen offset:2048 sc1
    buffer_load_dwordx4 v[156:159], v3, s[4:7], s36 offen offset:3072 sc1
    s_add_u32 s36, s36, 4096
    buffer_load_dwordx4 v[160:163], v3, s[4:7], s36 offen offset:0 sc1
    buffer_load_dwordx4 v[164:167], v3, s[4:7], s36 offen offset:1024 sc1
    buffer_load_dwordx4 v[168:171], v3, s[4:7], s36 offen offset:2048 sc1
    buffer_load_dwordx4 v[172:175], v3, s[4:7], s36 offen offset:3072 sc1
    s_add_u32 s36, s36, 4096
    buffer_load_dwordx4 v[176:179], v3, s[4:7], s36 offen offset:0 sc1
    buffer_load_dwordx4 v[180:183], v3, s[4:7], s36 offen offset:1024 sc1
    buffer_load_dwordx4 v[184:187], v3, s[4:7], s36 offen offset:2048 sc1
    buffer_load_dwordx4 v[188:191], v3, s[4:7], s36 offen offset:3072 sc1
    s_add_u32 s36, s36, 4096
    buffer_load_dwordx4 v[192:195], v3, s[4:7], s36 offen offset:0 sc1
    buffer_load_dwordx4 v[196:199], v3, s[4:7], s36 offen offset:1024 sc1
    buffer_load_dwordx4 v[200:203], v3, s[4:7], s36 offen offset:2048 sc1
    buffer_load_dwordx4 v[204:207], v3, s[4:7], s36 offen offset:3072 sc1
    s_add_u32 s36, s36, 4096
    buffer_load_dwordx4 v[208:211], v3, s[4:7], s36 offen offset:0 sc1
    buffer_load_dwordx4 v[212:215], v3, s[4:7], s36 offen offset:1024 sc1
    buffer_load_dwordx4 v[216:219], v3, s[4:7], s36 offen offset:2048 sc1
    buffer_load_dwordx4 v[220:223], v3, s[4:7], s36 offen offset:3072 sc1
    s_add_u32 s36, s36, 4096
    buffer_load_dwordx4 v[224:227], v3, s[4:7], s36 offen offset:0 sc1
    buffer_load_dwordx4 v[228:231], v3, s[4:7], s36 offen offset:1024 sc1
    buffer_load_dwordx4 v[232:235], v3, s[4:7], s36 offen offset:2048 sc1
    buffer_load_dwordx4 v[236:239], v3, s[4:7], s36 offen offset:3072 sc1
op_mid:
    s_mul_i32 s36, s39, 20480
    s_lshl_b32 s37, s40, 10
    s_add_u32 s37, s37, s36
    s_lshl_b32 s37, s37, 1
    s_add_u32 s37, s37, 127401984
    buffer_load_dwordx4 v[84:87], v10, s[4:7], s37 offen sc1
    s_add_u32 s37, s37, 5242880
    buffer_load_dwordx4 v[88:91], v10, s[4:7], s37 offen sc1
    s_add_u32 s37, s37, 5242880
    buffer_load_dwordx4 v[92:95], v10, s[4:7], s37 offen sc1
    s_add_u32 s37, s37, 5242880
    buffer_load_dwordx4 v[96:99], v10, s[4:7], s37 offen sc1
    s_lshl_b32 s37, s40, 6
    s_add_u32 s34, s37, s36
    buffer_load_dwordx2 v[26:27], v11, s[12:15], s34 offen
    s_add_u32 s36, s39, 6
    s_lshr_b32 s36, s36, 1
    s_min_u32 s36, s36, 63
    s_lshl_b32 s36, s36, 7
    s_add_u32 s36, s36, 5677056
    v_mov_b32 v8, 0
    buffer_load_dword v24, v8, s[4:7], s36 offen sc1
    s_waitcnt vmcnt(37)
    v_mfma_f32_16x16x32_bf16 v[32:35], a[0:3], v[112:115], 0
    v_mfma_f32_16x16x32_bf16 v[36:39], a[4:7], v[112:115], 0
    s_waitcnt vmcnt(36)
    v_mfma_f32_16x16x32_bf16 v[32:35], a[8:11], v[116:119], v[32:35]
    v_mfma_f32_16x16x32_bf16 v[36:39], a[12:15], v[116:119], v[36:39]
    s_waitcnt vmcnt(35)
    v_mfma_f32_16x16x32_bf16 v[32:35], a[16:19], v[120:123], v[32:35]
    v_mfma_f32_16x16x32_bf16 v[36:39], a[20:23], v[120:123], v[36:39]
    s_waitcnt vmcnt(34)
    v_mfma_f32_16x16x32_bf16 v[32:35], a[24:27], v[124:127], v[32:35]
    v_mfma_f32_16x16x32_bf16 v[36:39], a[28:31], v[124:127], v[36:39]
    s_waitcnt vmcnt(33)
    v_mfma_f32_16x16x32_bf16 v[32:35], a[32:35], v[128:131], v[32:35]
    v_mfma_f32_16x16x32_bf16 v[36:39], a[36:39], v[128:131], v[36:39]
    s_waitcnt vmcnt(32)
    v_mfma_f32_16x16x32_bf16 v[32:35], a[40:43], v[132:135], v[32:35]
    v_mfma_f32_16x16x32_bf16 v[36:39], a[44:47], v[132:135], v[36:39]
    s_waitcnt vmcnt(31)
    v_mfma_f32_16x16x32_bf16 v[32:35], a[48:51], v[136:139], v[32:35]
    v_mfma_f32_16x16x32_bf16 v[36:39], a[52:55], v[136:139], v[36:39]
    s_waitcnt vmcnt(30)
    v_mfma_f32_16x16x32_bf16 v[32:35], a[56:59], v[140:143], v[32:35]
    v_mfma_f32_16x16x32_bf16 v[36:39], a[60:63], v[140:143], v[36:39]
    s_waitcnt vmcnt(29)
    v_mfma_f32_16x16x32_bf16 v[32:35], a[64:67], v[144:147], v[32:35]
    v_mfma_f32_16x16x32_bf16 v[36:39], a[68:71], v[144:147], v[36:39]
    s_waitcnt vmcnt(28)
    v_mfma_f32_16x16x32_bf16 v[32:35], a[72:75], v[148:151], v[32:35]
    v_mfma_f32_16x16x32_bf16 v[36:39], a[76:79], v[148:151], v[36:39]
    s_waitcnt vmcnt(27)
    v_mfma_f32_16x16x32_bf16 v[32:35], a[80:83], v[152:155], v[32:35]
    v_mfma_f32_16x16x32_bf16 v[36:39], a[84:87], v[152:155], v[36:39]
    s_waitcnt vmcnt(26)
    v_mfma_f32_16x16x32_bf16 v[32:35], a[88:91], v[156:159], v[32:35]
    v_mfma_f32_16x16x32_bf16 v[36:39], a[92:95], v[156:159], v[36:39]
    s_waitcnt vmcnt(25)
    v_mfma_f32_16x16x32_bf16 v[32:35], a[96:99], v[160:163], v[32:35]
    v_mfma_f32_16x16x32_bf16 v[36:39], a[100:103], v[160:163], v[36:39]
    s_waitcnt vmcnt(24)
    v_mfma_f32_16x16x32_bf16 v[32:35], a[104:107], v[164:167], v[32:35]
    v_mfma_f32_16x16x32_bf16 v[36:39], a[108:111], v[164:167], v[36:39]
    s_waitcnt vmcnt(23)
    v_mfma_f32_16x16x32_bf16 v[32:35], a[112:115], v[168:171], v[32:35]
    v_mfma_f32_16x16x32_bf16 v[36:39], a[116:119], v[168:171], v[36:39]
    s_waitcnt vmcnt(22)
    v_mfma_f32_16x16x32_bf16 v[32:35], a[120:123], v[172:175], v[32:35]
    v_mfma_f32_16x16x32_bf16 v[36:39], a[124:127], v[172:175], v[36:39]
    s_waitcnt vmcnt(21)
    v_mfma_f32_16x16x32_bf16 v[32:35], a[128:131], v[176:179], v[32:35]
    v_mfma_f32_16x16x32_bf16 v[36:39], a[132:135], v[176:179], v[36:39]
    s_waitcnt vmcnt(20)
    v_mfma_f32_16x16x32_bf16 v[32:35], a[136:139], v[180:183], v[32:35]
    v_mfma_f32_16x16x32_bf16 v[36:39], a[140:143], v[180:183], v[36:39]
    s_waitcnt vmcnt(19)
    v_mfma_f32_16x16x32_bf16 v[32:35], a[144:147], v[184:187], v[32:35]
    v_mfma_f32_16x16x32_bf16 v[36:39], a[148:151], v[184:187], v[36:39]
    s_waitcnt vmcnt(18)
    v_mfma_f32_16x16x32_bf16 v[32:35], a[152:155], v[188:191], v[32:35]
    v_mfma_f32_16x16x32_bf16 v[36:39], a[156:159], v[188:191], v[36:39]
    s_waitcnt vmcnt(17)
    v_mfma_f32_16x16x32_bf16 v[32:35], a[160:163], v[192:195], v[32:35]
    v_mfma_f32_16x16x32_bf16 v[36:39], a[164:167], v[192:195], v[36:39]
    s_waitcnt vmcnt(16)
    v_mfma_f32_16x16x32_bf16 v[32:35], a[168:171], v[196:199], v[32:35]
    v_mfma_f32_16x16x32_bf16 v[36:39], a[172:175], v[196:199], v[36:39]
    s_waitcnt vmcnt(15)
    v_mfma_f32_16x16x32_bf16 v[32:35], a[176:179], v[200:203], v[32:35]
    v_mfma_f32_16x16x32_bf16 v[36:39], a[180:183], v[200:203], v[36:39]
    s_waitcnt vmcnt(14)
    v_mfma_f32_16x16x32_bf16 v[32:35], a[184:187], v[204:207], v[32:35]
    v_mfma_f32_16x16x32_bf16 v[36:39], a[188:191], v[204:207], v[36:39]
    s_waitcnt vmcnt(13)
    v_mfma_f32_16x16x32_bf16 v[32:35], a[192:195], v[208:211], v[32:35]
    v_mfma_f32_16x16x32_bf16 v[36:39], a[196:199], v[208:211], v[36:39]
    s_waitcnt vmcnt(12)
    v_mfma_f32_16x16x32_bf16 v[32:35], a[200:203], v[212:215], v[32:35]
    v_mfma_f32_16x16x32_bf16 v[36:39], a[204:207], v[212:215], v[36:39]
    s_waitcnt vmcnt(11)
    v_mfma_f32_16x16x32_bf16 v[32:35], a[208:211], v[216:219], v[32:35]
    v_mfma_f32_16x16x32_bf16 v[36:39], a[212:215], v[216:219], v[36:39]
    s_waitcnt vmcnt(10)
    v_mfma_f32_16x16x32_bf16 v[32:35], a[216:219], v[220:223], v[32:35]
    v_mfma_f32_16x16x32_bf16 v[36:39], a[220:223], v[220:223], v[36:39]
    s_waitcnt vmcnt(9)
    v_mfma_f32_16x16x32_bf16 v[32:35], a[224:227], v[224:227], v[32:35]
    v_mfma_f32_16x16x32_bf16 v[36:39], a[228:231], v[224:227], v[36:39]
    s_waitcnt vmcnt(8)
    v_mfma_f32_16x16x32_bf16 v[32:35], a[232:235], v[228:231], v[32:35]
    v_mfma_f32_16x16x32_bf16 v[36:39], a[236:239], v[228:231], v[36:39]
    s_waitcnt vmcnt(7)
    v_mfma_f32_16x16x32_bf16 v[32:35], a[240:243], v[232:235], v[32:35]
    v_mfma_f32_16x16x32_bf16 v[36:39], a[244:247], v[232:235], v[36:39]
    s_waitcnt vmcnt(6)
    v_mfma_f32_16x16x32_bf16 v[32:35], a[248:251], v[236:239], v[32:35]
    v_mfma_f32_16x16x32_bf16 v[36:39], a[252:255], v[236:239], v[36:39]
    v_add_u32 v8, s41, v12
    v_add_u32 v9, s41, v13
    s_waitcnt vmcnt(0)
    v_readfirstlane_b32 s32, v24
    s_nop 3
    ds_write_b128 v8, v[32:35]
    ds_write_b128 v8, v[36:39] offset:1024
    s_xor_b32 s41, s41, 8192
    s_cmp_eq_u32 s32, -1
    s_cbranch_scc1 op_nopf
    s_lshl_b32 s36, s39, 17
    s_add_u32 s36, s36, 111411200
    buffer_load_dwordx4 v[112:115], v3, s[4:7], s36 offen offset:0 sc1
    buffer_load_dwordx4 v[116:119], v3, s[4:7], s36 offen offset:1024 sc1
    buffer_load_dwordx4 v[120:123], v3, s[4:7], s36 offen offset:2048 sc1
    buffer_load_dwordx4 v[124:127], v3, s[4:7], s36 offen offset:3072 sc1
    s_add_u32 s36, s36, 4096
    buffer_load_dwordx4 v[128:131], v3, s[4:7], s36 offen offset:0 sc1
    buffer_load_dwordx4 v[132:135], v3, s[4:7], s36 offen offset:1024 sc1
    buffer_load_dwordx4 v[136:139], v3, s[4:7], s36 offen offset:2048 sc1
    buffer_load_dwordx4 v[140:143], v3, s[4:7], s36 offen offset:3072 sc1
    s_add_u32 s36, s36, 4096
    buffer_load_dwordx4 v[144:147], v3, s[4:7], s36 offen offset:0 sc1
    buffer_load_dwordx4 v[148:151], v3, s[4:7], s36 offen offset:1024 sc1
    buffer_load_dwordx4 v[152:155], v3, s[4:7], s36 offen offset:2048 sc1
    buffer_load_dwordx4 v[156:159], v3, s[4:7], s36 offen offset:3072 sc1
    s_add_u32 s36, s36, 4096
    buffer_load_dwordx4 v[160:163], v3, s[4:7], s36 offen offset:0 sc1
    buffer_load_dwordx4 v[164:167], v3, s[4:7], s36 offen offset:1024 sc1
    buffer_load_dwordx4 v[168:171], v3, s[4:7], s36 offen offset:2048 sc1
    buffer_load_dwordx4 v[172:175], v3, s[4:7], s36 offen offset:3072 sc1
    s_add_u32 s36, s36, 4096
    buffer_load_dwordx4 v[176:179], v3, s[4:7], s36 offen offset:0 sc1
    buffer_load_dwordx4 v[180:183], v3, s[4:7], s36 offen offset:1024 sc1
    buffer_load_dwordx4 v[184:187], v3, s[4:7], s36 offen offset:2048 sc1
    buffer_load_dwordx4 v[188:191], v3, s[4:7], s36 offen offset:3072 sc1
    s_add_u32 s36, s36, 4096
    buffer_load_dwordx4 v[192:195], v3, s[4:7], s36 offen offset:0 sc1
    buffer_load_dwordx4 v[196:199], v3, s[4:7], s36 offen offset:1024 sc1
    buffer_load_dwordx4 v[200:203], v3, s[4:7], s36 offen offset:2048 sc1
    buffer_load_dwordx4 v[204:207], v3, s[4:7], s36 offen offset:3072 sc1
    s_add_u32 s36, s36, 4096
    buffer_load_dwordx4 v[208:211], v3, s[4:7], s36 offen offset:0 sc1
    buffer_load_dwordx4 v[212:215], v3, s[4:7], s36 offen offset:1024 sc1
    buffer_load_dwordx4 v[216:219], v3, s[4:7], s36 offen offset:2048 sc1
    buffer_load_dwordx4 v[220:223], v3, s[4:7], s36 offen offset:3072 sc1
    s_add_u32 s36, s36, 4096
    buffer_load_dwordx4 v[224:227], v3, s[4:7], s36 offen offset:0 sc1
    buffer_load_dwordx4 v[228:231], v3, s[4:7], s36 offen offset:1024 sc1
    buffer_load_dwordx4 v[232:235], v3, s[4:7], s36 offen offset:2048 sc1
    buffer_load_dwordx4 v[236:239], v3, s[4:7], s36 offen offset:3072 sc1
op_nopf:
    s_waitcnt lgkmcnt(0)
    s_barrier
    s_cmp_ge_u32 s30, 2
    s_cbranch_scc1 op_next
    ds_read_b128 v[64:67], v9 offset:0
    ds_read_b128 v[68:71], v9 offset:2048
    ds_read_b128 v[72:75], v9 offset:4096
    ds_read_b128 v[76:79], v9 offset:6144
    s_waitcnt lgkmcnt(0)
    v_add_f32 v64, v64, v68
    v_add_f32 v72, v72, v76
    v_add_f32 v64, v64, v72
    v_add_f32 v84, v84, v88
    v_add_f32 v92, v92, v96
    v_add_f32 v84, v84, v92
    v_add_f32 v65, v65, v69
    v_add_f32 v73, v73, v77
    v_add_f32 v65, v65, v73
    v_add_f32 v85, v85, v89
    v_add_f32 v93, v93, v97
    v_add_f32 v85, v85, v93
    v_add_f32 v66, v66, v70
    v_add_f32 v74, v74, v78
    v_add_f32 v66, v66, v74
    v_add_f32 v86, v86, v90
    v_add_f32 v94, v94, v98
    v_add_f32 v86, v86, v94
    v_add_f32 v67, v67, v71
    v_add_f32 v75, v75, v79
    v_add_f32 v67, v67, v75
    v_add_f32 v87, v87, v91
    v_add_f32 v95, v95, v99
    v_add_f32 v87, v87, v95
    v_cvt_pk_bf16_f32 v6, v84, v85
    v_lshlrev_b32 v84, 16, v6
    v_and_b32 v85, 0xffff0000, v6
    v_mul_f32 v6, 0xbfb8aa3b, v84
    v_exp_f32 v6, v6
    s_nop 0
    v_add_f32 v6, 1.0, v6
    v_rcp_f32 v6, v6
    s_nop 0
    v_mul_f32 v84, v84, v6
    v_mul_f32 v7, 0xbfb8aa3b, v85
    v_exp_f32 v7, v7
    s_nop 0
    v_add_f32 v7, 1.0, v7
    v_rcp_f32 v7, v7
    s_nop 0
    v_mul_f32 v85, v85, v7
    v_cvt_pk_bf16_f32 v6, v84, v85
    v_lshlrev_b32 v84, 16, v6
    v_and_b32 v85, 0xffff0000, v6
    v_cvt_pk_bf16_f32 v6, v64, v65
    v_lshlrev_b32 v64, 16, v6
    v_and_b32 v65, 0xffff0000, v6
    v_mul_f32 v64, v64, v84
    v_mul_f32 v65, v65, v85
    v_cvt_pk_bf16_f32 v6, v64, v65
    v_lshlrev_b32 v64, 16, v6
    v_and_b32 v65, 0xffff0000, v6
    v_lshlrev_b32 v6, 16, v26
    v_and_b32 v7, 0xffff0000, v26
    v_add_f32 v64, v64, v6
    v_add_f32 v65, v65, v7
    v_cvt_pk_bf16_f32 v80, v64, v65
    v_cvt_pk_bf16_f32 v6, v86, v87
    v_lshlrev_b32 v86, 16, v6
    v_and_b32 v87, 0xffff0000, v6
    v_mul_f32 v6, 0xbfb8aa3b, v86
    v_exp_f32 v6, v6
    s_nop 0
    v_add_f32 v6, 1.0, v6
    v_rcp_f32 v6, v6
    s_nop 0
    v_mul_f32 v86, v86, v6
    v_mul_f32 v7, 0xbfb8aa3b, v87
    v_exp_f32 v7, v7
    s_nop 0
    v_add_f32 v7, 1.0, v7
    v_rcp_f32 v7, v7
    s_nop 0
    v_mul_f32 v87, v87, v7
    v_cvt_pk_bf16_f32 v6, v86, v87
    v_lshlrev_b32 v86, 16, v6
    v_and_b32 v87, 0xffff0000, v6
    v_cvt_pk_bf16_f32 v6, v66, v67
    v_lshlrev_b32 v66, 16, v6
    v_and_b32 v67, 0xffff0000, v6
    v_mul_f32 v66, v66, v86
    v_mul_f32 v67, v67, v87
    v_cvt_pk_bf16_f32 v6, v66, v67
    v_lshlrev_b32 v66, 16, v6
    v_and_b32 v67, 0xffff0000, v6
    v_lshlrev_b32 v6, 16, v27
    v_and_b32 v7, 0xffff0000, v27
    v_add_f32 v66, v66, v6
    v_add_f32 v67, v67, v7
    v_cvt_pk_bf16_f32 v81, v66, v67
    buffer_store_dwordx2 v[80:81], v11, s[16:19], s34 offen
op_next:
    s_add_u32 s39, s39, 6
    s_cmp_lg_u32 s32, -1
    s_cbranch_scc1 op_mid
    s_cmp_lt_u32 s39, 128
    s_cbranch_scc1 op_loop
    s_endpgm
bulk_abort:
    v_mov_b32 v6, 9
    v_mov_b32 v7, 4
    buffer_store_dword v6, v7, s[20:23], 0 offen
bulk_end:
    s_endpgm
.section .rodata,"a"
.p2align 6
.amdhsa_kernel recurrent_scan__memory_aug_recurrent_mem_tr__glu_gated_swiglu__prompt_kernel
  .amdhsa_next_free_vgpr 512
  .amdhsa_next_free_sgpr 102
  .amdhsa_accum_offset 256
  .amdhsa_group_segment_fixed_size 0
  .amdhsa_kernarg_size 112
  .amdhsa_user_sgpr_count 2
  .amdhsa_user_sgpr_kernarg_segment_ptr 1
  .amdhsa_system_sgpr_workgroup_id_x 1
  .amdhsa_float_denorm_mode_32 3
  .amdhsa_float_denorm_mode_16_64 3
.end_amdhsa_kernel
```
